```python
import torch

def _softmax(x, axis=-1):
    return torch.softmax(x, dim=axis)
def _gelu(x):
    return torch.nn.functional.gelu(x, approximate="tanh")
def _silu(x):
    return torch.nn.functional.silu(x)
def _sigmoid(x):
    return torch.sigmoid(x)
def _layernorm(x, axis=-1, eps=1e-5):
    m = x.mean(dim=axis, keepdim=True)
    v = x.var(dim=axis, keepdim=True, unbiased=False)
    return (x - m) / torch.sqrt(v + eps)
def _scatter_add(tgt, idx, src, axis=0):
    return tgt.clone().index_add_(axis, idx, src)
def _segment_sum(src, seg, n):
    out = torch.zeros((n,) + src.shape[1:], dtype=src.dtype)
    return out.index_add_(0, seg, src)
def _pad(x, pw):
    flat = tuple(v for pair in reversed(pw) for v in pair)
    return torch.nn.functional.pad(x, flat)

kernel_name = 'concat_heads__mha_block_cached__mha_block_cached__near_ridge'

def setup_inputs():

    _w = (lambda a: (lambda t: t.to(torch.bfloat16) if t.is_floating_point() else t)(torch.as_tensor(a)))
    def _A_setup():
        B, Sq, D = 16, 112, 512
        H, Sk, Dh = 32, 512, 128
        return {
            "x": _w((lambda *s: torch.randn(*s, dtype=torch.bfloat16) * 0.8)(B, Sq, D)),
            "k_cache": _w((lambda *s: torch.randn(*s, dtype=torch.bfloat16) * 0.8)(B, H, Sk, Dh)),
            "v_cache": _w((lambda *s: torch.randn(*s, dtype=torch.bfloat16) * 0.05)(B, H, Sk, Dh)),
            "wq": _w((lambda *s: torch.randn(*s, dtype=torch.bfloat16) * 0.8)(D, H * Dh) * (D ** -0.5)),
            "wo": _w((lambda *s: torch.randn(*s, dtype=torch.bfloat16) * 0.05)(H * Dh, D) * ((H * Dh) ** -0.5)),
        }
    _A_in = _A_setup()

    def _B_setup():
        B, Sq, D = 16, 112, 512
        H, Sk, Dh = 32, 512, 128
        return {
            "x": _w((lambda *s: torch.randn(*s, dtype=torch.bfloat16) * 0.8)(B, Sq, D)),
            "k_cache": _w((lambda *s: torch.randn(*s, dtype=torch.bfloat16) * 0.8)(B, H, Sk, Dh)),
            "v_cache": _w((lambda *s: torch.randn(*s, dtype=torch.bfloat16) * 0.05)(B, H, Sk, Dh)),
            "wq": _w((lambda *s: torch.randn(*s, dtype=torch.bfloat16) * 0.8)(D, H * Dh) * (D ** -0.5)),
            "wo": _w((lambda *s: torch.randn(*s, dtype=torch.bfloat16) * 0.05)(H * Dh, D) * ((H * Dh) ** -0.5)),
        }
    _B_in = _B_setup()

    return {
        "A_x": _A_in["x"],
        "A_k_cache": _A_in["k_cache"],
        "A_v_cache": _A_in["v_cache"],
        "A_wq": _A_in["wq"],
        "A_wo": _A_in["wo"],
        "B_x": _B_in["x"],
        "B_k_cache": _B_in["k_cache"],
        "B_v_cache": _B_in["v_cache"],
        "B_wq": _B_in["wq"],
        "B_wo": _B_in["wo"],
    }

def reference(A_x, A_k_cache, A_v_cache, A_wq, A_wo, B_x, B_k_cache, B_v_cache, B_wq, B_wo):
    def _A_ref(x, k_cache, v_cache, wq, wo):
        B, Sq, D = x.shape
        H, Dh = 32, 128
        q = (lambda x, *d: x.permute(*d))((x @ wq).reshape(B, Sq, H, Dh), 0, 2, 1, 3)
        scores = torch.einsum("bhqd,bhkd->bhqk", q, k_cache) * (Dh ** -0.5)
        p = _softmax(scores, axis=-1)
        o = torch.einsum("bhqk,bhkd->bhqd", p, v_cache)
        return (lambda x, *d: x.permute(*d))(o, 0, 2, 1, 3).reshape(B, Sq, H * Dh) @ wo

    def _B_ref(x, k_cache, v_cache, wq, wo):
        B, Sq, D = x.shape
        H, Dh = 32, 128
        q = (lambda x, *d: x.permute(*d))((x @ wq).reshape(B, Sq, H, Dh), 0, 2, 1, 3)
        scores = torch.einsum("bhqd,bhkd->bhqk", q, k_cache) * (Dh ** -0.5)
        p = _softmax(scores, axis=-1)
        o = torch.einsum("bhqk,bhkd->bhqd", p, v_cache)
        return (lambda x, *d: x.permute(*d))(o, 0, 2, 1, 3).reshape(B, Sq, H * Dh) @ wo

    a = _A_ref(A_x, A_k_cache, A_v_cache, A_wq, A_wo)
    b = _B_ref(B_x, B_k_cache, B_v_cache, B_wq, B_wo)
    return torch.concatenate([a, b], axis=-1)
```

```asm
; @launch grid=(256,1,1) block=(256,1,1) lds=163840
.amdgcn_target "amdgcn-amd-amdhsa--gfx950"
.text
.globl concat_heads__mha_block_cached__mha_block_cached__near_ridge_kernel
.p2align 8
.type concat_heads__mha_block_cached__mha_block_cached__near_ridge_kernel,@function
concat_heads__mha_block_cached__mha_block_cached__near_ridge_kernel:
    s_cmp_ge_u32 s2, 256
    s_cbranch_scc1 L_end
    s_and_b32 s52, s2, 7
    s_lshr_b32 s3, s52, 2
    s_mul_i32 s53, s3, 40
    s_add_u32 s66, s0, s53
    s_addc_u32 s67, s1, 0
    s_load_dwordx2 s[28:29], s[66:67], 0
    s_load_dwordx2 s[16:17], s[66:67], 24
    s_load_dwordx2 s[8:9], s[66:67], 8
    s_load_dwordx2 s[12:13], s[66:67], 16
    s_load_dwordx2 s[20:21], s[66:67], 32
    s_load_dwordx2 s[32:33], s[0:1], 80
    s_load_dwordx2 s[36:37], s[0:1], 88
    s_load_dwordx2 s[24:25], s[0:1], 96
    v_lshrrev_b32 v1, 6, v0
    s_lshr_b32 s7, s2, 3
    v_readfirstlane_b32 s40, v1
    v_and_b32 v0, 63, v0
    s_lshr_b32 s4, s7, 1
    s_and_b32 s52, s52, 3
    s_and_b32 s53, s7, 1
    s_lshl1_add_u32 s5, s52, s53
    s_getpc_b64 s[68:69]
L_pc:
    s_sub_u32 s68, s68, L_pc-concat_heads__mha_block_cached__mha_block_cached__near_ridge_kernel
    s_subb_u32 s69, s69, 0
    s_lshl2_add_u32 s52, s7, s40
    s_lshl_b32 s52, s52, 9
    v_and_b32 v1, 3, v0
    v_lshl_add_u32 v1, v1, 7, s52
    v_min_u32 v1, L_end-concat_heads__mha_block_cached__mha_block_cached__near_ridge_kernel, v1
    global_load_dword v7, v1, s[68:69]
    s_mov_b32 s30, 114688
    s_mov_b32 s31, 0x20000
    s_mov_b32 s18, 4194304
    s_mov_b32 s19, 0x20000
    s_lshl_b32 s53, s53, 2
    s_xor_b32 s53, s53, s4
    s_and_b32 s45, s53, 3
    s_and_b32 s41, s40, 1
    s_lshr_b32 s42, s40, 1
    s_lshl_b32 s52, s41, 15
    s_add_u32 s52, s52, 8192
    s_mul_i32 s53, s41, 24576
    s_add_u32 s53, s53, 114688
    s_cmp_eq_u32 s42, 0
    s_cselect_b32 s63, s52, s53
    s_cselect_b32 s52, 8192, 0
    s_add_u32 s64, s63, 24576
    s_add_u32 s62, s63, s52
    s_mov_b32 s61, s62
    s_lshl_b32 s96, s40, 10
    s_add_u32 s96, s96, 65536
    s_mov_b32 s65, 0
    s_lshl2_add_u32 s54, s5, s41
    v_lshrrev_b32 v1, 3, v0
    v_and_b32 v2, 7, v0
    v_lshrrev_b32 v3, 2, v0
    v_and_b32 v3, 4, v3
    v_xor_b32 v3, v3, v2
    v_lshlrev_b32 v3, 4, v3
    v_lshl_add_u32 v254, v1, 13, v3
    s_lshl1_add_u32 s52, s54, s42
    s_lshl_b32 s52, s52, 7
    v_add_u32 v254, s52, v254
    v_lshrrev_b32 v3, 4, v0
    v_lshl_add_u32 v3, s41, 2, v3
    v_xor_b32 v3, v3, v2
    v_lshlrev_b32 v3, 4, v3
    v_lshl_add_u32 v1, s40, 3, v1
    v_lshl_add_u32 v255, v1, 10, v3
    s_mul_i32 s52, s4, 114688
    s_lshl_b32 s53, s5, 19
    s_waitcnt lgkmcnt(0)
    s_add_u32 s28, s28, s52
    s_addc_u32 s29, s29, 0
    s_add_u32 s20, s20, s53
    s_addc_u32 s21, s21, 0
    s_add_u32 m0, s96, s65
    s_xor_b32 s57, s45, 0
    s_lshl_b32 s57, s57, 7
    buffer_load_dwordx4 v255, s[28:31], s57 offen lds
    s_addk_i32 m0, 4096
    s_add_u32 s57, s57, 32768
    buffer_load_dwordx4 v255, s[28:31], s57 offen lds
    s_addk_i32 m0, 4096
    s_add_u32 s57, s57, 32768
    buffer_load_dwordx4 v255, s[28:31], s57 offen lds
    s_addk_i32 m0, 4096
    s_add_u32 s57, s57, 32768
    buffer_load_dwordx4 v255, s[28:31], s57 offen lds
    s_addk_i32 s65, 16384
    s_mov_b32 m0, s62
    s_xor_b32 s58, s45, 0
    s_lshl_b32 s58, s58, 19
    buffer_load_dwordx4 v254, s[16:19], s58 offen offset:0 lds
    s_add_u32 s58, s58, 64512
    buffer_load_dwordx4 v254, s[16:19], s58 offen offset:1024 lds
    s_add_u32 s58, s58, 64512
    buffer_load_dwordx4 v254, s[16:19], s58 offen offset:2048 lds
    s_add_u32 s58, s58, 64512
    buffer_load_dwordx4 v254, s[16:19], s58 offen offset:3072 lds
    v_mov_b32 v232, 0
    v_mov_b32 v233, 0
    v_mov_b32 v234, 0
    v_mov_b32 v235, 0
    s_mov_b32 s10, 67108864
    s_mov_b32 s11, 0x20000
    s_mov_b32 s14, 67108864
    v_mfma_f32_32x32x16_bf16 v[8:23], v[232:235], v[232:235], 0
    s_mov_b32 s15, 0x20000
    s_mov_b32 s22, 524288
    s_mov_b32 s23, 0x20000
    s_mov_b32 s26, 288882688
    s_mov_b32 s27, 0x20000
    s_mov_b32 s34, 3670016
    v_mfma_f32_32x32x16_bf16 v[24:39], v[232:235], v[232:235], 0
    s_mov_b32 s35, 0x20000
    s_mov_b32 s38, 256
    s_mov_b32 s39, 0x20000
    s_lshl4_add_u32 s6, s3, s4
    s_lshl1_add_u32 s43, s41, s42
    s_lshl_b32 s52, s4, 5
    v_mfma_f32_32x32x16_bf16 v[40:55], v[232:235], v[232:235], 0
    s_add_u32 s52, s52, s54
    s_lshl_b32 s46, s52, 17
    s_mul_i32 s52, s2, 0x9e3779b1
    s_lshr_b32 s52, s52, 28
    s_mul_i32 s53, s41, 2
    s_add_u32 s52, s52, s53
    v_mfma_f32_32x32x16_bf16 v[56:71], v[232:235], v[232:235], 0
    s_and_b32 s52, s52, 15
    s_lshl1_add_u32 s52, s52, s41
    s_lshl_b32 s52, s52, 12
    s_or_b32 s46, s46, s52
    s_add_u32 s47, s46, 262144
    s_mul_i32 s48, s41, 36864
    v_mfma_f32_32x32x16_bf16 v[72:87], v[232:235], v[232:235], 0
    s_xor_b32 s49, s48, 0x1000
    s_add_u32 s44, s5, s4
    s_and_b32 s44, s44, 7
    s_mov_b32 s50, 0x3e0293ee
    s_mov_b32 s51, 0x3e0293ee
    s_lshl2_add_u32 s52, s6, s40
    v_mfma_f32_32x32x16_bf16 v[88:103], v[232:235], v[232:235], 0
    s_lshl_b32 s52, s52, 10
    s_add_u32 s52, s52, 33554432
    s_cmp_eq_u32 s44, 0
    s_cselect_b32 s52, s52, 2146435072
    v_lshlrev_b32 v4, 4, v0
    buffer_store_dwordx4 v[232:235], v4, s[24:27], s52 offen sc1
    v_mfma_f32_32x32x16_bf16 v[104:119], v[232:235], v[232:235], 0
    s_lshl_b32 s55, s6, 3
    v_bfe_u32 v1, v0, 2, 2
    v_lshrrev_b32 v2, 4, v0
    v_lshl_add_u32 v2, v2, 3, v1
    v_lshlrev_b32 v2, 7, v2
    v_and_b32 v3, 3, v0
    v_mfma_f32_32x32x16_bf16 v[120:135], v[232:235], v[232:235], 0
    v_lshl_add_u32 v2, v3, 4, v2
    v_lshrrev_b32 v1, 1, v1
    v_lshl_add_u32 v2, v1, 6, v2
    v_add_u32 v248, s61, v2
    v_xor_b32 v249, 64, v248
    v_and_b32 v1, 15, v0
    v_mfma_f32_32x32x16_bf16 v[136:151], v[232:235], v[232:235], 0
    v_lshrrev_b32 v2, 1, v1
    v_lshrrev_b32 v3, 4, v0
    v_xor_b32 v2, v2, v3
    v_lshlrev_b32 v2, 4, v2
    v_lshl_add_u32 v2, v1, 7, v2
    v_add_u32 v252, 65536, v2
    v_mfma_f32_32x32x16_bf16 v[152:167], v[232:235], v[232:235], 0
    v_xor_b32 v253, 64, v252
    s_lshl_b32 s52, s41, 15
    v_and_b32 v2, 7, v0
    v_lshlrev_b32 v2, 1, v2
    v_xor_b32 v2, v2, v3
    v_lshlrev_b32 v2, 4, v2
    v_mfma_f32_32x32x16_bf16 v[168:183], v[232:235], v[232:235], 0
    v_lshl_add_u32 v2, v1, 8, v2
    v_add_u32 v236, s52, v2
    v_xor_b32 v237, 64, v236
    v_xor_b32 v238, 128, v236
    v_xor_b32 v239, 192, v236
    v_lshrrev_b32 v1, 2, v0
    v_mfma_f32_32x32x16_bf16 a[0:15], v[232:235], v[232:235], 0
    v_and_b32 v2, 7, v1
    v_lshlrev_b32 v2, 5, v2
    v_and_b32 v3, 3, v0
    v_lshl_add_u32 v2, v3, 3, v2
    v_lshl_add_u32 v2, v1, 8, v2
    v_add_u32 v240, s52, v2
    v_mfma_f32_32x32x16_bf16 a[16:31], v[232:235], v[232:235], 0
    v_xor_b32 v241, 32, v240
    v_xor_b32 v242, 64, v240
    v_xor_b32 v243, 96, v240
    v_xor_b32 v244, 128, v240
    v_xor_b32 v245, 160, v240
    v_xor_b32 v246, 192, v240
    v_mfma_f32_32x32x16_bf16 a[32:47], v[232:235], v[232:235], 0
    v_xor_b32 v247, 224, v240
    v_lshrrev_b32 v1, 4, v0
    v_and_b32 v2, 15, v0
    v_lshlrev_b32 v3, 1, v1
    v_xor_b32 v3, v3, v2
    v_lshlrev_b32 v3, 4, v3
    v_mfma_f32_32x32x16_bf16 a[48:63], v[232:235], v[232:235], 0
    v_lshl_add_u32 v5, v1, 8, v3
    v_xor_b32 v6, 0x80, v5
    v_mfma_f32_32x32x16_bf16 a[64:79], v[232:235], v[232:235], 0
    v_mfma_f32_32x32x16_bf16 a[80:95], v[232:235], v[232:235], 0
    s_add_u32 m0, s62, 4096
    s_add_u32 s58, s58, 68608
    buffer_load_dwordx4 v254, s[16:19], s58 offen offset:0 lds
    s_add_u32 s58, s58, 64512
    buffer_load_dwordx4 v254, s[16:19], s58 offen offset:1024 lds
    s_add_u32 s58, s58, 64512
    buffer_load_dwordx4 v254, s[16:19], s58 offen offset:2048 lds
    s_add_u32 s58, s58, 64512
    buffer_load_dwordx4 v254, s[16:19], s58 offen offset:3072 lds
    s_add_u32 s62, s62, 8192
    s_cmp_eq_u32 s62, s64
    s_cselect_b32 s62, s63, s62
    s_add_u32 m0, s96, s65
    s_xor_b32 s57, s45, 1
    s_lshl_b32 s57, s57, 7
    buffer_load_dwordx4 v255, s[28:31], s57 offen lds
    s_addk_i32 m0, 4096
    s_add_u32 s57, s57, 32768
    buffer_load_dwordx4 v255, s[28:31], s57 offen lds
    s_addk_i32 m0, 4096
    s_add_u32 s57, s57, 32768
    buffer_load_dwordx4 v255, s[28:31], s57 offen lds
    s_addk_i32 m0, 4096
    s_add_u32 s57, s57, 32768
    buffer_load_dwordx4 v255, s[28:31], s57 offen lds
    s_addk_i32 s65, 16384
    s_mov_b32 m0, s62
    s_xor_b32 s58, s45, 1
    s_lshl_b32 s58, s58, 19
    buffer_load_dwordx4 v254, s[16:19], s58 offen offset:0 lds
    s_add_u32 s58, s58, 64512
    buffer_load_dwordx4 v254, s[16:19], s58 offen offset:1024 lds
    s_mov_b32 s66, 16384
    s_mov_b32 s67, 0
    s_mov_b32 s59, 2
    s_waitcnt vmcnt(6)
    s_barrier
    ds_read_b128 v[176:179], v252 offset:0
    ds_read_b128 v[180:183], v252 offset:2048
    ds_read_b128 v[184:187], v252 offset:4096
    ds_read_b128 v[188:191], v252 offset:6144
    ds_read_b128 v[192:195], v252 offset:8192
    ds_read_b128 v[196:199], v252 offset:10240
    ds_read_b128 v[200:203], v252 offset:12288
    ds_read_b64_tr_b16 a[84:85], v248 offset:0
    ds_read_b64_tr_b16 a[86:87], v248 offset:512
    ds_read_b64_tr_b16 a[88:89], v248 offset:8
    ds_read_b64_tr_b16 a[90:91], v248 offset:520
    v_add_u32 v252, 16384, v252
    s_add_u32 s58, s58, 64512
    buffer_load_dwordx4 v254, s[16:19], s58 offen offset:2048 lds
    s_add_u32 s58, s58, 64512
    buffer_load_dwordx4 v254, s[16:19], s58 offen offset:3072 lds
    s_add_u32 m0, s62, 4096
    s_add_u32 s58, s58, 68608
    buffer_load_dwordx4 v254, s[16:19], s58 offen offset:0 lds
    s_add_u32 s58, s58, 64512
    buffer_load_dwordx4 v254, s[16:19], s58 offen offset:1024 lds
    s_add_u32 s58, s58, 64512
    buffer_load_dwordx4 v254, s[16:19], s58 offen offset:2048 lds
    s_add_u32 s58, s58, 64512
    buffer_load_dwordx4 v254, s[16:19], s58 offen offset:3072 lds
    s_add_u32 s62, s62, 8192
    s_cmp_eq_u32 s62, s64
    s_cselect_b32 s62, s63, s62
L_a1:
    s_waitcnt lgkmcnt(2)
    v_mfma_f32_16x16x32_bf16 v[8:11], a[84:87], v[176:179], v[8:11]
    ds_read_b64_tr_b16 a[92:93], v249 offset:0
    ds_read_b64_tr_b16 a[94:95], v249 offset:512
    v_mfma_f32_16x16x32_bf16 v[24:27], a[84:87], v[180:183], v[24:27]
    ds_read_b128 v[204:207], v253 offset:0
    v_mfma_f32_16x16x32_bf16 v[40:43], a[84:87], v[184:187], v[40:43]
    s_add_u32 m0, s96, s65
    s_xor_b32 s57, s45, s59
    s_lshl_b32 s57, s57, 7
    v_mfma_f32_16x16x32_bf16 v[56:59], a[84:87], v[188:191], v[56:59]
    buffer_load_dwordx4 v255, s[28:31], s57 offen lds
    v_mfma_f32_16x16x32_bf16 v[72:75], a[84:87], v[192:195], v[72:75]
    ds_read_b128 v[208:211], v253 offset:2048
    v_mfma_f32_16x16x32_bf16 v[88:91], a[84:87], v[196:199], v[88:91]
    ds_read_b128 v[212:215], v253 offset:4096
    v_mfma_f32_16x16x32_bf16 v[104:107], a[84:87], v[200:203], v[104:107]
    s_addk_i32 m0, 4096
    s_add_u32 s57, s57, 32768
    s_waitcnt lgkmcnt(5)
    v_mfma_f32_16x16x32_bf16 v[12:15], a[88:91], v[176:179], v[12:15]
    buffer_load_dwordx4 v255, s[28:31], s57 offen lds
    v_mfma_f32_16x16x32_bf16 v[28:31], a[88:91], v[180:183], v[28:31]
    ds_read_b64_tr_b16 a[96:97], v249 offset:8
    ds_read_b64_tr_b16 a[98:99], v249 offset:520
    v_mfma_f32_16x16x32_bf16 v[44:47], a[88:91], v[184:187], v[44:47]
    ds_read_b128 v[216:219], v253 offset:6144
    ds_read_b128 v[220:223], v253 offset:8192
    v_mfma_f32_16x16x32_bf16 v[60:63], a[88:91], v[188:191], v[60:63]
    s_addk_i32 m0, 4096
    s_add_u32 s57, s57, 32768
    v_mfma_f32_16x16x32_bf16 v[76:79], a[88:91], v[192:195], v[76:79]
    buffer_load_dwordx4 v255, s[28:31], s57 offen lds
    v_mfma_f32_16x16x32_bf16 v[92:95], a[88:91], v[196:199], v[92:95]
    ds_read_b128 v[224:227], v253 offset:10240
    v_mfma_f32_16x16x32_bf16 v[108:111], a[88:91], v[200:203], v[108:111]
    ds_read_b128 v[228:231], v253 offset:12288
    s_waitcnt lgkmcnt(9)
    v_mfma_f32_16x16x32_bf16 v[16:19], a[92:95], v[176:179], v[16:19]
    ds_read_b64_tr_b16 a[84:85], v248 offset:4096
    ds_read_b64_tr_b16 a[86:87], v248 offset:4608
    v_mfma_f32_16x16x32_bf16 v[32:35], a[92:95], v[180:183], v[32:35]
    s_addk_i32 m0, 4096
    s_add_u32 s57, s57, 32768
    v_mfma_f32_16x16x32_bf16 v[48:51], a[92:95], v[184:187], v[48:51]
    buffer_load_dwordx4 v255, s[28:31], s57 offen lds
    v_mfma_f32_16x16x32_bf16 v[64:67], a[92:95], v[188:191], v[64:67]
    s_addk_i32 s65, 16384
    s_cmp_eq_u32 s65, 49152
    s_cselect_b32 s65, 0, s65
    v_mfma_f32_16x16x32_bf16 v[80:83], a[92:95], v[192:195], v[80:83]
    s_mov_b32 s53, s67
    s_addk_i32 s67, 16384
    s_cmp_eq_u32 s67, 49152
    v_mfma_f32_16x16x32_bf16 v[96:99], a[92:95], v[196:199], v[96:99]
    s_cselect_b32 s67, 0, s67
    s_sub_u32 s53, s67, s53
    v_add_u32 v253, s53, v253
    v_mfma_f32_16x16x32_bf16 v[112:115], a[92:95], v[200:203], v[112:115]
    s_mov_b32 m0, s62
    s_xor_b32 s58, s45, s59
    s_waitcnt lgkmcnt(6)
    v_mfma_f32_16x16x32_bf16 v[20:23], a[96:99], v[176:179], v[20:23]
    s_lshl_b32 s58, s58, 19
    v_mfma_f32_16x16x32_bf16 v[36:39], a[96:99], v[180:183], v[36:39]
    buffer_load_dwordx4 v254, s[16:19], s58 offen offset:0 lds
    v_mfma_f32_16x16x32_bf16 v[52:55], a[96:99], v[184:187], v[52:55]
    ds_read_b64_tr_b16 a[88:89], v248 offset:4104
    ds_read_b64_tr_b16 a[90:91], v248 offset:4616
    v_mfma_f32_16x16x32_bf16 v[68:71], a[96:99], v[188:191], v[68:71]
    s_add_u32 s58, s58, 64512
    v_mfma_f32_16x16x32_bf16 v[84:87], a[96:99], v[192:195], v[84:87]
    buffer_load_dwordx4 v254, s[16:19], s58 offen offset:1024 lds
    v_mfma_f32_16x16x32_bf16 v[100:103], a[96:99], v[196:199], v[100:103]
    v_mfma_f32_16x16x32_bf16 v[116:119], a[96:99], v[200:203], v[116:119]
    s_add_u32 s58, s58, 64512
    s_waitcnt lgkmcnt(2)
    v_mfma_f32_16x16x32_bf16 v[8:11], a[84:87], v[204:207], v[8:11]
    buffer_load_dwordx4 v254, s[16:19], s58 offen offset:2048 lds
    v_mfma_f32_16x16x32_bf16 v[24:27], a[84:87], v[208:211], v[24:27]
    ds_read_b64_tr_b16 a[92:93], v249 offset:4096
    ds_read_b64_tr_b16 a[94:95], v249 offset:4608
    v_mfma_f32_16x16x32_bf16 v[40:43], a[84:87], v[212:215], v[40:43]
    s_waitcnt vmcnt(15)
    s_barrier
    ds_read_b128 v[176:179], v252 offset:0
    v_mfma_f32_16x16x32_bf16 v[56:59], a[84:87], v[216:219], v[56:59]
    ds_read_b128 v[180:183], v252 offset:2048
    s_add_u32 s58, s58, 64512
    v_mfma_f32_16x16x32_bf16 v[72:75], a[84:87], v[220:223], v[72:75]
    buffer_load_dwordx4 v254, s[16:19], s58 offen offset:3072 lds
    v_mfma_f32_16x16x32_bf16 v[88:91], a[84:87], v[224:227], v[88:91]
    ds_read_b128 v[184:187], v252 offset:4096
    ds_read_b128 v[188:191], v252 offset:6144
    v_mfma_f32_16x16x32_bf16 v[104:107], a[84:87], v[228:231], v[104:107]
    s_waitcnt lgkmcnt(6)
    v_mfma_f32_16x16x32_bf16 v[12:15], a[88:91], v[204:207], v[12:15]
    ds_read_b64_tr_b16 a[96:97], v249 offset:4104
    ds_read_b64_tr_b16 a[98:99], v249 offset:4616
    v_mfma_f32_16x16x32_bf16 v[28:31], a[88:91], v[208:211], v[28:31]
    ds_read_b128 v[192:195], v252 offset:8192
    s_add_u32 m0, s62, 4096
    v_mfma_f32_16x16x32_bf16 v[44:47], a[88:91], v[212:215], v[44:47]
    s_add_u32 s58, s58, 68608
    v_mfma_f32_16x16x32_bf16 v[60:63], a[88:91], v[216:219], v[60:63]
    buffer_load_dwordx4 v254, s[16:19], s58 offen offset:0 lds
    v_mfma_f32_16x16x32_bf16 v[76:79], a[88:91], v[220:223], v[76:79]
    ds_read_b128 v[196:199], v252 offset:10240
    ds_read_b128 v[200:203], v252 offset:12288
    v_mfma_f32_16x16x32_bf16 v[92:95], a[88:91], v[224:227], v[92:95]
    s_add_u32 s58, s58, 64512
    v_mfma_f32_16x16x32_bf16 v[108:111], a[88:91], v[228:231], v[108:111]
    s_waitcnt lgkmcnt(9)
    v_mfma_f32_16x16x32_bf16 v[16:19], a[92:95], v[204:207], v[16:19]
    buffer_load_dwordx4 v254, s[16:19], s58 offen offset:1024 lds
    v_mfma_f32_16x16x32_bf16 v[32:35], a[92:95], v[208:211], v[32:35]
    s_mov_b32 s53, s61
    s_addk_i32 s61, 8192
    s_cmp_eq_u32 s61, s64
    v_mfma_f32_16x16x32_bf16 v[48:51], a[92:95], v[212:215], v[48:51]
    s_cselect_b32 s61, s63, s61
    s_sub_u32 s53, s61, s53
    v_add_u32 v248, s53, v248
    v_mfma_f32_16x16x32_bf16 v[64:67], a[92:95], v[216:219], v[64:67]
    v_add_u32 v249, s53, v249
    s_waitcnt vmcnt(10)
    v_mfma_f32_16x16x32_bf16 v[80:83], a[92:95], v[220:223], v[80:83]
    ds_read_b64_tr_b16 a[84:85], v248 offset:0
    ds_read_b64_tr_b16 a[86:87], v248 offset:512
    v_mfma_f32_16x16x32_bf16 v[96:99], a[92:95], v[224:227], v[96:99]
    s_add_u32 s58, s58, 64512
    v_mfma_f32_16x16x32_bf16 v[112:115], a[92:95], v[228:231], v[112:115]
    buffer_load_dwordx4 v254, s[16:19], s58 offen offset:2048 lds
    s_waitcnt lgkmcnt(5)
    v_mfma_f32_16x16x32_bf16 v[20:23], a[96:99], v[204:207], v[20:23]
    s_mov_b32 s53, s66
    s_addk_i32 s66, 16384
    s_cmp_eq_u32 s66, 49152
    v_mfma_f32_16x16x32_bf16 v[36:39], a[96:99], v[208:211], v[36:39]
    s_cselect_b32 s66, 0, s66
    s_sub_u32 s53, s66, s53
    v_add_u32 v252, s53, v252
    v_mfma_f32_16x16x32_bf16 v[52:55], a[96:99], v[212:215], v[52:55]
    s_add_u32 s58, s58, 64512
    v_mfma_f32_16x16x32_bf16 v[68:71], a[96:99], v[216:219], v[68:71]
    buffer_load_dwordx4 v254, s[16:19], s58 offen offset:3072 lds
    s_add_u32 s62, s62, 8192
    s_cmp_eq_u32 s62, s64
    s_cselect_b32 s62, s63, s62
    v_mfma_f32_16x16x32_bf16 v[84:87], a[96:99], v[220:223], v[84:87]
    ds_read_b64_tr_b16 a[88:89], v248 offset:8
    ds_read_b64_tr_b16 a[90:91], v248 offset:520
    v_mfma_f32_16x16x32_bf16 v[100:103], a[96:99], v[224:227], v[100:103]
    s_add_u32 s59, s59, 1
    s_cmp_lt_u32 s59, 8
    v_mfma_f32_16x16x32_bf16 v[116:119], a[96:99], v[228:231], v[116:119]
    s_cbranch_scc1 L_a1
    s_waitcnt lgkmcnt(2)
    v_mfma_f32_16x16x32_bf16 v[8:11], a[84:87], v[176:179], v[8:11]
    ds_read_b64_tr_b16 a[92:93], v249 offset:0
    ds_read_b64_tr_b16 a[94:95], v249 offset:512
    v_mfma_f32_16x16x32_bf16 v[24:27], a[84:87], v[180:183], v[24:27]
    ds_read_b128 v[204:207], v253 offset:0
    v_mfma_f32_16x16x32_bf16 v[40:43], a[84:87], v[184:187], v[40:43]
    s_lshl2_add_u32 s52, s44, s40
    v_mov_b32 v1, 2147418112
    v_lshl_add_u32 v2, v0, 5, s52
    v_mfma_f32_16x16x32_bf16 v[56:59], a[84:87], v[188:191], v[56:59]
    v_cmp_eq_u32 vcc, 0, v2
    v_mov_b32 v3, 1
    v_mfma_f32_16x16x32_bf16 v[72:75], a[84:87], v[192:195], v[72:75]
    s_nop 0
    v_cndmask_b32 v1, v1, v2, vcc
    v_mfma_f32_16x16x32_bf16 v[88:91], a[84:87], v[196:199], v[88:91]
    buffer_store_dword v3, v1, s[36:39], s55 offen sc1
    v_mfma_f32_16x16x32_bf16 v[104:107], a[84:87], v[200:203], v[104:107]
    ds_read_b128 v[208:211], v253 offset:2048
    s_waitcnt lgkmcnt(4)
    v_mfma_f32_16x16x32_bf16 v[12:15], a[88:91], v[176:179], v[12:15]
    ds_read_b128 v[212:215], v253 offset:4096
    ds_read_b64_tr_b16 a[96:97], v249 offset:8
    v_mfma_f32_16x16x32_bf16 v[28:31], a[88:91], v[180:183], v[28:31]
    ds_read_b64_tr_b16 a[98:99], v249 offset:520
    ds_read_b128 v[216:219], v253 offset:6144
    v_mfma_f32_16x16x32_bf16 v[44:47], a[88:91], v[184:187], v[44:47]
    ds_read_b128 v[220:223], v253 offset:8192
    v_mfma_f32_16x16x32_bf16 v[60:63], a[88:91], v[188:191], v[60:63]
    v_mfma_f32_16x16x32_bf16 v[76:79], a[88:91], v[192:195], v[76:79]
    ds_read_b128 v[224:227], v253 offset:10240
    v_mfma_f32_16x16x32_bf16 v[92:95], a[88:91], v[196:199], v[92:95]
    s_cmp_eq_u32 s42, 0
    s_cselect_b32 s52, s48, s49
    s_add_u32 m0, s52, 0
    v_mfma_f32_16x16x32_bf16 v[108:111], a[88:91], v[200:203], v[108:111]
    s_lshl_b32 s56, s42, 12
    s_xor_b32 s56, s56, s46
    s_waitcnt lgkmcnt(8)
    v_mfma_f32_16x16x32_bf16 v[16:19], a[92:95], v[176:179], v[16:19]
    buffer_load_dwordx4 v5, s[8:11], s56 offen offset:0 nt lds
    v_mfma_f32_16x16x32_bf16 v[32:35], a[92:95], v[180:183], v[32:35]
    ds_read_b128 v[228:231], v253 offset:12288
    ds_read_b64_tr_b16 a[84:85], v248 offset:4096
    v_mfma_f32_16x16x32_bf16 v[48:51], a[92:95], v[184:187], v[48:51]
    ds_read_b64_tr_b16 a[86:87], v248 offset:4608
    v_mfma_f32_16x16x32_bf16 v[64:67], a[92:95], v[188:191], v[64:67]
    v_mfma_f32_16x16x32_bf16 v[80:83], a[92:95], v[192:195], v[80:83]
    s_mov_b32 s53, s67
    s_addk_i32 s67, 16384
    s_cmp_eq_u32 s67, 49152
    v_mfma_f32_16x16x32_bf16 v[96:99], a[92:95], v[196:199], v[96:99]
    s_cselect_b32 s67, 0, s67
    s_sub_u32 s53, s67, s53
    v_add_u32 v253, s53, v253
    v_mfma_f32_16x16x32_bf16 v[112:115], a[92:95], v[200:203], v[112:115]
    s_waitcnt lgkmcnt(6)
    v_mfma_f32_16x16x32_bf16 v[20:23], a[96:99], v[176:179], v[20:23]
    ds_read_b64_tr_b16 a[88:89], v248 offset:4104
    ds_read_b64_tr_b16 a[90:91], v248 offset:4616
    v_mfma_f32_16x16x32_bf16 v[36:39], a[96:99], v[180:183], v[36:39]
    buffer_load_dwordx4 v6, s[8:11], s56 offen offset:1024 nt lds
    v_mfma_f32_16x16x32_bf16 v[52:55], a[96:99], v[184:187], v[52:55]
    v_mfma_f32_16x16x32_bf16 v[68:71], a[96:99], v[188:191], v[68:71]
    v_mfma_f32_16x16x32_bf16 v[84:87], a[96:99], v[192:195], v[84:87]
    v_mfma_f32_16x16x32_bf16 v[100:103], a[96:99], v[196:199], v[100:103]
    v_mfma_f32_16x16x32_bf16 v[116:119], a[96:99], v[200:203], v[116:119]
    s_waitcnt lgkmcnt(2)
    v_mfma_f32_16x16x32_bf16 v[8:11], a[84:87], v[204:207], v[8:11]
    ds_read_b64_tr_b16 a[92:93], v249 offset:4096
    ds_read_b64_tr_b16 a[94:95], v249 offset:4608
    v_mfma_f32_16x16x32_bf16 v[24:27], a[84:87], v[208:211], v[24:27]
    s_waitcnt vmcnt(11)
    s_barrier
    ds_read_b128 v[176:179], v252 offset:0
    v_mfma_f32_16x16x32_bf16 v[40:43], a[84:87], v[212:215], v[40:43]
    ds_read_b128 v[180:183], v252 offset:2048
    v_mfma_f32_16x16x32_bf16 v[56:59], a[84:87], v[216:219], v[56:59]
    v_mfma_f32_16x16x32_bf16 v[72:75], a[84:87], v[220:223], v[72:75]
    ds_read_b128 v[184:187], v252 offset:4096
    v_mfma_f32_16x16x32_bf16 v[88:91], a[84:87], v[224:227], v[88:91]
    buffer_load_dwordx4 v5, s[8:11], s56 offen offset:2048 nt lds
    v_mfma_f32_16x16x32_bf16 v[104:107], a[84:87], v[228:231], v[104:107]
    ds_read_b128 v[188:191], v252 offset:6144
    s_waitcnt lgkmcnt(6)
    v_mfma_f32_16x16x32_bf16 v[12:15], a[88:91], v[204:207], v[12:15]
    ds_read_b64_tr_b16 a[96:97], v249 offset:4104
    ds_read_b64_tr_b16 a[98:99], v249 offset:4616
    v_mfma_f32_16x16x32_bf16 v[28:31], a[88:91], v[208:211], v[28:31]
    ds_read_b128 v[192:195], v252 offset:8192
    ds_read_b128 v[196:199], v252 offset:10240
    v_mfma_f32_16x16x32_bf16 v[44:47], a[88:91], v[212:215], v[44:47]
    v_mfma_f32_16x16x32_bf16 v[60:63], a[88:91], v[216:219], v[60:63]
    ds_read_b128 v[200:203], v252 offset:12288
    v_mfma_f32_16x16x32_bf16 v[76:79], a[88:91], v[220:223], v[76:79]
    v_mfma_f32_16x16x32_bf16 v[92:95], a[88:91], v[224:227], v[92:95]
    s_mov_b32 s53, s61
    s_addk_i32 s61, 8192
    s_cmp_eq_u32 s61, s64
    v_mfma_f32_16x16x32_bf16 v[108:111], a[88:91], v[228:231], v[108:111]
    s_cselect_b32 s61, s63, s61
    s_sub_u32 s53, s61, s53
    s_waitcnt lgkmcnt(9)
    v_mfma_f32_16x16x32_bf16 v[16:19], a[92:95], v[204:207], v[16:19]
    v_add_u32 v248, s53, v248
    v_add_u32 v249, s53, v249
    v_mfma_f32_16x16x32_bf16 v[32:35], a[92:95], v[208:211], v[32:35]
    s_waitcnt vmcnt(4)
    ds_read_b64_tr_b16 a[84:85], v248 offset:0
    ds_read_b64_tr_b16 a[86:87], v248 offset:512
    v_mfma_f32_16x16x32_bf16 v[48:51], a[92:95], v[212:215], v[48:51]
    buffer_load_dwordx4 v6, s[8:11], s56 offen offset:3072 nt lds
    v_mfma_f32_16x16x32_bf16 v[64:67], a[92:95], v[216:219], v[64:67]
    s_mov_b32 s53, s66
    s_addk_i32 s66, 16384
    s_cmp_eq_u32 s66, 49152
    v_mfma_f32_16x16x32_bf16 v[80:83], a[92:95], v[220:223], v[80:83]
    s_cselect_b32 s66, 0, s66
    s_sub_u32 s53, s66, s53
    v_add_u32 v252, s53, v252
    v_mfma_f32_16x16x32_bf16 v[96:99], a[92:95], v[224:227], v[96:99]
    v_mfma_f32_16x16x32_bf16 v[112:115], a[92:95], v[228:231], v[112:115]
    s_waitcnt lgkmcnt(5)
    v_mfma_f32_16x16x32_bf16 v[20:23], a[96:99], v[204:207], v[20:23]
    ds_read_b64_tr_b16 a[88:89], v248 offset:8
    ds_read_b64_tr_b16 a[90:91], v248 offset:520
    v_mfma_f32_16x16x32_bf16 v[36:39], a[96:99], v[208:211], v[36:39]
    v_mfma_f32_16x16x32_bf16 v[52:55], a[96:99], v[212:215], v[52:55]
    v_mfma_f32_16x16x32_bf16 v[68:71], a[96:99], v[216:219], v[68:71]
    v_mfma_f32_16x16x32_bf16 v[84:87], a[96:99], v[220:223], v[84:87]
    v_mfma_f32_16x16x32_bf16 v[100:103], a[96:99], v[224:227], v[100:103]
    v_mfma_f32_16x16x32_bf16 v[116:119], a[96:99], v[228:231], v[116:119]
    s_cmp_eq_u32 s42, 1
    s_cbranch_scc1 L_y
    s_waitcnt lgkmcnt(2)
    v_mfma_f32_16x16x32_bf16 v[8:11], a[84:87], v[176:179], v[8:11]
    ds_read_b64_tr_b16 a[92:93], v249 offset:0
    ds_read_b64_tr_b16 a[94:95], v249 offset:512
    v_mfma_f32_16x16x32_bf16 v[24:27], a[84:87], v[180:183], v[24:27]
    ds_read_b128 v[204:207], v253 offset:0
    v_mfma_f32_16x16x32_bf16 v[40:43], a[84:87], v[184:187], v[40:43]
    s_cmp_eq_u32 s42, 0
    s_cselect_b32 s52, s48, s49
    s_add_u32 m0, s52, 8192
    v_mfma_f32_16x16x32_bf16 v[56:59], a[84:87], v[188:191], v[56:59]
    s_lshl_b32 s56, s42, 12
    s_xor_b32 s56, s56, s46
    v_mfma_f32_16x16x32_bf16 v[72:75], a[84:87], v[192:195], v[72:75]
    buffer_load_dwordx4 v5, s[12:15], s56 offen offset:0 nt lds
    v_mfma_f32_16x16x32_bf16 v[88:91], a[84:87], v[196:199], v[88:91]
    ds_read_b128 v[208:211], v253 offset:2048
    ds_read_b128 v[212:215], v253 offset:4096
    v_mfma_f32_16x16x32_bf16 v[104:107], a[84:87], v[200:203], v[104:107]
    s_waitcnt lgkmcnt(5)
    v_mfma_f32_16x16x32_bf16 v[12:15], a[88:91], v[176:179], v[12:15]
    ds_read_b64_tr_b16 a[96:97], v249 offset:8
    ds_read_b64_tr_b16 a[98:99], v249 offset:520
    v_mfma_f32_16x16x32_bf16 v[28:31], a[88:91], v[180:183], v[28:31]
    ds_read_b128 v[216:219], v253 offset:6144
    v_mfma_f32_16x16x32_bf16 v[44:47], a[88:91], v[184:187], v[44:47]
    ds_read_b128 v[220:223], v253 offset:8192
    v_mfma_f32_16x16x32_bf16 v[60:63], a[88:91], v[188:191], v[60:63]
    v_mfma_f32_16x16x32_bf16 v[76:79], a[88:91], v[192:195], v[76:79]
    ds_read_b128 v[224:227], v253 offset:10240
    v_mfma_f32_16x16x32_bf16 v[92:95], a[88:91], v[196:199], v[92:95]
    buffer_load_dwordx4 v6, s[12:15], s56 offen offset:1024 nt lds
    v_mfma_f32_16x16x32_bf16 v[108:111], a[88:91], v[200:203], v[108:111]
    ds_read_b128 v[228:231], v253 offset:12288
    s_waitcnt lgkmcnt(9)
    v_mfma_f32_16x16x32_bf16 v[16:19], a[92:95], v[176:179], v[16:19]
    ds_read_b64_tr_b16 a[84:85], v248 offset:4096
    ds_read_b64_tr_b16 a[86:87], v248 offset:4608
    v_mfma_f32_16x16x32_bf16 v[32:35], a[92:95], v[180:183], v[32:35]
    v_mfma_f32_16x16x32_bf16 v[48:51], a[92:95], v[184:187], v[48:51]
    v_mfma_f32_16x16x32_bf16 v[64:67], a[92:95], v[188:191], v[64:67]
    v_mfma_f32_16x16x32_bf16 v[80:83], a[92:95], v[192:195], v[80:83]
    v_mfma_f32_16x16x32_bf16 v[96:99], a[92:95], v[196:199], v[96:99]
    v_mfma_f32_16x16x32_bf16 v[112:115], a[92:95], v[200:203], v[112:115]
    s_waitcnt lgkmcnt(6)
    v_mfma_f32_16x16x32_bf16 v[20:23], a[96:99], v[176:179], v[20:23]
    ds_read_b64_tr_b16 a[88:89], v248 offset:4104
    ds_read_b64_tr_b16 a[90:91], v248 offset:4616
    v_mfma_f32_16x16x32_bf16 v[36:39], a[96:99], v[180:183], v[36:39]
    buffer_load_dwordx4 v5, s[12:15], s56 offen offset:2048 nt lds
    v_mfma_f32_16x16x32_bf16 v[52:55], a[96:99], v[184:187], v[52:55]
    v_mfma_f32_16x16x32_bf16 v[68:71], a[96:99], v[188:191], v[68:71]
    v_mfma_f32_16x16x32_bf16 v[84:87], a[96:99], v[192:195], v[84:87]
    v_mfma_f32_16x16x32_bf16 v[100:103], a[96:99], v[196:199], v[100:103]
    v_mfma_f32_16x16x32_bf16 v[116:119], a[96:99], v[200:203], v[116:119]
    s_waitcnt lgkmcnt(2)
    v_mfma_f32_16x16x32_bf16 v[8:11], a[84:87], v[204:207], v[8:11]
    ds_read_b64_tr_b16 a[92:93], v249 offset:4096
    ds_read_b64_tr_b16 a[94:95], v249 offset:4608
    v_mfma_f32_16x16x32_bf16 v[24:27], a[84:87], v[208:211], v[24:27]
    v_mfma_f32_16x16x32_bf16 v[40:43], a[84:87], v[212:215], v[40:43]
    v_mfma_f32_16x16x32_bf16 v[56:59], a[84:87], v[216:219], v[56:59]
    v_mfma_f32_16x16x32_bf16 v[72:75], a[84:87], v[220:223], v[72:75]
    buffer_load_dwordx4 v6, s[12:15], s56 offen offset:3072 nt lds
    v_mfma_f32_16x16x32_bf16 v[88:91], a[84:87], v[224:227], v[88:91]
    v_mfma_f32_16x16x32_bf16 v[104:107], a[84:87], v[228:231], v[104:107]
    s_waitcnt lgkmcnt(2)
    v_mfma_f32_16x16x32_bf16 v[12:15], a[88:91], v[204:207], v[12:15]
    ds_read_b64_tr_b16 a[96:97], v249 offset:4104
    ds_read_b64_tr_b16 a[98:99], v249 offset:4616
    v_mfma_f32_16x16x32_bf16 v[28:31], a[88:91], v[208:211], v[28:31]
    v_mfma_f32_16x16x32_bf16 v[44:47], a[88:91], v[212:215], v[44:47]
    v_mfma_f32_16x16x32_bf16 v[60:63], a[88:91], v[216:219], v[60:63]
    v_mfma_f32_16x16x32_bf16 v[76:79], a[88:91], v[220:223], v[76:79]
    v_mfma_f32_16x16x32_bf16 v[92:95], a[88:91], v[224:227], v[92:95]
    v_mfma_f32_16x16x32_bf16 v[108:111], a[88:91], v[228:231], v[108:111]
    s_waitcnt lgkmcnt(2)
    v_mfma_f32_16x16x32_bf16 v[16:19], a[92:95], v[204:207], v[16:19]
    s_mul_i32 s52, s41, 24576
    s_add_u32 s52, s52, 131072
    v_add_u32 v1, s52, v4
    v_mfma_f32_16x16x32_bf16 v[32:35], a[92:95], v[208:211], v[32:35]
    s_lshl_b32 s52, s41, 13
    s_add_u32 s52, s52, 90112
    v_add_u32 v3, s52, v4
    v_mfma_f32_16x16x32_bf16 v[48:51], a[92:95], v[212:215], v[48:51]
    v_mfma_f32_16x16x32_bf16 v[64:67], a[92:95], v[216:219], v[64:67]
    v_mfma_f32_16x16x32_bf16 v[80:83], a[92:95], v[220:223], v[80:83]
    v_mfma_f32_16x16x32_bf16 v[96:99], a[92:95], v[224:227], v[96:99]
    v_mfma_f32_16x16x32_bf16 v[112:115], a[92:95], v[228:231], v[112:115]
    s_waitcnt lgkmcnt(0)
    v_mfma_f32_16x16x32_bf16 v[20:23], a[96:99], v[204:207], v[20:23]
    v_mfma_f32_16x16x32_bf16 v[36:39], a[96:99], v[208:211], v[36:39]
    v_mfma_f32_16x16x32_bf16 v[52:55], a[96:99], v[212:215], v[52:55]
    v_mfma_f32_16x16x32_bf16 v[68:71], a[96:99], v[216:219], v[68:71]
    v_mfma_f32_16x16x32_bf16 v[84:87], a[96:99], v[220:223], v[84:87]
    v_mfma_f32_16x16x32_bf16 v[100:103], a[96:99], v[224:227], v[100:103]
    v_mfma_f32_16x16x32_bf16 v[116:119], a[96:99], v[228:231], v[116:119]
    s_add_u32 m0, s48, 16384
    s_xor_b32 s56, s46, 8192
    buffer_load_dwordx4 v5, s[8:11], s56 offen offset:0 nt lds
    .p2align 3
    v_pk_mul_f32 v[8:9], v[8:9], s[50:51]
    v_pk_mul_f32 v[10:11], v[10:11], s[50:51]
    v_pk_mul_f32 v[12:13], v[12:13], s[50:51]
    v_pk_mul_f32 v[14:15], v[14:15], s[50:51]
    v_cvt_pk_bf16_f32 v8, v8, v9
    v_cvt_pk_bf16_f32 v9, v10, v11
    v_cvt_pk_bf16_f32 v10, v12, v13
    v_cvt_pk_bf16_f32 v11, v14, v15
    v_accvgpr_write_b32 a144, v8
    v_accvgpr_write_b32 a145, v9
    v_accvgpr_write_b32 a146, v10
    v_accvgpr_write_b32 a147, v11
    buffer_load_dwordx4 v6, s[8:11], s56 offen offset:1024 nt lds
    .p2align 3
    v_pk_mul_f32 v[16:17], v[16:17], s[50:51]
    v_pk_mul_f32 v[18:19], v[18:19], s[50:51]
    v_pk_mul_f32 v[20:21], v[20:21], s[50:51]
    v_pk_mul_f32 v[22:23], v[22:23], s[50:51]
    v_cvt_pk_bf16_f32 v16, v16, v17
    v_cvt_pk_bf16_f32 v17, v18, v19
    v_cvt_pk_bf16_f32 v18, v20, v21
    v_cvt_pk_bf16_f32 v19, v22, v23
    v_accvgpr_write_b32 a148, v16
    v_accvgpr_write_b32 a149, v17
    v_accvgpr_write_b32 a150, v18
    v_accvgpr_write_b32 a151, v19
    .p2align 3
    v_pk_mul_f32 v[24:25], v[24:25], s[50:51]
    v_pk_mul_f32 v[26:27], v[26:27], s[50:51]
    v_pk_mul_f32 v[28:29], v[28:29], s[50:51]
    v_pk_mul_f32 v[30:31], v[30:31], s[50:51]
    v_mfma_f32_32x32x16_bf16 v[8:23], v[232:235], v[232:235], 0
    v_cvt_pk_bf16_f32 v24, v24, v25
    v_cvt_pk_bf16_f32 v25, v26, v27
    v_cvt_pk_bf16_f32 v26, v28, v29
    v_cvt_pk_bf16_f32 v27, v30, v31
    v_accvgpr_write_b32 a160, v24
    v_accvgpr_write_b32 a161, v25
    v_accvgpr_write_b32 a162, v26
    v_accvgpr_write_b32 a163, v27
    buffer_load_dwordx4 v5, s[8:11], s56 offen offset:2048 nt lds
    .p2align 3
    v_pk_mul_f32 v[32:33], v[32:33], s[50:51]
    v_pk_mul_f32 v[34:35], v[34:35], s[50:51]
    v_pk_mul_f32 v[36:37], v[36:37], s[50:51]
    v_pk_mul_f32 v[38:39], v[38:39], s[50:51]
    v_cvt_pk_bf16_f32 v32, v32, v33
    v_cvt_pk_bf16_f32 v33, v34, v35
    v_cvt_pk_bf16_f32 v34, v36, v37
    v_cvt_pk_bf16_f32 v35, v38, v39
    v_accvgpr_write_b32 a164, v32
    v_accvgpr_write_b32 a165, v33
    v_accvgpr_write_b32 a166, v34
    v_accvgpr_write_b32 a167, v35
    .p2align 3
    v_pk_mul_f32 v[40:41], v[40:41], s[50:51]
    v_pk_mul_f32 v[42:43], v[42:43], s[50:51]
    v_pk_mul_f32 v[44:45], v[44:45], s[50:51]
    v_pk_mul_f32 v[46:47], v[46:47], s[50:51]
    v_mfma_f32_32x32x16_bf16 v[24:39], v[232:235], v[232:235], 0
    v_cvt_pk_bf16_f32 v40, v40, v41
    v_cvt_pk_bf16_f32 v41, v42, v43
    v_cvt_pk_bf16_f32 v42, v44, v45
    v_cvt_pk_bf16_f32 v43, v46, v47
    v_accvgpr_write_b32 a176, v40
    v_accvgpr_write_b32 a177, v41
    v_accvgpr_write_b32 a178, v42
    v_accvgpr_write_b32 a179, v43
    buffer_load_dwordx4 v6, s[8:11], s56 offen offset:3072 nt lds
    .p2align 3
    v_pk_mul_f32 v[48:49], v[48:49], s[50:51]
    v_pk_mul_f32 v[50:51], v[50:51], s[50:51]
    v_pk_mul_f32 v[52:53], v[52:53], s[50:51]
    v_pk_mul_f32 v[54:55], v[54:55], s[50:51]
    v_cvt_pk_bf16_f32 v48, v48, v49
    v_cvt_pk_bf16_f32 v49, v50, v51
    v_cvt_pk_bf16_f32 v50, v52, v53
    v_cvt_pk_bf16_f32 v51, v54, v55
    v_accvgpr_write_b32 a180, v48
    v_accvgpr_write_b32 a181, v49
    v_accvgpr_write_b32 a182, v50
    v_accvgpr_write_b32 a183, v51
    .p2align 3
    v_pk_mul_f32 v[56:57], v[56:57], s[50:51]
    v_pk_mul_f32 v[58:59], v[58:59], s[50:51]
    v_pk_mul_f32 v[60:61], v[60:61], s[50:51]
    v_pk_mul_f32 v[62:63], v[62:63], s[50:51]
    v_mfma_f32_32x32x16_bf16 v[40:55], v[232:235], v[232:235], 0
    v_cvt_pk_bf16_f32 v56, v56, v57
    v_cvt_pk_bf16_f32 v57, v58, v59
    v_cvt_pk_bf16_f32 v58, v60, v61
    v_cvt_pk_bf16_f32 v59, v62, v63
    v_accvgpr_write_b32 a192, v56
    v_accvgpr_write_b32 a193, v57
    v_accvgpr_write_b32 a194, v58
    v_accvgpr_write_b32 a195, v59
    s_add_u32 m0, s49, 16384
    s_xor_b32 s56, s56, 0x1000
    buffer_load_dwordx4 v5, s[8:11], s56 offen offset:0 nt lds
    .p2align 3
    v_pk_mul_f32 v[64:65], v[64:65], s[50:51]
    v_pk_mul_f32 v[66:67], v[66:67], s[50:51]
    v_pk_mul_f32 v[68:69], v[68:69], s[50:51]
    v_pk_mul_f32 v[70:71], v[70:71], s[50:51]
    v_cvt_pk_bf16_f32 v64, v64, v65
    v_cvt_pk_bf16_f32 v65, v66, v67
    v_cvt_pk_bf16_f32 v66, v68, v69
    v_cvt_pk_bf16_f32 v67, v70, v71
    v_accvgpr_write_b32 a196, v64
    v_accvgpr_write_b32 a197, v65
    v_accvgpr_write_b32 a198, v66
    v_accvgpr_write_b32 a199, v67
    buffer_load_dwordx4 v6, s[8:11], s56 offen offset:1024 nt lds
    .p2align 3
    v_pk_mul_f32 v[72:73], v[72:73], s[50:51]
    v_pk_mul_f32 v[74:75], v[74:75], s[50:51]
    v_pk_mul_f32 v[76:77], v[76:77], s[50:51]
    v_pk_mul_f32 v[78:79], v[78:79], s[50:51]
    v_mfma_f32_32x32x16_bf16 v[56:71], v[232:235], v[232:235], 0
    v_cvt_pk_bf16_f32 v72, v72, v73
    v_cvt_pk_bf16_f32 v73, v74, v75
    v_cvt_pk_bf16_f32 v74, v76, v77
    v_cvt_pk_bf16_f32 v75, v78, v79
    v_accvgpr_write_b32 a208, v72
    v_accvgpr_write_b32 a209, v73
    v_accvgpr_write_b32 a210, v74
    v_accvgpr_write_b32 a211, v75
    .p2align 3
    v_pk_mul_f32 v[80:81], v[80:81], s[50:51]
    v_pk_mul_f32 v[82:83], v[82:83], s[50:51]
    v_pk_mul_f32 v[84:85], v[84:85], s[50:51]
    v_pk_mul_f32 v[86:87], v[86:87], s[50:51]
    v_cvt_pk_bf16_f32 v80, v80, v81
    v_cvt_pk_bf16_f32 v81, v82, v83
    v_cvt_pk_bf16_f32 v82, v84, v85
    v_cvt_pk_bf16_f32 v83, v86, v87
    v_accvgpr_write_b32 a212, v80
    v_accvgpr_write_b32 a213, v81
    v_accvgpr_write_b32 a214, v82
    v_accvgpr_write_b32 a215, v83
    buffer_load_dwordx4 v5, s[8:11], s56 offen offset:2048 nt lds
    .p2align 3
    v_pk_mul_f32 v[88:89], v[88:89], s[50:51]
    v_pk_mul_f32 v[90:91], v[90:91], s[50:51]
    v_pk_mul_f32 v[92:93], v[92:93], s[50:51]
    v_pk_mul_f32 v[94:95], v[94:95], s[50:51]
    v_mfma_f32_32x32x16_bf16 v[72:87], v[232:235], v[232:235], 0
    v_cvt_pk_bf16_f32 v88, v88, v89
    v_cvt_pk_bf16_f32 v89, v90, v91
    v_cvt_pk_bf16_f32 v90, v92, v93
    v_cvt_pk_bf16_f32 v91, v94, v95
    v_accvgpr_write_b32 a224, v88
    v_accvgpr_write_b32 a225, v89
    v_accvgpr_write_b32 a226, v90
    v_accvgpr_write_b32 a227, v91
    .p2align 3
    v_pk_mul_f32 v[96:97], v[96:97], s[50:51]
    v_pk_mul_f32 v[98:99], v[98:99], s[50:51]
    v_pk_mul_f32 v[100:101], v[100:101], s[50:51]
    v_pk_mul_f32 v[102:103], v[102:103], s[50:51]
    v_cvt_pk_bf16_f32 v96, v96, v97
    v_cvt_pk_bf16_f32 v97, v98, v99
    v_cvt_pk_bf16_f32 v98, v100, v101
    v_cvt_pk_bf16_f32 v99, v102, v103
    v_accvgpr_write_b32 a228, v96
    v_accvgpr_write_b32 a229, v97
    v_accvgpr_write_b32 a230, v98
    v_accvgpr_write_b32 a231, v99
    buffer_load_dwordx4 v6, s[8:11], s56 offen offset:3072 nt lds
    .p2align 3
    v_pk_mul_f32 v[104:105], v[104:105], s[50:51]
    v_pk_mul_f32 v[106:107], v[106:107], s[50:51]
    v_pk_mul_f32 v[108:109], v[108:109], s[50:51]
    v_pk_mul_f32 v[110:111], v[110:111], s[50:51]
    v_mfma_f32_32x32x16_bf16 v[88:103], v[232:235], v[232:235], 0
    v_cvt_pk_bf16_f32 v104, v104, v105
    v_cvt_pk_bf16_f32 v105, v106, v107
    v_cvt_pk_bf16_f32 v106, v108, v109
    v_cvt_pk_bf16_f32 v107, v110, v111
    v_accvgpr_write_b32 a240, v104
    v_accvgpr_write_b32 a241, v105
    v_accvgpr_write_b32 a242, v106
    v_accvgpr_write_b32 a243, v107
    .p2align 3
    v_pk_mul_f32 v[112:113], v[112:113], s[50:51]
    v_pk_mul_f32 v[114:115], v[114:115], s[50:51]
    v_pk_mul_f32 v[116:117], v[116:117], s[50:51]
    v_pk_mul_f32 v[118:119], v[118:119], s[50:51]
    v_cvt_pk_bf16_f32 v112, v112, v113
    v_cvt_pk_bf16_f32 v113, v114, v115
    v_cvt_pk_bf16_f32 v114, v116, v117
    v_cvt_pk_bf16_f32 v115, v118, v119
    v_accvgpr_write_b32 a244, v112
    v_accvgpr_write_b32 a245, v113
    v_accvgpr_write_b32 a246, v114
    v_accvgpr_write_b32 a247, v115
    v_mfma_f32_32x32x16_bf16 v[104:119], v[232:235], v[232:235], 0
    v_mov_b32 v232, 0x3f803f80
    v_mov_b32 v233, 0x3f803f80
    v_mov_b32 v234, 0x3f803f80
    v_mov_b32 v235, 0x3f803f80
    s_waitcnt vmcnt(12)
    s_barrier
    ds_read_b128 a[152:155], v1 offset:0
    ds_read_b128 a[156:159], v1 offset:1024
    ds_read_b128 a[168:171], v1 offset:2048
    ds_read_b128 a[172:175], v1 offset:3072
    ds_read_b128 a[184:187], v1 offset:4096
    ds_read_b128 a[188:191], v1 offset:5120
    ds_read_b128 a[200:203], v1 offset:6144
    ds_read_b128 a[204:207], v1 offset:7168
    ds_read_b128 a[216:219], v3 offset:8192
    ds_read_b128 a[220:223], v3 offset:9216
    ds_read_b128 a[232:235], v3 offset:10240
    ds_read_b128 a[236:239], v3 offset:11264
    ds_read_b128 a[248:251], v3 offset:12288
    ds_read_b128 a[252:255], v3 offset:13312
    ds_read_b128 a[88:91], v236 offset:0
    s_waitcnt lgkmcnt(14)
    ds_read_b128 a[92:95], v236 offset:4096
    s_waitcnt lgkmcnt(14)
    ds_read_b128 a[96:99], v237 offset:0
    s_waitcnt lgkmcnt(14)
    ds_read_b128 a[100:103], v237 offset:4096
    s_waitcnt lgkmcnt(14)
    ds_read_b128 a[104:107], v238 offset:0
    s_waitcnt lgkmcnt(14)
    ds_read_b128 a[108:111], v238 offset:4096
    s_waitcnt lgkmcnt(14)
    ds_read_b128 a[112:115], v239 offset:0
    s_waitcnt lgkmcnt(14)
    ds_read_b128 a[84:87], v239 offset:4096
    s_mov_b32 s59, 0
    s_waitcnt lgkmcnt(8)
    s_barrier
L_att:
    s_waitcnt lgkmcnt(6)
    v_mfma_f32_16x16x32_bf16 v[176:179], a[88:91], a[144:147], 0
    v_mfma_f32_16x16x32_bf16 v[180:183], a[92:95], a[144:147], 0
    s_waitcnt lgkmcnt(4)
    v_mfma_f32_16x16x32_bf16 v[176:179], a[96:99], a[148:151], v[176:179]
    v_mfma_f32_16x16x32_bf16 v[180:183], a[100:103], a[148:151], v[180:183]
    s_waitcnt lgkmcnt(2)
    v_mfma_f32_16x16x32_bf16 v[176:179], a[104:107], a[152:155], v[176:179]
    v_mfma_f32_16x16x32_bf16 v[180:183], a[108:111], a[152:155], v[180:183]
    s_waitcnt lgkmcnt(0)
    v_mfma_f32_16x16x32_bf16 v[176:179], a[112:115], a[156:159], v[176:179]
    v_mfma_f32_16x16x32_bf16 v[180:183], a[84:87], a[156:159], v[180:183]
    v_mfma_f32_16x16x32_bf16 v[184:187], a[88:91], a[160:163], 0
    v_mfma_f32_16x16x32_bf16 v[188:191], a[92:95], a[160:163], 0
    v_mfma_f32_16x16x32_bf16 v[184:187], a[96:99], a[164:167], v[184:187]
    v_mfma_f32_16x16x32_bf16 v[188:191], a[100:103], a[164:167], v[188:191]
    v_mfma_f32_16x16x32_bf16 v[184:187], a[104:107], a[168:171], v[184:187]
    v_mfma_f32_16x16x32_bf16 v[188:191], a[108:111], a[168:171], v[188:191]
    v_mfma_f32_16x16x32_bf16 v[184:187], a[112:115], a[172:175], v[184:187]
    v_exp_f32 v176, v176
    v_mfma_f32_16x16x32_bf16 v[188:191], a[84:87], a[172:175], v[188:191]
    v_exp_f32 v177, v177
    v_mfma_f32_16x16x32_bf16 v[192:195], a[88:91], a[176:179], 0
    v_exp_f32 v178, v178
    v_mfma_f32_16x16x32_bf16 v[196:199], a[92:95], a[176:179], 0
    v_exp_f32 v179, v179
    v_mfma_f32_16x16x32_bf16 v[192:195], a[96:99], a[180:183], v[192:195]
    v_exp_f32 v180, v180
    v_mfma_f32_16x16x32_bf16 v[196:199], a[100:103], a[180:183], v[196:199]
    v_cvt_pk_bf16_f32 v176, v176, v177
    v_cvt_pk_bf16_f32 v177, v178, v179
    v_mfma_f32_16x16x32_bf16 v[192:195], a[104:107], a[184:187], v[192:195]
    v_exp_f32 v181, v181
    v_mfma_f32_16x16x32_bf16 v[196:199], a[108:111], a[184:187], v[196:199]
    v_exp_f32 v182, v182
    v_mfma_f32_16x16x32_bf16 v[192:195], a[112:115], a[188:191], v[192:195]
    v_exp_f32 v183, v183
    v_mfma_f32_16x16x32_bf16 v[196:199], a[84:87], a[188:191], v[196:199]
    s_nop 0
    v_cvt_pk_bf16_f32 v178, v180, v181
    v_cvt_pk_bf16_f32 v179, v182, v183
    v_mfma_f32_16x16x32_bf16 v[200:203], a[88:91], a[192:195], 0
    v_exp_f32 v184, v184
    v_mfma_f32_16x16x32_bf16 v[204:207], a[92:95], a[192:195], 0
    v_exp_f32 v185, v185
    v_mfma_f32_16x16x32_bf16 v[200:203], a[96:99], a[196:199], v[200:203]
    v_exp_f32 v186, v186
    v_mfma_f32_16x16x32_bf16 v[204:207], a[100:103], a[196:199], v[204:207]
    v_exp_f32 v187, v187
    v_mfma_f32_16x16x32_bf16 v[200:203], a[104:107], a[200:203], v[200:203]
    v_exp_f32 v188, v188
    v_mfma_f32_16x16x32_bf16 v[204:207], a[108:111], a[200:203], v[204:207]
    v_cvt_pk_bf16_f32 v184, v184, v185
    v_cvt_pk_bf16_f32 v185, v186, v187
    v_mfma_f32_16x16x32_bf16 v[200:203], a[112:115], a[204:207], v[200:203]
    v_exp_f32 v189, v189
    v_mfma_f32_16x16x32_bf16 v[204:207], a[84:87], a[204:207], v[204:207]
    v_exp_f32 v190, v190
    v_mfma_f32_16x16x32_bf16 v[208:211], a[88:91], a[208:211], 0
    v_exp_f32 v191, v191
    v_mfma_f32_16x16x32_bf16 v[212:215], a[92:95], a[208:211], 0
    s_nop 0
    v_cvt_pk_bf16_f32 v186, v188, v189
    v_cvt_pk_bf16_f32 v187, v190, v191
    v_mfma_f32_16x16x32_bf16 v[208:211], a[96:99], a[212:215], v[208:211]
    v_exp_f32 v192, v192
    v_mfma_f32_16x16x32_bf16 v[212:215], a[100:103], a[212:215], v[212:215]
    v_exp_f32 v193, v193
    v_mfma_f32_16x16x32_bf16 v[208:211], a[104:107], a[216:219], v[208:211]
    v_exp_f32 v194, v194
    v_mfma_f32_16x16x32_bf16 v[212:215], a[108:111], a[216:219], v[212:215]
    v_exp_f32 v195, v195
    v_mfma_f32_16x16x32_bf16 v[208:211], a[112:115], a[220:223], v[208:211]
    v_exp_f32 v196, v196
    v_mfma_f32_16x16x32_bf16 v[212:215], a[84:87], a[220:223], v[212:215]
    v_cvt_pk_bf16_f32 v192, v192, v193
    v_cvt_pk_bf16_f32 v193, v194, v195
    v_mfma_f32_16x16x32_bf16 v[216:219], a[88:91], a[224:227], 0
    v_exp_f32 v197, v197
    v_mfma_f32_16x16x32_bf16 v[220:223], a[92:95], a[224:227], 0
    v_exp_f32 v198, v198
    v_mfma_f32_16x16x32_bf16 v[216:219], a[96:99], a[228:231], v[216:219]
    v_exp_f32 v199, v199
    v_mfma_f32_16x16x32_bf16 v[220:223], a[100:103], a[228:231], v[220:223]
    s_nop 0
    v_cvt_pk_bf16_f32 v194, v196, v197
    v_cvt_pk_bf16_f32 v195, v198, v199
    v_mfma_f32_16x16x32_bf16 v[216:219], a[104:107], a[232:235], v[216:219]
    s_waitcnt vmcnt(8)
    s_barrier
    v_mfma_f32_16x16x32_bf16 v[220:223], a[108:111], a[232:235], v[220:223]
    ds_read_b64_tr_b16 a[116:117], v241 offset:8192
    ds_read_b64_tr_b16 a[118:119], v241 offset:12288
    v_mfma_f32_16x16x32_bf16 v[216:219], a[112:115], a[236:239], v[216:219]
    ds_read_b64_tr_b16 a[120:121], v242 offset:8192
    ds_read_b64_tr_b16 a[122:123], v242 offset:12288
    v_mfma_f32_16x16x32_bf16 v[220:223], a[84:87], a[236:239], v[220:223]
    ds_read_b64_tr_b16 a[124:125], v243 offset:8192
    ds_read_b64_tr_b16 a[126:127], v243 offset:12288
    v_mfma_f32_16x16x32_bf16 v[224:227], a[88:91], a[240:243], 0
    ds_read_b64_tr_b16 a[128:129], v244 offset:8192
    ds_read_b64_tr_b16 a[130:131], v244 offset:12288
    v_mfma_f32_16x16x32_bf16 v[228:231], a[92:95], a[240:243], 0
    ds_read_b64_tr_b16 a[132:133], v245 offset:8192
    ds_read_b64_tr_b16 a[134:135], v245 offset:12288
    v_mfma_f32_16x16x32_bf16 v[224:227], a[96:99], a[244:247], v[224:227]
    ds_read_b64_tr_b16 a[136:137], v246 offset:8192
    ds_read_b64_tr_b16 a[138:139], v246 offset:12288
    v_mfma_f32_16x16x32_bf16 v[228:231], a[100:103], a[244:247], v[228:231]
    ds_read_b64_tr_b16 a[140:141], v247 offset:8192
    ds_read_b64_tr_b16 a[142:143], v247 offset:12288
    v_mfma_f32_16x16x32_bf16 v[224:227], a[104:107], a[248:251], v[224:227]
    v_exp_f32 v200, v200
    v_mfma_f32_16x16x32_bf16 v[228:231], a[108:111], a[248:251], v[228:231]
    v_exp_f32 v201, v201
    v_mfma_f32_16x16x32_bf16 v[224:227], a[112:115], a[252:255], v[224:227]
    v_exp_f32 v202, v202
    v_mfma_f32_16x16x32_bf16 v[228:231], a[84:87], a[252:255], v[228:231]
    ds_read_b64_tr_b16 a[84:85], v240 offset:8192
    s_waitcnt lgkmcnt(14)
    ds_read_b64_tr_b16 a[86:87], v240 offset:12288
    s_waitcnt lgkmcnt(2)
    v_mfma_f32_16x16x32_bf16 v[12:15], a[116:119], v[176:179], v[12:15]
    v_exp_f32 v203, v203
    v_mfma_f32_16x16x32_bf16 v[16:19], a[120:123], v[176:179], v[16:19]
    v_exp_f32 v204, v204
    v_mfma_f32_16x16x32_bf16 v[20:23], a[124:127], v[176:179], v[20:23]
    v_cvt_pk_bf16_f32 v200, v200, v201
    v_cvt_pk_bf16_f32 v201, v202, v203
    v_mfma_f32_16x16x32_bf16 v[120:123], a[128:131], v[176:179], v[120:123]
    v_exp_f32 v205, v205
    v_mfma_f32_16x16x32_bf16 v[124:127], a[132:135], v[176:179], v[124:127]
    v_exp_f32 v206, v206
    v_mfma_f32_16x16x32_bf16 a[0:3], a[136:139], v[176:179], a[0:3]
    v_exp_f32 v207, v207
    v_mfma_f32_16x16x32_bf16 a[4:7], a[140:143], v[176:179], a[4:7]
    s_nop 0
    v_cvt_pk_bf16_f32 v202, v204, v205
    v_cvt_pk_bf16_f32 v203, v206, v207
    v_mfma_f32_16x16x32_bf16 a[56:59], v[232:235], v[176:179], a[56:59]
    v_exp_f32 v208, v208
    s_waitcnt lgkmcnt(0)
    v_mfma_f32_16x16x32_bf16 v[8:11], a[84:87], v[176:179], v[8:11]
    v_exp_f32 v209, v209
    v_mfma_f32_16x16x32_bf16 v[24:27], a[84:87], v[184:187], v[24:27]
    v_exp_f32 v210, v210
    v_mfma_f32_16x16x32_bf16 v[28:31], a[116:119], v[184:187], v[28:31]
    v_exp_f32 v211, v211
    v_mfma_f32_16x16x32_bf16 v[32:35], a[120:123], v[184:187], v[32:35]
    v_exp_f32 v212, v212
    v_mfma_f32_16x16x32_bf16 v[36:39], a[124:127], v[184:187], v[36:39]
    v_cvt_pk_bf16_f32 v208, v208, v209
    v_cvt_pk_bf16_f32 v209, v210, v211
    v_mfma_f32_16x16x32_bf16 v[128:131], a[128:131], v[184:187], v[128:131]
    v_exp_f32 v213, v213
    v_mfma_f32_16x16x32_bf16 v[132:135], a[132:135], v[184:187], v[132:135]
    v_exp_f32 v214, v214
    v_mfma_f32_16x16x32_bf16 a[8:11], a[136:139], v[184:187], a[8:11]
    v_exp_f32 v215, v215
    v_mfma_f32_16x16x32_bf16 a[12:15], a[140:143], v[184:187], a[12:15]
    s_nop 0
    v_cvt_pk_bf16_f32 v210, v212, v213
    v_cvt_pk_bf16_f32 v211, v214, v215
    v_mfma_f32_16x16x32_bf16 a[60:63], v[232:235], v[184:187], a[60:63]
    v_exp_f32 v216, v216
    v_mfma_f32_16x16x32_bf16 v[40:43], a[84:87], v[192:195], v[40:43]
    v_exp_f32 v217, v217
    v_mfma_f32_16x16x32_bf16 v[44:47], a[116:119], v[192:195], v[44:47]
    v_exp_f32 v218, v218
    v_mfma_f32_16x16x32_bf16 v[48:51], a[120:123], v[192:195], v[48:51]
    v_exp_f32 v219, v219
    v_mfma_f32_16x16x32_bf16 v[52:55], a[124:127], v[192:195], v[52:55]
    v_exp_f32 v220, v220
    v_mfma_f32_16x16x32_bf16 v[136:139], a[128:131], v[192:195], v[136:139]
    v_cvt_pk_bf16_f32 v216, v216, v217
    v_cvt_pk_bf16_f32 v217, v218, v219
    v_mfma_f32_16x16x32_bf16 v[140:143], a[132:135], v[192:195], v[140:143]
    v_exp_f32 v221, v221
    v_mfma_f32_16x16x32_bf16 a[16:19], a[136:139], v[192:195], a[16:19]
    v_exp_f32 v222, v222
    v_mfma_f32_16x16x32_bf16 a[20:23], a[140:143], v[192:195], a[20:23]
    v_exp_f32 v223, v223
    v_mfma_f32_16x16x32_bf16 a[64:67], v[232:235], v[192:195], a[64:67]
    s_nop 0
    v_cvt_pk_bf16_f32 v218, v220, v221
    v_cvt_pk_bf16_f32 v219, v222, v223
    v_mfma_f32_16x16x32_bf16 v[56:59], a[84:87], v[200:203], v[56:59]
    v_exp_f32 v224, v224
    v_mfma_f32_16x16x32_bf16 v[60:63], a[116:119], v[200:203], v[60:63]
    v_exp_f32 v225, v225
    v_mfma_f32_16x16x32_bf16 v[64:67], a[120:123], v[200:203], v[64:67]
    v_exp_f32 v226, v226
    v_mfma_f32_16x16x32_bf16 v[68:71], a[124:127], v[200:203], v[68:71]
    v_exp_f32 v227, v227
    v_mfma_f32_16x16x32_bf16 v[144:147], a[128:131], v[200:203], v[144:147]
    v_exp_f32 v228, v228
    v_mfma_f32_16x16x32_bf16 v[148:151], a[132:135], v[200:203], v[148:151]
    v_cvt_pk_bf16_f32 v224, v224, v225
    v_cvt_pk_bf16_f32 v225, v226, v227
    v_mfma_f32_16x16x32_bf16 a[24:27], a[136:139], v[200:203], a[24:27]
    v_exp_f32 v229, v229
    v_mfma_f32_16x16x32_bf16 a[28:31], a[140:143], v[200:203], a[28:31]
    v_exp_f32 v230, v230
    v_mfma_f32_16x16x32_bf16 a[68:71], v[232:235], v[200:203], a[68:71]
    v_exp_f32 v231, v231
    v_mfma_f32_16x16x32_bf16 v[72:75], a[84:87], v[208:211], v[72:75]
    s_nop 0
    v_cvt_pk_bf16_f32 v226, v228, v229
    v_cvt_pk_bf16_f32 v227, v230, v231
    v_mfma_f32_16x16x32_bf16 v[76:79], a[116:119], v[208:211], v[76:79]
    v_mfma_f32_16x16x32_bf16 v[80:83], a[120:123], v[208:211], v[80:83]
    v_mfma_f32_16x16x32_bf16 v[84:87], a[124:127], v[208:211], v[84:87]
    v_mfma_f32_16x16x32_bf16 v[152:155], a[128:131], v[208:211], v[152:155]
    v_mfma_f32_16x16x32_bf16 v[156:159], a[132:135], v[208:211], v[156:159]
    v_mfma_f32_16x16x32_bf16 a[32:35], a[136:139], v[208:211], a[32:35]
    v_mfma_f32_16x16x32_bf16 a[36:39], a[140:143], v[208:211], a[36:39]
    v_mfma_f32_16x16x32_bf16 a[72:75], v[232:235], v[208:211], a[72:75]
    v_mfma_f32_16x16x32_bf16 v[88:91], a[84:87], v[216:219], v[88:91]
    v_mfma_f32_16x16x32_bf16 v[92:95], a[116:119], v[216:219], v[92:95]
    v_mfma_f32_16x16x32_bf16 v[96:99], a[120:123], v[216:219], v[96:99]
    v_mfma_f32_16x16x32_bf16 v[100:103], a[124:127], v[216:219], v[100:103]
    v_mfma_f32_16x16x32_bf16 v[160:163], a[128:131], v[216:219], v[160:163]
    v_mfma_f32_16x16x32_bf16 v[164:167], a[132:135], v[216:219], v[164:167]
    s_waitcnt vmcnt(0)
    s_barrier
    v_mfma_f32_16x16x32_bf16 a[40:43], a[136:139], v[216:219], a[40:43]
    ds_read_b128 a[88:91], v236 offset:16384
    ds_read_b128 a[92:95], v236 offset:20480
    v_mfma_f32_16x16x32_bf16 a[44:47], a[140:143], v[216:219], a[44:47]
    ds_read_b128 a[96:99], v237 offset:16384
    ds_read_b128 a[100:103], v237 offset:20480
    v_mfma_f32_16x16x32_bf16 a[76:79], v[232:235], v[216:219], a[76:79]
    ds_read_b128 a[104:107], v238 offset:16384
    ds_read_b128 a[108:111], v238 offset:20480
    v_mfma_f32_16x16x32_bf16 v[104:107], a[84:87], v[224:227], v[104:107]
    ds_read_b128 a[112:115], v239 offset:16384
    v_mfma_f32_16x16x32_bf16 v[108:111], a[116:119], v[224:227], v[108:111]
    ds_read_b128 a[84:87], v239 offset:20480
    v_mfma_f32_16x16x32_bf16 v[112:115], a[120:123], v[224:227], v[112:115]
    v_mfma_f32_16x16x32_bf16 v[116:119], a[124:127], v[224:227], v[116:119]
    v_mfma_f32_16x16x32_bf16 v[168:171], a[128:131], v[224:227], v[168:171]
    v_mfma_f32_16x16x32_bf16 v[172:175], a[132:135], v[224:227], v[172:175]
    v_mfma_f32_16x16x32_bf16 a[48:51], a[136:139], v[224:227], a[48:51]
    v_mfma_f32_16x16x32_bf16 a[52:55], a[140:143], v[224:227], a[52:55]
    v_mfma_f32_16x16x32_bf16 a[80:83], v[232:235], v[224:227], a[80:83]
    s_waitcnt lgkmcnt(6)
    v_mfma_f32_16x16x32_bf16 v[176:179], a[88:91], a[144:147], 0
    v_mfma_f32_16x16x32_bf16 v[180:183], a[92:95], a[144:147], 0
    s_waitcnt lgkmcnt(4)
    v_mfma_f32_16x16x32_bf16 v[176:179], a[96:99], a[148:151], v[176:179]
    v_mfma_f32_16x16x32_bf16 v[180:183], a[100:103], a[148:151], v[180:183]
    s_waitcnt lgkmcnt(2)
    v_mfma_f32_16x16x32_bf16 v[176:179], a[104:107], a[152:155], v[176:179]
    v_mfma_f32_16x16x32_bf16 v[180:183], a[108:111], a[152:155], v[180:183]
    s_waitcnt lgkmcnt(0)
    v_mfma_f32_16x16x32_bf16 v[176:179], a[112:115], a[156:159], v[176:179]
    v_mfma_f32_16x16x32_bf16 v[180:183], a[84:87], a[156:159], v[180:183]
    v_mfma_f32_16x16x32_bf16 v[184:187], a[88:91], a[160:163], 0
    v_mfma_f32_16x16x32_bf16 v[188:191], a[92:95], a[160:163], 0
    v_mfma_f32_16x16x32_bf16 v[184:187], a[96:99], a[164:167], v[184:187]
    v_mfma_f32_16x16x32_bf16 v[188:191], a[100:103], a[164:167], v[188:191]
    v_mfma_f32_16x16x32_bf16 v[184:187], a[104:107], a[168:171], v[184:187]
    v_mfma_f32_16x16x32_bf16 v[188:191], a[108:111], a[168:171], v[188:191]
    v_mfma_f32_16x16x32_bf16 v[184:187], a[112:115], a[172:175], v[184:187]
    v_exp_f32 v176, v176
    v_mfma_f32_16x16x32_bf16 v[188:191], a[84:87], a[172:175], v[188:191]
    v_exp_f32 v177, v177
    v_mfma_f32_16x16x32_bf16 v[192:195], a[88:91], a[176:179], 0
    v_exp_f32 v178, v178
    v_mfma_f32_16x16x32_bf16 v[196:199], a[92:95], a[176:179], 0
    v_exp_f32 v179, v179
    v_mfma_f32_16x16x32_bf16 v[192:195], a[96:99], a[180:183], v[192:195]
    v_exp_f32 v180, v180
    v_mfma_f32_16x16x32_bf16 v[196:199], a[100:103], a[180:183], v[196:199]
    v_cvt_pk_bf16_f32 v176, v176, v177
    v_cvt_pk_bf16_f32 v177, v178, v179
    v_mfma_f32_16x16x32_bf16 v[192:195], a[104:107], a[184:187], v[192:195]
    v_exp_f32 v181, v181
    v_mfma_f32_16x16x32_bf16 v[196:199], a[108:111], a[184:187], v[196:199]
    v_exp_f32 v182, v182
    v_mfma_f32_16x16x32_bf16 v[192:195], a[112:115], a[188:191], v[192:195]
    v_exp_f32 v183, v183
    v_mfma_f32_16x16x32_bf16 v[196:199], a[84:87], a[188:191], v[196:199]
    s_nop 0
    v_cvt_pk_bf16_f32 v178, v180, v181
    v_cvt_pk_bf16_f32 v179, v182, v183
    v_mfma_f32_16x16x32_bf16 v[200:203], a[88:91], a[192:195], 0
    v_exp_f32 v184, v184
    v_mfma_f32_16x16x32_bf16 v[204:207], a[92:95], a[192:195], 0
    v_exp_f32 v185, v185
    v_mfma_f32_16x16x32_bf16 v[200:203], a[96:99], a[196:199], v[200:203]
    v_exp_f32 v186, v186
    v_mfma_f32_16x16x32_bf16 v[204:207], a[100:103], a[196:199], v[204:207]
    v_exp_f32 v187, v187
    v_mfma_f32_16x16x32_bf16 v[200:203], a[104:107], a[200:203], v[200:203]
    v_exp_f32 v188, v188
    v_mfma_f32_16x16x32_bf16 v[204:207], a[108:111], a[200:203], v[204:207]
    v_cvt_pk_bf16_f32 v184, v184, v185
    v_cvt_pk_bf16_f32 v185, v186, v187
    v_mfma_f32_16x16x32_bf16 v[200:203], a[112:115], a[204:207], v[200:203]
    v_exp_f32 v189, v189
    v_mfma_f32_16x16x32_bf16 v[204:207], a[84:87], a[204:207], v[204:207]
    v_exp_f32 v190, v190
    v_mfma_f32_16x16x32_bf16 v[208:211], a[88:91], a[208:211], 0
    v_exp_f32 v191, v191
    v_mfma_f32_16x16x32_bf16 v[212:215], a[92:95], a[208:211], 0
    s_nop 0
    v_cvt_pk_bf16_f32 v186, v188, v189
    v_cvt_pk_bf16_f32 v187, v190, v191
    v_mfma_f32_16x16x32_bf16 v[208:211], a[96:99], a[212:215], v[208:211]
    v_exp_f32 v192, v192
    v_mfma_f32_16x16x32_bf16 v[212:215], a[100:103], a[212:215], v[212:215]
    v_exp_f32 v193, v193
    v_mfma_f32_16x16x32_bf16 v[208:211], a[104:107], a[216:219], v[208:211]
    v_exp_f32 v194, v194
    v_mfma_f32_16x16x32_bf16 v[212:215], a[108:111], a[216:219], v[212:215]
    v_exp_f32 v195, v195
    v_mfma_f32_16x16x32_bf16 v[208:211], a[112:115], a[220:223], v[208:211]
    v_exp_f32 v196, v196
    v_mfma_f32_16x16x32_bf16 v[212:215], a[84:87], a[220:223], v[212:215]
    v_cvt_pk_bf16_f32 v192, v192, v193
    v_cvt_pk_bf16_f32 v193, v194, v195
    v_mfma_f32_16x16x32_bf16 v[216:219], a[88:91], a[224:227], 0
    v_exp_f32 v197, v197
    v_mfma_f32_16x16x32_bf16 v[220:223], a[92:95], a[224:227], 0
    v_exp_f32 v198, v198
    v_mfma_f32_16x16x32_bf16 v[216:219], a[96:99], a[228:231], v[216:219]
    v_exp_f32 v199, v199
    v_mfma_f32_16x16x32_bf16 v[220:223], a[100:103], a[228:231], v[220:223]
    s_nop 0
    v_cvt_pk_bf16_f32 v194, v196, v197
    v_cvt_pk_bf16_f32 v195, v198, v199
    v_mfma_f32_16x16x32_bf16 v[216:219], a[104:107], a[232:235], v[216:219]
    s_waitcnt vmcnt(8)
    s_barrier
    v_mfma_f32_16x16x32_bf16 v[220:223], a[108:111], a[232:235], v[220:223]
    ds_read_b64_tr_b16 a[116:117], v241 offset:24576
    ds_read_b64_tr_b16 a[118:119], v241 offset:28672
    v_mfma_f32_16x16x32_bf16 v[216:219], a[112:115], a[236:239], v[216:219]
    ds_read_b64_tr_b16 a[120:121], v242 offset:24576
    ds_read_b64_tr_b16 a[122:123], v242 offset:28672
    v_mfma_f32_16x16x32_bf16 v[220:223], a[84:87], a[236:239], v[220:223]
    ds_read_b64_tr_b16 a[124:125], v243 offset:24576
    ds_read_b64_tr_b16 a[126:127], v243 offset:28672
    v_mfma_f32_16x16x32_bf16 v[224:227], a[88:91], a[240:243], 0
    ds_read_b64_tr_b16 a[128:129], v244 offset:24576
    ds_read_b64_tr_b16 a[130:131], v244 offset:28672
    v_mfma_f32_16x16x32_bf16 v[228:231], a[92:95], a[240:243], 0
    ds_read_b64_tr_b16 a[132:133], v245 offset:24576
    ds_read_b64_tr_b16 a[134:135], v245 offset:28672
    v_mfma_f32_16x16x32_bf16 v[224:227], a[96:99], a[244:247], v[224:227]
    ds_read_b64_tr_b16 a[136:137], v246 offset:24576
    ds_read_b64_tr_b16 a[138:139], v246 offset:28672
    v_mfma_f32_16x16x32_bf16 v[228:231], a[100:103], a[244:247], v[228:231]
    ds_read_b64_tr_b16 a[140:141], v247 offset:24576
    ds_read_b64_tr_b16 a[142:143], v247 offset:28672
    v_mfma_f32_16x16x32_bf16 v[224:227], a[104:107], a[248:251], v[224:227]
    v_exp_f32 v200, v200
    v_mfma_f32_16x16x32_bf16 v[228:231], a[108:111], a[248:251], v[228:231]
    v_exp_f32 v201, v201
    v_mfma_f32_16x16x32_bf16 v[224:227], a[112:115], a[252:255], v[224:227]
    v_exp_f32 v202, v202
    v_mfma_f32_16x16x32_bf16 v[228:231], a[84:87], a[252:255], v[228:231]
    ds_read_b64_tr_b16 a[84:85], v240 offset:24576
    s_waitcnt lgkmcnt(14)
    ds_read_b64_tr_b16 a[86:87], v240 offset:28672
    s_waitcnt lgkmcnt(2)
    v_mfma_f32_16x16x32_bf16 v[12:15], a[116:119], v[176:179], v[12:15]
    v_exp_f32 v203, v203
    v_mfma_f32_16x16x32_bf16 v[16:19], a[120:123], v[176:179], v[16:19]
    v_exp_f32 v204, v204
    v_mfma_f32_16x16x32_bf16 v[20:23], a[124:127], v[176:179], v[20:23]
    v_cvt_pk_bf16_f32 v200, v200, v201
    v_cvt_pk_bf16_f32 v201, v202, v203
    v_mfma_f32_16x16x32_bf16 v[120:123], a[128:131], v[176:179], v[120:123]
    v_exp_f32 v205, v205
    v_mfma_f32_16x16x32_bf16 v[124:127], a[132:135], v[176:179], v[124:127]
    v_exp_f32 v206, v206
    v_mfma_f32_16x16x32_bf16 a[0:3], a[136:139], v[176:179], a[0:3]
    v_exp_f32 v207, v207
    v_mfma_f32_16x16x32_bf16 a[4:7], a[140:143], v[176:179], a[4:7]
    s_nop 0
    v_cvt_pk_bf16_f32 v202, v204, v205
    v_cvt_pk_bf16_f32 v203, v206, v207
    v_mfma_f32_16x16x32_bf16 a[56:59], v[232:235], v[176:179], a[56:59]
    v_exp_f32 v208, v208
    s_waitcnt lgkmcnt(0)
    v_mfma_f32_16x16x32_bf16 v[8:11], a[84:87], v[176:179], v[8:11]
    v_exp_f32 v209, v209
    v_mfma_f32_16x16x32_bf16 v[24:27], a[84:87], v[184:187], v[24:27]
    v_exp_f32 v210, v210
    v_mfma_f32_16x16x32_bf16 v[28:31], a[116:119], v[184:187], v[28:31]
    v_exp_f32 v211, v211
    v_mfma_f32_16x16x32_bf16 v[32:35], a[120:123], v[184:187], v[32:35]
    v_exp_f32 v212, v212
    v_mfma_f32_16x16x32_bf16 v[36:39], a[124:127], v[184:187], v[36:39]
    v_cvt_pk_bf16_f32 v208, v208, v209
    v_cvt_pk_bf16_f32 v209, v210, v211
    v_mfma_f32_16x16x32_bf16 v[128:131], a[128:131], v[184:187], v[128:131]
    v_exp_f32 v213, v213
    v_mfma_f32_16x16x32_bf16 v[132:135], a[132:135], v[184:187], v[132:135]
    v_exp_f32 v214, v214
    v_mfma_f32_16x16x32_bf16 a[8:11], a[136:139], v[184:187], a[8:11]
    v_exp_f32 v215, v215
    v_mfma_f32_16x16x32_bf16 a[12:15], a[140:143], v[184:187], a[12:15]
    s_nop 0
    v_cvt_pk_bf16_f32 v210, v212, v213
    v_cvt_pk_bf16_f32 v211, v214, v215
    v_mfma_f32_16x16x32_bf16 a[60:63], v[232:235], v[184:187], a[60:63]
    v_exp_f32 v216, v216
    v_mfma_f32_16x16x32_bf16 v[40:43], a[84:87], v[192:195], v[40:43]
    v_exp_f32 v217, v217
    v_mfma_f32_16x16x32_bf16 v[44:47], a[116:119], v[192:195], v[44:47]
    v_exp_f32 v218, v218
    v_mfma_f32_16x16x32_bf16 v[48:51], a[120:123], v[192:195], v[48:51]
    v_exp_f32 v219, v219
    v_mfma_f32_16x16x32_bf16 v[52:55], a[124:127], v[192:195], v[52:55]
    v_exp_f32 v220, v220
    v_mfma_f32_16x16x32_bf16 v[136:139], a[128:131], v[192:195], v[136:139]
    v_cvt_pk_bf16_f32 v216, v216, v217
    v_cvt_pk_bf16_f32 v217, v218, v219
    v_mfma_f32_16x16x32_bf16 v[140:143], a[132:135], v[192:195], v[140:143]
    v_exp_f32 v221, v221
    v_mfma_f32_16x16x32_bf16 a[16:19], a[136:139], v[192:195], a[16:19]
    v_exp_f32 v222, v222
    v_mfma_f32_16x16x32_bf16 a[20:23], a[140:143], v[192:195], a[20:23]
    v_exp_f32 v223, v223
    v_mfma_f32_16x16x32_bf16 a[64:67], v[232:235], v[192:195], a[64:67]
    s_nop 0
    v_cvt_pk_bf16_f32 v218, v220, v221
    v_cvt_pk_bf16_f32 v219, v222, v223
    v_mfma_f32_16x16x32_bf16 v[56:59], a[84:87], v[200:203], v[56:59]
    v_exp_f32 v224, v224
    v_mfma_f32_16x16x32_bf16 v[60:63], a[116:119], v[200:203], v[60:63]
    v_exp_f32 v225, v225
    v_mfma_f32_16x16x32_bf16 v[64:67], a[120:123], v[200:203], v[64:67]
    v_exp_f32 v226, v226
    v_mfma_f32_16x16x32_bf16 v[68:71], a[124:127], v[200:203], v[68:71]
    v_exp_f32 v227, v227
    v_mfma_f32_16x16x32_bf16 v[144:147], a[128:131], v[200:203], v[144:147]
    v_exp_f32 v228, v228
    v_mfma_f32_16x16x32_bf16 v[148:151], a[132:135], v[200:203], v[148:151]
    v_cvt_pk_bf16_f32 v224, v224, v225
    v_cvt_pk_bf16_f32 v225, v226, v227
    v_mfma_f32_16x16x32_bf16 a[24:27], a[136:139], v[200:203], a[24:27]
    v_exp_f32 v229, v229
    v_mfma_f32_16x16x32_bf16 a[28:31], a[140:143], v[200:203], a[28:31]
    v_exp_f32 v230, v230
    v_mfma_f32_16x16x32_bf16 a[68:71], v[232:235], v[200:203], a[68:71]
    v_exp_f32 v231, v231
    v_mfma_f32_16x16x32_bf16 v[72:75], a[84:87], v[208:211], v[72:75]
    s_nop 0
    v_cvt_pk_bf16_f32 v226, v228, v229
    v_cvt_pk_bf16_f32 v227, v230, v231
    v_mfma_f32_16x16x32_bf16 v[76:79], a[116:119], v[208:211], v[76:79]
    v_mfma_f32_16x16x32_bf16 v[80:83], a[120:123], v[208:211], v[80:83]
    v_mfma_f32_16x16x32_bf16 v[84:87], a[124:127], v[208:211], v[84:87]
    v_mfma_f32_16x16x32_bf16 v[152:155], a[128:131], v[208:211], v[152:155]
    v_mfma_f32_16x16x32_bf16 v[156:159], a[132:135], v[208:211], v[156:159]
    v_mfma_f32_16x16x32_bf16 a[32:35], a[136:139], v[208:211], a[32:35]
    v_mfma_f32_16x16x32_bf16 a[36:39], a[140:143], v[208:211], a[36:39]
    v_mfma_f32_16x16x32_bf16 a[72:75], v[232:235], v[208:211], a[72:75]
    v_mfma_f32_16x16x32_bf16 v[88:91], a[84:87], v[216:219], v[88:91]
    v_mfma_f32_16x16x32_bf16 v[92:95], a[116:119], v[216:219], v[92:95]
    v_mfma_f32_16x16x32_bf16 v[96:99], a[120:123], v[216:219], v[96:99]
    v_mfma_f32_16x16x32_bf16 v[100:103], a[124:127], v[216:219], v[100:103]
    v_mfma_f32_16x16x32_bf16 v[160:163], a[128:131], v[216:219], v[160:163]
    v_mfma_f32_16x16x32_bf16 v[164:167], a[132:135], v[216:219], v[164:167]
    s_waitcnt vmcnt(0)
    s_barrier
    v_mfma_f32_16x16x32_bf16 a[40:43], a[136:139], v[216:219], a[40:43]
    ds_read_b128 a[88:91], v236 offset:0
    ds_read_b128 a[92:95], v236 offset:4096
    v_mfma_f32_16x16x32_bf16 a[44:47], a[140:143], v[216:219], a[44:47]
    ds_read_b128 a[96:99], v237 offset:0
    ds_read_b128 a[100:103], v237 offset:4096
    v_mfma_f32_16x16x32_bf16 a[76:79], v[232:235], v[216:219], a[76:79]
    ds_read_b128 a[104:107], v238 offset:0
    ds_read_b128 a[108:111], v238 offset:4096
    v_mfma_f32_16x16x32_bf16 v[104:107], a[84:87], v[224:227], v[104:107]
    ds_read_b128 a[112:115], v239 offset:0
    v_mfma_f32_16x16x32_bf16 v[108:111], a[116:119], v[224:227], v[108:111]
    ds_read_b128 a[84:87], v239 offset:4096
    v_mfma_f32_16x16x32_bf16 v[112:115], a[120:123], v[224:227], v[112:115]
    v_mfma_f32_16x16x32_bf16 v[116:119], a[124:127], v[224:227], v[116:119]
    v_mfma_f32_16x16x32_bf16 v[168:171], a[128:131], v[224:227], v[168:171]
    v_mfma_f32_16x16x32_bf16 v[172:175], a[132:135], v[224:227], v[172:175]
    v_mfma_f32_16x16x32_bf16 a[48:51], a[136:139], v[224:227], a[48:51]
    s_add_u32 s59, s59, 1
    s_cmp_lt_u32 s59, 8
    v_mfma_f32_16x16x32_bf16 a[52:55], a[140:143], v[224:227], a[52:55]
    v_mfma_f32_16x16x32_bf16 a[80:83], v[232:235], v[224:227], a[80:83]
    s_cbranch_scc1 L_att
    s_waitcnt lgkmcnt(0)
    s_nop 4
L_lchk:
    v_accvgpr_read_b32 v224, a56
    v_accvgpr_read_b32 v225, a60
    v_accvgpr_read_b32 v226, a64
    v_accvgpr_read_b32 v227, a68
    v_accvgpr_read_b32 v228, a72
    v_accvgpr_read_b32 v229, a76
    v_accvgpr_read_b32 v230, a80
    v_subrev_u32 v176, 0x2b800000, v224
    v_subrev_u32 v177, 0x2b800000, v225
    v_subrev_u32 v178, 0x2b800000, v226
    v_subrev_u32 v179, 0x2b800000, v227
    v_subrev_u32 v180, 0x2b800000, v228
    v_subrev_u32 v181, 0x2b800000, v229
    v_subrev_u32 v182, 0x2b800000, v230
    v_max3_u32 v176, v176, v177, v178
    v_max3_u32 v176, v176, v179, v180
    v_max3_u32 v176, v176, v181, v182
    v_cmp_lt_u32 vcc, 0x28000000, v176
    v_rcp_f32 v224, v224
    v_rcp_f32 v225, v225
    v_rcp_f32 v226, v226
    v_rcp_f32 v227, v227
    v_rcp_f32 v228, v228
    v_rcp_f32 v229, v229
    v_rcp_f32 v230, v230
    s_cbranch_vccnz L_safe
L_lok:
    s_cmp_eq_u32 s42, 1
    s_cbranch_scc1 L_y2
    s_add_u32 m0, s48, 24576
    s_xor_b32 s56, s47, 8192
    buffer_load_dwordx4 v5, s[12:15], s56 offen offset:0 nt lds
    s_mul_i32 s52, s41, 28672
    s_xor_b32 s53, s42, 1
    s_lshl_b32 s53, s53, 16
    s_add_u32 s52, s52, s53
    v_add_u32 v207, s52, v4
    v_lshrrev_b32 v198, 1, v4
    s_mul_i32 s52, s41, 28672
    s_add_u32 s52, s52, 65536
    v_add_u32 v208, s52, v4
    buffer_load_dwordx4 v6, s[12:15], s56 offen offset:1024 nt lds
    v_add_u32 v209, s52, v198
    v_lshrrev_b32 v1, 2, v0
    v_bfe_u32 v2, v1, 1, 2
    v_xor_b32 v2, s43, v2
    v_lshlrev_b32 v2, 5, v2
    v_and_b32 v3, 3, v0
    v_lshl_add_u32 v2, v3, 3, v2
    v_lshl_add_u32 v192, v1, 7, v2
    v_add_u32 v193, 0x10000, v192
    v_add_u32 v194, 0x20000, v192
    buffer_load_dwordx4 v5, s[12:15], s56 offen offset:2048 nt lds
    v_and_b32 v2, 1, v3
    v_lshlrev_b32 v2, 4, v2
    s_movk_i32 s52, 0x3f80
    v_lshlrev_b32 v2, v2, s52
    v_cmp_gt_u32 vcc, 2, v3
    v_lshrrev_b32 v1, 4, v0
    v_lshlrev_b32 v3, 1, v1
    v_cndmask_b32 v204, 0, v2, vcc
    v_xor_b32 v205, v204, v2
    v_and_b32 v2, 7, v0
    buffer_load_dwordx4 v6, s[12:15], s56 offen offset:3072 nt lds
    v_xor_b32 v3, v3, v2
    v_lshrrev_b32 v2, 3, v0
    v_lshlrev_b32 v2, 10, v2
    v_lshl_add_u32 v197, v3, 4, v2
    s_lshl2_add_u32 s52, s41, s42
    s_lshl_b32 s52, s52, 15
    v_add_u32 v197, s52, v197
    s_lshl_b32 s65, s40, 12
    v_add_u32 v195, 122880, v192
    v_xor_b32 v196, 32, v195
    s_add_u32 m0, s49, 24576
    s_xor_b32 s56, s56, 0x1000
    buffer_load_dwordx4 v5, s[12:15], s56 offen offset:0 nt lds
    v_add_u32 v210, 65536, v4
    .p2align 3
    v_accvgpr_read_b32 v176, a0
    v_accvgpr_read_b32 v177, a1
    v_accvgpr_read_b32 v178, a2
    v_accvgpr_read_b32 v179, a3
    v_accvgpr_read_b32 v180, a4
    v_accvgpr_read_b32 v181, a5
    v_accvgpr_read_b32 v182, a6
    v_accvgpr_read_b32 v183, a7
    buffer_load_dwordx4 v6, s[12:15], s56 offen offset:1024 nt lds
    v_pk_mul_f32 v[8:9], v[8:9], v[224:225] op_sel:[0,0] op_sel_hi:[1,0]
    v_pk_mul_f32 v[10:11], v[10:11], v[224:225] op_sel:[0,0] op_sel_hi:[1,0]
    v_pk_mul_f32 v[12:13], v[12:13], v[224:225] op_sel:[0,0] op_sel_hi:[1,0]
    v_pk_mul_f32 v[14:15], v[14:15], v[224:225] op_sel:[0,0] op_sel_hi:[1,0]
    v_cvt_pk_bf16_f32 v8, v8, v9
    v_cvt_pk_bf16_f32 v9, v10, v11
    v_cvt_pk_bf16_f32 v10, v12, v13
    v_cvt_pk_bf16_f32 v11, v14, v15
    ds_write_b128 v207, v[8:11] offset:0
    v_pk_mul_f32 v[16:17], v[16:17], v[224:225] op_sel:[0,0] op_sel_hi:[1,0]
    buffer_load_dwordx4 v5, s[12:15], s56 offen offset:2048 nt lds
    v_pk_mul_f32 v[18:19], v[18:19], v[224:225] op_sel:[0,0] op_sel_hi:[1,0]
    v_pk_mul_f32 v[20:21], v[20:21], v[224:225] op_sel:[0,0] op_sel_hi:[1,0]
    v_pk_mul_f32 v[22:23], v[22:23], v[224:225] op_sel:[0,0] op_sel_hi:[1,0]
    v_cvt_pk_bf16_f32 v16, v16, v17
    v_cvt_pk_bf16_f32 v17, v18, v19
    v_cvt_pk_bf16_f32 v18, v20, v21
    v_cvt_pk_bf16_f32 v19, v22, v23
    ds_write_b128 v207, v[16:19] offset:7168
    v_pk_mul_f32 v[120:121], v[120:121], v[224:225] op_sel:[0,0] op_sel_hi:[1,0]
    v_pk_mul_f32 v[122:123], v[122:123], v[224:225] op_sel:[0,0] op_sel_hi:[1,0]
    buffer_load_dwordx4 v6, s[12:15], s56 offen offset:3072 nt lds
    v_pk_mul_f32 v[124:125], v[124:125], v[224:225] op_sel:[0,0] op_sel_hi:[1,0]
    v_pk_mul_f32 v[126:127], v[126:127], v[224:225] op_sel:[0,0] op_sel_hi:[1,0]
    v_cvt_pk_bf16_f32 v120, v120, v121
    v_cvt_pk_bf16_f32 v121, v122, v123
    v_cvt_pk_bf16_f32 v122, v124, v125
    v_cvt_pk_bf16_f32 v123, v126, v127
    ds_write_b128 v207, v[120:123] offset:14336
    v_pk_mul_f32 v[176:177], v[176:177], v[224:225] op_sel:[0,0] op_sel_hi:[1,0]
    v_pk_mul_f32 v[178:179], v[178:179], v[224:225] op_sel:[0,0] op_sel_hi:[1,0]
    v_pk_mul_f32 v[180:181], v[180:181], v[224:225] op_sel:[0,0] op_sel_hi:[1,0]
    s_barrier
    s_add_u32 m0, s48, 0
    s_xor_b32 s56, s47, 16384
    buffer_load_dwordx4 v5, s[8:11], s56 offen offset:0 nt lds
    v_pk_mul_f32 v[182:183], v[182:183], v[224:225] op_sel:[0,0] op_sel_hi:[1,0]
    v_cvt_pk_bf16_f32 v176, v176, v177
    v_cvt_pk_bf16_f32 v177, v178, v179
    v_cvt_pk_bf16_f32 v178, v180, v181
    v_cvt_pk_bf16_f32 v179, v182, v183
    buffer_load_dwordx4 v6, s[8:11], s56 offen offset:1024 nt lds
    ds_write_b128 v207, v[176:179] offset:21504
    .p2align 3
    v_accvgpr_read_b32 v184, a8
    v_accvgpr_read_b32 v185, a9
    v_accvgpr_read_b32 v186, a10
    v_accvgpr_read_b32 v187, a11
    buffer_load_dwordx4 v5, s[8:11], s56 offen offset:2048 nt lds
    v_accvgpr_read_b32 v188, a12
    v_accvgpr_read_b32 v189, a13
    v_accvgpr_read_b32 v190, a14
    v_accvgpr_read_b32 v191, a15
    v_pk_mul_f32 v[24:25], v[24:25], v[224:225] op_sel:[0,1] op_sel_hi:[1,1]
    v_pk_mul_f32 v[26:27], v[26:27], v[224:225] op_sel:[0,1] op_sel_hi:[1,1]
    buffer_load_dwordx4 v6, s[8:11], s56 offen offset:3072 nt lds
    v_pk_mul_f32 v[28:29], v[28:29], v[224:225] op_sel:[0,1] op_sel_hi:[1,1]
    v_pk_mul_f32 v[30:31], v[30:31], v[224:225] op_sel:[0,1] op_sel_hi:[1,1]
    v_cvt_pk_bf16_f32 v24, v24, v25
    v_cvt_pk_bf16_f32 v25, v26, v27
    v_cvt_pk_bf16_f32 v26, v28, v29
    v_cvt_pk_bf16_f32 v27, v30, v31
    s_add_u32 m0, s65, 122880
    s_add_u32 s58, s44, 1
    s_and_b32 s58, s58, 7
    s_lshl_b32 s58, s58, 7
    buffer_load_dwordx4 v197, s[20:23], s58 offen offset:0 lds
    ds_write_b128 v207, v[24:27] offset:1024
    v_pk_mul_f32 v[32:33], v[32:33], v[224:225] op_sel:[0,1] op_sel_hi:[1,1]
    v_pk_mul_f32 v[34:35], v[34:35], v[224:225] op_sel:[0,1] op_sel_hi:[1,1]
    v_pk_mul_f32 v[36:37], v[36:37], v[224:225] op_sel:[0,1] op_sel_hi:[1,1]
    v_pk_mul_f32 v[38:39], v[38:39], v[224:225] op_sel:[0,1] op_sel_hi:[1,1]
    v_cvt_pk_bf16_f32 v32, v32, v33
    s_addk_i32 s58, 7168
    buffer_load_dwordx4 v197, s[20:23], s58 offen offset:1024 lds
    v_cvt_pk_bf16_f32 v33, v34, v35
    v_cvt_pk_bf16_f32 v34, v36, v37
    v_cvt_pk_bf16_f32 v35, v38, v39
    ds_write_b128 v207, v[32:35] offset:8192
    v_pk_mul_f32 v[128:129], v[128:129], v[224:225] op_sel:[0,1] op_sel_hi:[1,1]
    s_addk_i32 s58, 7168
    buffer_load_dwordx4 v197, s[20:23], s58 offen offset:2048 lds
    v_pk_mul_f32 v[130:131], v[130:131], v[224:225] op_sel:[0,1] op_sel_hi:[1,1]
    v_pk_mul_f32 v[132:133], v[132:133], v[224:225] op_sel:[0,1] op_sel_hi:[1,1]
    v_pk_mul_f32 v[134:135], v[134:135], v[224:225] op_sel:[0,1] op_sel_hi:[1,1]
    v_cvt_pk_bf16_f32 v128, v128, v129
    v_cvt_pk_bf16_f32 v129, v130, v131
    v_cvt_pk_bf16_f32 v130, v132, v133
    s_addk_i32 s58, 7168
    buffer_load_dwordx4 v197, s[20:23], s58 offen offset:3072 lds
    v_cvt_pk_bf16_f32 v131, v134, v135
    ds_write_b128 v207, v[128:131] offset:15360
    v_pk_mul_f32 v[184:185], v[184:185], v[224:225] op_sel:[0,1] op_sel_hi:[1,1]
    v_pk_mul_f32 v[186:187], v[186:187], v[224:225] op_sel:[0,1] op_sel_hi:[1,1]
    v_pk_mul_f32 v[188:189], v[188:189], v[224:225] op_sel:[0,1] op_sel_hi:[1,1]
    v_pk_mul_f32 v[190:191], v[190:191], v[224:225] op_sel:[0,1] op_sel_hi:[1,1]
    s_add_u32 m0, s65, 131072
    s_add_u32 s58, s44, 1
    s_and_b32 s58, s58, 7
    s_lshl_b32 s58, s58, 7
    s_add_u32 s58, s58, 32768
    buffer_load_dwordx4 v197, s[20:23], s58 offen offset:0 lds
    v_cvt_pk_bf16_f32 v184, v184, v185
    v_cvt_pk_bf16_f32 v185, v186, v187
    v_cvt_pk_bf16_f32 v186, v188, v189
    v_cvt_pk_bf16_f32 v187, v190, v191
    ds_write_b128 v207, v[184:187] offset:22528
    s_waitcnt lgkmcnt(4)
    s_addk_i32 s58, 7168
    buffer_load_dwordx4 v197, s[20:23], s58 offen offset:1024 lds
    .p2align 3
    v_accvgpr_read_b32 v176, a16
    v_accvgpr_read_b32 v177, a17
    v_accvgpr_read_b32 v178, a18
    v_accvgpr_read_b32 v179, a19
    v_accvgpr_read_b32 v180, a20
    s_addk_i32 s58, 7168
    buffer_load_dwordx4 v197, s[20:23], s58 offen offset:2048 lds
    v_accvgpr_read_b32 v181, a21
    v_accvgpr_read_b32 v182, a22
    v_accvgpr_read_b32 v183, a23
    v_pk_mul_f32 v[40:41], v[40:41], v[226:227] op_sel:[0,0] op_sel_hi:[1,0]
    v_pk_mul_f32 v[42:43], v[42:43], v[226:227] op_sel:[0,0] op_sel_hi:[1,0]
    s_addk_i32 s58, 7168
    buffer_load_dwordx4 v197, s[20:23], s58 offen offset:3072 lds
    v_pk_mul_f32 v[44:45], v[44:45], v[226:227] op_sel:[0,0] op_sel_hi:[1,0]
    v_pk_mul_f32 v[46:47], v[46:47], v[226:227] op_sel:[0,0] op_sel_hi:[1,0]
    v_cvt_pk_bf16_f32 v40, v40, v41
    v_cvt_pk_bf16_f32 v41, v42, v43
    v_cvt_pk_bf16_f32 v42, v44, v45
    v_cvt_pk_bf16_f32 v43, v46, v47
    s_add_u32 m0, s49, 0
    s_xor_b32 s56, s56, 0x1000
    buffer_load_dwordx4 v5, s[8:11], s56 offen offset:0 nt lds
    ds_write_b128 v207, v[40:43] offset:2048
    v_pk_mul_f32 v[48:49], v[48:49], v[226:227] op_sel:[0,0] op_sel_hi:[1,0]
    v_pk_mul_f32 v[50:51], v[50:51], v[226:227] op_sel:[0,0] op_sel_hi:[1,0]
    v_pk_mul_f32 v[52:53], v[52:53], v[226:227] op_sel:[0,0] op_sel_hi:[1,0]
    v_pk_mul_f32 v[54:55], v[54:55], v[226:227] op_sel:[0,0] op_sel_hi:[1,0]
    v_cvt_pk_bf16_f32 v48, v48, v49
    s_waitcnt vmcnt(20)
    buffer_load_dwordx4 v6, s[8:11], s56 offen offset:1024 nt lds
    v_cvt_pk_bf16_f32 v49, v50, v51
    v_cvt_pk_bf16_f32 v50, v52, v53
    v_cvt_pk_bf16_f32 v51, v54, v55
    ds_write_b128 v207, v[48:51] offset:9216
    v_pk_mul_f32 v[136:137], v[136:137], v[226:227] op_sel:[0,0] op_sel_hi:[1,0]
    v_pk_mul_f32 v[138:139], v[138:139], v[226:227] op_sel:[0,0] op_sel_hi:[1,0]
    s_waitcnt vmcnt(20)
    buffer_load_dwordx4 v5, s[8:11], s56 offen offset:2048 nt lds
    v_pk_mul_f32 v[140:141], v[140:141], v[226:227] op_sel:[0,0] op_sel_hi:[1,0]
    v_pk_mul_f32 v[142:143], v[142:143], v[226:227] op_sel:[0,0] op_sel_hi:[1,0]
    v_cvt_pk_bf16_f32 v136, v136, v137
    v_cvt_pk_bf16_f32 v137, v138, v139
    v_cvt_pk_bf16_f32 v138, v140, v141
    v_cvt_pk_bf16_f32 v139, v142, v143
    s_waitcnt vmcnt(20)
    buffer_load_dwordx4 v6, s[8:11], s56 offen offset:3072 nt lds
    ds_write_b128 v207, v[136:139] offset:16384
    v_pk_mul_f32 v[176:177], v[176:177], v[226:227] op_sel:[0,0] op_sel_hi:[1,0]
    v_pk_mul_f32 v[178:179], v[178:179], v[226:227] op_sel:[0,0] op_sel_hi:[1,0]
    v_pk_mul_f32 v[180:181], v[180:181], v[226:227] op_sel:[0,0] op_sel_hi:[1,0]
    v_pk_mul_f32 v[182:183], v[182:183], v[226:227] op_sel:[0,0] op_sel_hi:[1,0]
    v_cvt_pk_bf16_f32 v176, v176, v177
    s_barrier
    s_add_u32 m0, s48, 8192
    s_xor_b32 s56, s47, 16384
    s_waitcnt vmcnt(20)
    buffer_load_dwordx4 v5, s[12:15], s56 offen offset:0 nt lds
    v_cvt_pk_bf16_f32 v177, v178, v179
    v_cvt_pk_bf16_f32 v178, v180, v181
    v_cvt_pk_bf16_f32 v179, v182, v183
    ds_write_b128 v207, v[176:179] offset:23552
    s_waitcnt lgkmcnt(4)
    .p2align 3
    v_accvgpr_read_b32 v184, a24
    v_accvgpr_read_b32 v185, a25
    v_accvgpr_read_b32 v186, a26
    v_accvgpr_read_b32 v187, a27
    v_accvgpr_read_b32 v188, a28
    s_waitcnt vmcnt(20)
    buffer_load_dwordx4 v6, s[12:15], s56 offen offset:1024 nt lds
    v_accvgpr_read_b32 v189, a29
    v_accvgpr_read_b32 v190, a30
    v_accvgpr_read_b32 v191, a31
    v_pk_mul_f32 v[56:57], v[56:57], v[226:227] op_sel:[0,1] op_sel_hi:[1,1]
    v_pk_mul_f32 v[58:59], v[58:59], v[226:227] op_sel:[0,1] op_sel_hi:[1,1]
    v_pk_mul_f32 v[60:61], v[60:61], v[226:227] op_sel:[0,1] op_sel_hi:[1,1]
    v_pk_mul_f32 v[62:63], v[62:63], v[226:227] op_sel:[0,1] op_sel_hi:[1,1]
    v_cvt_pk_bf16_f32 v56, v56, v57
    v_cvt_pk_bf16_f32 v57, v58, v59
    v_cvt_pk_bf16_f32 v58, v60, v61
    v_cvt_pk_bf16_f32 v59, v62, v63
    ds_write_b128 v207, v[56:59] offset:3072
    s_waitcnt vmcnt(20)
    buffer_load_dwordx4 v5, s[12:15], s56 offen offset:2048 nt lds
    v_pk_mul_f32 v[64:65], v[64:65], v[226:227] op_sel:[0,1] op_sel_hi:[1,1]
    v_pk_mul_f32 v[66:67], v[66:67], v[226:227] op_sel:[0,1] op_sel_hi:[1,1]
    v_pk_mul_f32 v[68:69], v[68:69], v[226:227] op_sel:[0,1] op_sel_hi:[1,1]
    v_pk_mul_f32 v[70:71], v[70:71], v[226:227] op_sel:[0,1] op_sel_hi:[1,1]
    v_cvt_pk_bf16_f32 v64, v64, v65
    v_cvt_pk_bf16_f32 v65, v66, v67
    v_cvt_pk_bf16_f32 v66, v68, v69
    v_cvt_pk_bf16_f32 v67, v70, v71
    ds_write_b128 v207, v[64:67] offset:10240
    v_pk_mul_f32 v[144:145], v[144:145], v[226:227] op_sel:[0,1] op_sel_hi:[1,1]
    v_pk_mul_f32 v[146:147], v[146:147], v[226:227] op_sel:[0,1] op_sel_hi:[1,1]
    v_pk_mul_f32 v[148:149], v[148:149], v[226:227] op_sel:[0,1] op_sel_hi:[1,1]
    s_waitcnt vmcnt(20)
    buffer_load_dwordx4 v6, s[12:15], s56 offen offset:3072 nt lds
    v_pk_mul_f32 v[150:151], v[150:151], v[226:227] op_sel:[0,1] op_sel_hi:[1,1]
    v_cvt_pk_bf16_f32 v144, v144, v145
    v_cvt_pk_bf16_f32 v145, v146, v147
    v_cvt_pk_bf16_f32 v146, v148, v149
    v_cvt_pk_bf16_f32 v147, v150, v151
    ds_write_b128 v207, v[144:147] offset:17408
    v_pk_mul_f32 v[184:185], v[184:185], v[226:227] op_sel:[0,1] op_sel_hi:[1,1]
    v_pk_mul_f32 v[186:187], v[186:187], v[226:227] op_sel:[0,1] op_sel_hi:[1,1]
    v_pk_mul_f32 v[188:189], v[188:189], v[226:227] op_sel:[0,1] op_sel_hi:[1,1]
    v_pk_mul_f32 v[190:191], v[190:191], v[226:227] op_sel:[0,1] op_sel_hi:[1,1]
    v_cvt_pk_bf16_f32 v184, v184, v185
    v_cvt_pk_bf16_f32 v185, v186, v187
    s_add_u32 m0, s49, 8192
    s_xor_b32 s56, s56, 0x1000
    s_waitcnt vmcnt(20)
    buffer_load_dwordx4 v5, s[12:15], s56 offen offset:0 nt lds
    v_cvt_pk_bf16_f32 v186, v188, v189
    v_cvt_pk_bf16_f32 v187, v190, v191
    ds_write_b128 v207, v[184:187] offset:24576
    s_waitcnt lgkmcnt(4)
    .p2align 3
    v_accvgpr_read_b32 v176, a32
    v_accvgpr_read_b32 v177, a33
    v_accvgpr_read_b32 v178, a34
    v_accvgpr_read_b32 v179, a35
    v_accvgpr_read_b32 v180, a36
    v_accvgpr_read_b32 v181, a37
    s_waitcnt vmcnt(20)
    buffer_load_dwordx4 v6, s[12:15], s56 offen offset:1024 nt lds
    v_accvgpr_read_b32 v182, a38
    v_accvgpr_read_b32 v183, a39
    v_pk_mul_f32 v[72:73], v[72:73], v[228:229] op_sel:[0,0] op_sel_hi:[1,0]
    v_pk_mul_f32 v[74:75], v[74:75], v[228:229] op_sel:[0,0] op_sel_hi:[1,0]
    v_pk_mul_f32 v[76:77], v[76:77], v[228:229] op_sel:[0,0] op_sel_hi:[1,0]
    v_pk_mul_f32 v[78:79], v[78:79], v[228:229] op_sel:[0,0] op_sel_hi:[1,0]
    v_cvt_pk_bf16_f32 v72, v72, v73
    v_cvt_pk_bf16_f32 v73, v74, v75
    v_cvt_pk_bf16_f32 v74, v76, v77
    v_cvt_pk_bf16_f32 v75, v78, v79
    ds_write_b128 v207, v[72:75] offset:4096
    v_pk_mul_f32 v[80:81], v[80:81], v[228:229] op_sel:[0,0] op_sel_hi:[1,0]
    s_waitcnt vmcnt(20)
    buffer_load_dwordx4 v5, s[12:15], s56 offen offset:2048 nt lds
    v_pk_mul_f32 v[82:83], v[82:83], v[228:229] op_sel:[0,0] op_sel_hi:[1,0]
    v_pk_mul_f32 v[84:85], v[84:85], v[228:229] op_sel:[0,0] op_sel_hi:[1,0]
    v_pk_mul_f32 v[86:87], v[86:87], v[228:229] op_sel:[0,0] op_sel_hi:[1,0]
    v_cvt_pk_bf16_f32 v80, v80, v81
    v_cvt_pk_bf16_f32 v81, v82, v83
    v_cvt_pk_bf16_f32 v82, v84, v85
    v_cvt_pk_bf16_f32 v83, v86, v87
    ds_write_b128 v207, v[80:83] offset:11264
    v_pk_mul_f32 v[152:153], v[152:153], v[228:229] op_sel:[0,0] op_sel_hi:[1,0]
    v_pk_mul_f32 v[154:155], v[154:155], v[228:229] op_sel:[0,0] op_sel_hi:[1,0]
    v_pk_mul_f32 v[156:157], v[156:157], v[228:229] op_sel:[0,0] op_sel_hi:[1,0]
    v_pk_mul_f32 v[158:159], v[158:159], v[228:229] op_sel:[0,0] op_sel_hi:[1,0]
    s_waitcnt vmcnt(20)
    buffer_load_dwordx4 v6, s[12:15], s56 offen offset:3072 nt lds
    v_cvt_pk_bf16_f32 v152, v152, v153
    v_cvt_pk_bf16_f32 v153, v154, v155
    v_cvt_pk_bf16_f32 v154, v156, v157
    v_cvt_pk_bf16_f32 v155, v158, v159
    ds_write_b128 v207, v[152:155] offset:18432
    v_pk_mul_f32 v[176:177], v[176:177], v[228:229] op_sel:[0,0] op_sel_hi:[1,0]
    v_pk_mul_f32 v[178:179], v[178:179], v[228:229] op_sel:[0,0] op_sel_hi:[1,0]
    v_pk_mul_f32 v[180:181], v[180:181], v[228:229] op_sel:[0,0] op_sel_hi:[1,0]
    v_pk_mul_f32 v[182:183], v[182:183], v[228:229] op_sel:[0,0] op_sel_hi:[1,0]
    v_cvt_pk_bf16_f32 v176, v176, v177
    v_cvt_pk_bf16_f32 v177, v178, v179
    v_cvt_pk_bf16_f32 v178, v180, v181
    s_barrier
    s_add_u32 m0, s48, 16384
    s_xor_b32 s56, s47, 24576
    s_waitcnt vmcnt(20)
    buffer_load_dwordx4 v5, s[8:11], s56 offen offset:0 nt lds
    v_cvt_pk_bf16_f32 v179, v182, v183
    ds_write_b128 v207, v[176:179] offset:25600
    s_waitcnt lgkmcnt(4)
    .p2align 3
    v_accvgpr_read_b32 v184, a40
    v_accvgpr_read_b32 v185, a41
    v_accvgpr_read_b32 v186, a42
    s_waitcnt vmcnt(12)
    buffer_load_dwordx4 v6, s[8:11], s56 offen offset:1024 nt lds
    v_accvgpr_read_b32 v187, a43
    v_accvgpr_read_b32 v188, a44
    v_accvgpr_read_b32 v189, a45
    v_accvgpr_read_b32 v190, a46
    v_accvgpr_read_b32 v191, a47
    v_pk_mul_f32 v[88:89], v[88:89], v[228:229] op_sel:[0,1] op_sel_hi:[1,1]
    v_pk_mul_f32 v[90:91], v[90:91], v[228:229] op_sel:[0,1] op_sel_hi:[1,1]
    v_pk_mul_f32 v[92:93], v[92:93], v[228:229] op_sel:[0,1] op_sel_hi:[1,1]
    s_waitcnt vmcnt(12)
    buffer_load_dwordx4 v5, s[8:11], s56 offen offset:2048 nt lds
    v_pk_mul_f32 v[94:95], v[94:95], v[228:229] op_sel:[0,1] op_sel_hi:[1,1]
    v_cvt_pk_bf16_f32 v88, v88, v89
    v_cvt_pk_bf16_f32 v89, v90, v91
    v_cvt_pk_bf16_f32 v90, v92, v93
    v_cvt_pk_bf16_f32 v91, v94, v95
    ds_write_b128 v207, v[88:91] offset:5120
    v_pk_mul_f32 v[96:97], v[96:97], v[228:229] op_sel:[0,1] op_sel_hi:[1,1]
    v_pk_mul_f32 v[98:99], v[98:99], v[228:229] op_sel:[0,1] op_sel_hi:[1,1]
    s_waitcnt vmcnt(12)
    buffer_load_dwordx4 v6, s[8:11], s56 offen offset:3072 nt lds
    v_pk_mul_f32 v[100:101], v[100:101], v[228:229] op_sel:[0,1] op_sel_hi:[1,1]
    v_pk_mul_f32 v[102:103], v[102:103], v[228:229] op_sel:[0,1] op_sel_hi:[1,1]
    v_cvt_pk_bf16_f32 v96, v96, v97
    v_cvt_pk_bf16_f32 v97, v98, v99
    v_cvt_pk_bf16_f32 v98, v100, v101
    v_cvt_pk_bf16_f32 v99, v102, v103
    ds_write_b128 v207, v[96:99] offset:12288
    v_pk_mul_f32 v[160:161], v[160:161], v[228:229] op_sel:[0,1] op_sel_hi:[1,1]
    s_add_u32 m0, s65, 139264
    s_add_u32 s58, s44, 1
    s_and_b32 s58, s58, 7
    s_lshl_b32 s58, s58, 7
    s_add_u32 s58, s58, 65536
    buffer_load_dwordx4 v197, s[20:23], s58 offen offset:0 lds
    v_pk_mul_f32 v[162:163], v[162:163], v[228:229] op_sel:[0,1] op_sel_hi:[1,1]
    v_pk_mul_f32 v[164:165], v[164:165], v[228:229] op_sel:[0,1] op_sel_hi:[1,1]
    v_pk_mul_f32 v[166:167], v[166:167], v[228:229] op_sel:[0,1] op_sel_hi:[1,1]
    v_cvt_pk_bf16_f32 v160, v160, v161
    v_cvt_pk_bf16_f32 v161, v162, v163
    v_cvt_pk_bf16_f32 v162, v164, v165
    v_cvt_pk_bf16_f32 v163, v166, v167
    ds_write_b128 v207, v[160:163] offset:19456
    s_addk_i32 s58, 7168
    buffer_load_dwordx4 v197, s[20:23], s58 offen offset:1024 lds
    v_pk_mul_f32 v[184:185], v[184:185], v[228:229] op_sel:[0,1] op_sel_hi:[1,1]
    v_pk_mul_f32 v[186:187], v[186:187], v[228:229] op_sel:[0,1] op_sel_hi:[1,1]
    v_pk_mul_f32 v[188:189], v[188:189], v[228:229] op_sel:[0,1] op_sel_hi:[1,1]
    v_pk_mul_f32 v[190:191], v[190:191], v[228:229] op_sel:[0,1] op_sel_hi:[1,1]
    v_cvt_pk_bf16_f32 v184, v184, v185
    v_cvt_pk_bf16_f32 v185, v186, v187
    v_cvt_pk_bf16_f32 v186, v188, v189
    v_cvt_pk_bf16_f32 v187, v190, v191
    s_addk_i32 s58, 7168
    buffer_load_dwordx4 v197, s[20:23], s58 offen offset:2048 lds
    ds_write_b128 v207, v[184:187] offset:26624
    s_waitcnt lgkmcnt(4)
    .p2align 3
    v_accvgpr_read_b32 v176, a48
    v_accvgpr_read_b32 v177, a49
    v_accvgpr_read_b32 v178, a50
    v_accvgpr_read_b32 v179, a51
    v_accvgpr_read_b32 v180, a52
    s_addk_i32 s58, 7168
    buffer_load_dwordx4 v197, s[20:23], s58 offen offset:3072 lds
    v_accvgpr_read_b32 v181, a53
    v_accvgpr_read_b32 v182, a54
    v_accvgpr_read_b32 v183, a55
    v_pk_mul_f32 v[104:105], v[104:105], v[230:231] op_sel:[0,0] op_sel_hi:[1,0]
    v_pk_mul_f32 v[106:107], v[106:107], v[230:231] op_sel:[0,0] op_sel_hi:[1,0]
    v_pk_mul_f32 v[108:109], v[108:109], v[230:231] op_sel:[0,0] op_sel_hi:[1,0]
    v_pk_mul_f32 v[110:111], v[110:111], v[230:231] op_sel:[0,0] op_sel_hi:[1,0]
    v_cvt_pk_bf16_f32 v104, v104, v105
    s_add_u32 m0, s49, 16384
    s_xor_b32 s56, s56, 0x1000
    s_waitcnt vmcnt(16)
    buffer_load_dwordx4 v5, s[8:11], s56 offen offset:0 nt lds
    v_cvt_pk_bf16_f32 v105, v106, v107
    v_cvt_pk_bf16_f32 v106, v108, v109
    v_cvt_pk_bf16_f32 v107, v110, v111
    ds_write_b128 v207, v[104:107] offset:6144
    v_pk_mul_f32 v[112:113], v[112:113], v[230:231] op_sel:[0,0] op_sel_hi:[1,0]
    v_pk_mul_f32 v[114:115], v[114:115], v[230:231] op_sel:[0,0] op_sel_hi:[1,0]
    v_pk_mul_f32 v[116:117], v[116:117], v[230:231] op_sel:[0,0] op_sel_hi:[1,0]
    v_pk_mul_f32 v[118:119], v[118:119], v[230:231] op_sel:[0,0] op_sel_hi:[1,0]
    s_waitcnt vmcnt(16)
    buffer_load_dwordx4 v6, s[8:11], s56 offen offset:1024 nt lds
    v_cvt_pk_bf16_f32 v112, v112, v113
    v_cvt_pk_bf16_f32 v113, v114, v115
    v_cvt_pk_bf16_f32 v114, v116, v117
    v_cvt_pk_bf16_f32 v115, v118, v119
    ds_write_b128 v207, v[112:115] offset:13312
    v_pk_mul_f32 v[168:169], v[168:169], v[230:231] op_sel:[0,0] op_sel_hi:[1,0]
    v_pk_mul_f32 v[170:171], v[170:171], v[230:231] op_sel:[0,0] op_sel_hi:[1,0]
    v_pk_mul_f32 v[172:173], v[172:173], v[230:231] op_sel:[0,0] op_sel_hi:[1,0]
    s_waitcnt vmcnt(16)
    buffer_load_dwordx4 v5, s[8:11], s56 offen offset:2048 nt lds
    v_pk_mul_f32 v[174:175], v[174:175], v[230:231] op_sel:[0,0] op_sel_hi:[1,0]
    v_cvt_pk_bf16_f32 v168, v168, v169
    v_cvt_pk_bf16_f32 v169, v170, v171
    v_cvt_pk_bf16_f32 v170, v172, v173
    v_cvt_pk_bf16_f32 v171, v174, v175
    ds_write_b128 v207, v[168:171] offset:20480
    v_pk_mul_f32 v[176:177], v[176:177], v[230:231] op_sel:[0,0] op_sel_hi:[1,0]
    v_pk_mul_f32 v[178:179], v[178:179], v[230:231] op_sel:[0,0] op_sel_hi:[1,0]
    s_waitcnt vmcnt(16)
    buffer_load_dwordx4 v6, s[8:11], s56 offen offset:3072 nt lds
    v_pk_mul_f32 v[180:181], v[180:181], v[230:231] op_sel:[0,0] op_sel_hi:[1,0]
    v_pk_mul_f32 v[182:183], v[182:183], v[230:231] op_sel:[0,0] op_sel_hi:[1,0]
    v_cvt_pk_bf16_f32 v176, v176, v177
    v_cvt_pk_bf16_f32 v177, v178, v179
    v_cvt_pk_bf16_f32 v178, v180, v181
    v_cvt_pk_bf16_f32 v179, v182, v183
    ds_write_b128 v207, v[176:179] offset:27648
    s_waitcnt lgkmcnt(0)
    s_barrier
    s_add_u32 m0, s48, 24576
    s_xor_b32 s56, s47, 24576
    s_waitcnt vmcnt(16)
    buffer_load_dwordx4 v5, s[12:15], s56 offen offset:0 nt lds
    ds_read_b128 a[0:3], v210 offset:0
    ds_read_b128 a[4:7], v210 offset:1024
    ds_read_b128 a[8:11], v210 offset:2048
    ds_read_b128 a[12:15], v210 offset:3072
    ds_read_b128 a[16:19], v210 offset:4096
    ds_read_b128 a[20:23], v210 offset:5120
    ds_read_b128 a[24:27], v210 offset:6144
    ds_read_b128 a[28:31], v210 offset:28672
    ds_read_b128 a[32:35], v210 offset:29696
    ds_read_b128 a[36:39], v210 offset:30720
    ds_read_b128 a[40:43], v210 offset:31744
    ds_read_b128 a[44:47], v210 offset:32768
    ds_read_b128 a[48:51], v210 offset:33792
    ds_read_b128 a[52:55], v210 offset:34816
    s_waitcnt vmcnt(16)
    buffer_load_dwordx4 v6, s[12:15], s56 offen offset:1024 nt lds
    ds_read_b128 a[56:59], v210 offset:7168
    s_waitcnt lgkmcnt(14)
    ds_read_b128 a[60:63], v210 offset:8192
    s_waitcnt lgkmcnt(14)
    ds_read_b128 a[64:67], v210 offset:9216
    s_waitcnt lgkmcnt(14)
    ds_read_b128 a[68:71], v210 offset:10240
    s_waitcnt lgkmcnt(14)
    ds_read_b128 a[72:75], v210 offset:11264
    s_waitcnt lgkmcnt(14)
    ds_read_b128 a[76:79], v210 offset:12288
    s_waitcnt lgkmcnt(14)
    ds_read_b128 a[80:83], v210 offset:13312
    s_waitcnt lgkmcnt(14)
    ds_read_b128 a[84:87], v210 offset:35840
    s_waitcnt lgkmcnt(14)
    ds_read_b128 a[88:91], v210 offset:36864
    s_waitcnt lgkmcnt(14)
    ds_read_b128 a[92:95], v210 offset:37888
    s_waitcnt lgkmcnt(14)
    ds_read_b128 a[96:99], v210 offset:38912
    s_waitcnt lgkmcnt(14)
    ds_read_b128 a[100:103], v210 offset:39936
    s_waitcnt lgkmcnt(14)
    ds_read_b128 a[104:107], v210 offset:40960
    s_waitcnt lgkmcnt(14)
    ds_read_b128 a[108:111], v210 offset:41984
    s_waitcnt lgkmcnt(14)
    ds_read_b128 a[112:115], v210 offset:14336
    s_waitcnt lgkmcnt(14)
    ds_read_b128 a[116:119], v210 offset:15360
    s_waitcnt lgkmcnt(14)
    ds_read_b128 a[120:123], v210 offset:16384
    s_waitcnt lgkmcnt(14)
    ds_read_b128 a[124:127], v210 offset:17408
    s_waitcnt lgkmcnt(14)
    ds_read_b128 a[128:131], v210 offset:18432
    s_waitcnt lgkmcnt(14)
    ds_read_b128 a[132:135], v210 offset:19456
    s_waitcnt lgkmcnt(14)
    ds_read_b128 a[136:139], v210 offset:20480
    s_waitcnt vmcnt(16)
    buffer_load_dwordx4 v5, s[12:15], s56 offen offset:2048 nt lds
    s_waitcnt lgkmcnt(14)
    ds_read_b128 a[140:143], v210 offset:43008
    s_waitcnt lgkmcnt(14)
    ds_read_b128 a[144:147], v210 offset:44032
    s_waitcnt lgkmcnt(14)
    ds_read_b128 a[148:151], v210 offset:45056
    s_waitcnt lgkmcnt(14)
    ds_read_b128 a[152:155], v210 offset:46080
    s_waitcnt lgkmcnt(14)
    ds_read_b128 a[156:159], v210 offset:47104
    s_waitcnt lgkmcnt(14)
    ds_read_b128 a[160:163], v210 offset:48128
    s_waitcnt lgkmcnt(14)
    ds_read_b128 a[164:167], v210 offset:49152
    s_waitcnt lgkmcnt(14)
    ds_read_b128 a[168:171], v210 offset:21504
    s_waitcnt lgkmcnt(14)
    ds_read_b128 a[172:175], v210 offset:22528
    s_waitcnt lgkmcnt(14)
    ds_read_b128 a[176:179], v210 offset:23552
    s_waitcnt lgkmcnt(14)
    ds_read_b128 a[180:183], v210 offset:24576
    s_waitcnt lgkmcnt(14)
    ds_read_b128 a[184:187], v210 offset:25600
    s_waitcnt lgkmcnt(14)
    ds_read_b128 a[188:191], v210 offset:26624
    s_waitcnt lgkmcnt(14)
    ds_read_b128 a[192:195], v210 offset:27648
    s_waitcnt vmcnt(16)
    buffer_load_dwordx4 v6, s[12:15], s56 offen offset:3072 nt lds
    s_waitcnt lgkmcnt(14)
    ds_read_b128 a[196:199], v210 offset:50176
    s_waitcnt lgkmcnt(14)
    ds_read_b128 a[200:203], v210 offset:51200
    s_waitcnt lgkmcnt(14)
    ds_read_b128 a[204:207], v210 offset:52224
    s_waitcnt lgkmcnt(14)
    ds_read_b128 a[208:211], v210 offset:53248
    s_waitcnt lgkmcnt(14)
    ds_read_b128 a[212:215], v210 offset:54272
    s_waitcnt lgkmcnt(14)
    ds_read_b128 a[216:219], v210 offset:55296
    s_waitcnt lgkmcnt(14)
    ds_read_b128 a[220:223], v210 offset:56320
    s_waitcnt lgkmcnt(0)
    ds_read_b64_tr_b16 a[224:225], v195 offset:0
    ds_read_b64_tr_b16 a[226:227], v195 offset:2048
    s_add_u32 m0, s65, 147456
    s_add_u32 s58, s44, 1
    s_and_b32 s58, s58, 7
    s_lshl_b32 s58, s58, 7
    s_add_u32 s58, s58, 98304
    buffer_load_dwordx4 v197, s[20:23], s58 offen offset:0 lds
    ds_read_b64_tr_b16 a[228:229], v196 offset:0
    ds_read_b64_tr_b16 a[230:231], v196 offset:2048
    s_waitcnt lgkmcnt(2)
    v_mfma_f32_16x16x32_bf16 v[120:123], a[224:227], a[0:3], 0
    ds_read_b64_tr_b16 a[232:233], v195 offset:4096
    ds_read_b64_tr_b16 a[234:235], v195 offset:6144
    s_addk_i32 s58, 7168
    buffer_load_dwordx4 v197, s[20:23], s58 offen offset:1024 lds
    v_mfma_f32_16x16x32_bf16 v[124:127], a[224:227], a[4:7], 0
    v_mfma_f32_16x16x32_bf16 v[128:131], a[224:227], a[8:11], 0
    v_mfma_f32_16x16x32_bf16 v[132:135], a[224:227], a[12:15], 0
    s_addk_i32 s58, 7168
    buffer_load_dwordx4 v197, s[20:23], s58 offen offset:2048 lds
    v_mfma_f32_16x16x32_bf16 v[136:139], a[224:227], a[16:19], 0
    v_mfma_f32_16x16x32_bf16 v[140:143], a[224:227], a[20:23], 0
    v_mfma_f32_16x16x32_bf16 v[144:147], a[224:227], a[24:27], 0
    s_addk_i32 s58, 7168
    buffer_load_dwordx4 v197, s[20:23], s58 offen offset:3072 lds
    s_waitcnt lgkmcnt(2)
    v_mfma_f32_16x16x32_bf16 v[148:151], a[228:231], a[0:3], 0
    ds_read_b64_tr_b16 a[236:237], v196 offset:4096
    ds_read_b64_tr_b16 a[238:239], v196 offset:6144
    v_mfma_f32_16x16x32_bf16 v[152:155], a[228:231], a[4:7], 0
    s_add_u32 m0, s49, 24576
    s_xor_b32 s56, s56, 0x1000
    s_waitcnt vmcnt(20)
    buffer_load_dwordx4 v5, s[12:15], s56 offen offset:0 nt lds
    v_mfma_f32_16x16x32_bf16 v[156:159], a[228:231], a[8:11], 0
    v_mfma_f32_16x16x32_bf16 v[160:163], a[228:231], a[12:15], 0
    v_mfma_f32_16x16x32_bf16 v[164:167], a[228:231], a[16:19], 0
    s_waitcnt vmcnt(20)
    buffer_load_dwordx4 v6, s[12:15], s56 offen offset:1024 nt lds
    v_mfma_f32_16x16x32_bf16 v[168:171], a[228:231], a[20:23], 0
    v_mfma_f32_16x16x32_bf16 v[172:175], a[228:231], a[24:27], 0
    s_waitcnt vmcnt(20)
    buffer_load_dwordx4 v5, s[12:15], s56 offen offset:2048 nt lds
    s_waitcnt lgkmcnt(2)
    v_mfma_f32_16x16x32_bf16 v[120:123], a[232:235], a[28:31], v[120:123]
    ds_read_b64_tr_b16 a[240:241], v195 offset:8192
    ds_read_b64_tr_b16 a[242:243], v195 offset:10240
    v_mfma_f32_16x16x32_bf16 v[124:127], a[232:235], a[32:35], v[124:127]
    v_mfma_f32_16x16x32_bf16 v[128:131], a[232:235], a[36:39], v[128:131]
    s_waitcnt vmcnt(20)
    buffer_load_dwordx4 v6, s[12:15], s56 offen offset:3072 nt lds
    v_mfma_f32_16x16x32_bf16 v[132:135], a[232:235], a[40:43], v[132:135]
    v_mfma_f32_16x16x32_bf16 v[136:139], a[232:235], a[44:47], v[136:139]
    v_mfma_f32_16x16x32_bf16 v[140:143], a[232:235], a[48:51], v[140:143]
    s_barrier
    s_add_u32 m0, s48, 0
    s_xor_b32 s56, s47, 32768
    s_waitcnt vmcnt(20)
    buffer_load_dwordx4 v5, s[8:11], s56 offen offset:0 nt lds
    v_mfma_f32_16x16x32_bf16 v[144:147], a[232:235], a[52:55], v[144:147]
    s_waitcnt vmcnt(16)
    buffer_load_dwordx4 v6, s[8:11], s56 offen offset:1024 nt lds
    s_waitcnt lgkmcnt(2)
    v_mfma_f32_16x16x32_bf16 v[148:151], a[236:239], a[28:31], v[148:151]
    ds_read_b64_tr_b16 a[244:245], v196 offset:8192
    ds_read_b64_tr_b16 a[246:247], v196 offset:10240
    v_mfma_f32_16x16x32_bf16 v[152:155], a[236:239], a[32:35], v[152:155]
    s_waitcnt vmcnt(16)
    buffer_load_dwordx4 v5, s[8:11], s56 offen offset:2048 nt lds
    v_mfma_f32_16x16x32_bf16 v[156:159], a[236:239], a[36:39], v[156:159]
    v_mfma_f32_16x16x32_bf16 v[160:163], a[236:239], a[40:43], v[160:163]
    s_waitcnt vmcnt(16)
    buffer_load_dwordx4 v6, s[8:11], s56 offen offset:3072 nt lds
    v_mfma_f32_16x16x32_bf16 v[164:167], a[236:239], a[44:47], v[164:167]
    v_mfma_f32_16x16x32_bf16 v[168:171], a[236:239], a[48:51], v[168:171]
    s_add_u32 m0, s65, 155648
    s_add_u32 s58, s44, 2
    s_and_b32 s58, s58, 7
    s_lshl_b32 s58, s58, 7
    buffer_load_dwordx4 v197, s[20:23], s58 offen offset:0 lds
    v_mfma_f32_16x16x32_bf16 v[172:175], a[236:239], a[52:55], v[172:175]
    s_addk_i32 s58, 7168
    buffer_load_dwordx4 v197, s[20:23], s58 offen offset:1024 lds
    s_waitcnt lgkmcnt(2)
    v_mfma_f32_16x16x32_bf16 v[120:123], a[240:243], a[56:59], v[120:123]
    ds_read_b64_tr_b16 a[248:249], v195 offset:12288
    ds_read_b64_tr_b16 a[250:251], v195 offset:14336
    v_mfma_f32_16x16x32_bf16 v[124:127], a[240:243], a[60:63], v[124:127]
    s_addk_i32 s58, 7168
    buffer_load_dwordx4 v197, s[20:23], s58 offen offset:2048 lds
    v_mfma_f32_16x16x32_bf16 v[128:131], a[240:243], a[64:67], v[128:131]
    v_mfma_f32_16x16x32_bf16 v[132:135], a[240:243], a[68:71], v[132:135]
    s_addk_i32 s58, 7168
    buffer_load_dwordx4 v197, s[20:23], s58 offen offset:3072 lds
    v_mfma_f32_16x16x32_bf16 v[136:139], a[240:243], a[72:75], v[136:139]
    v_mfma_f32_16x16x32_bf16 v[140:143], a[240:243], a[76:79], v[140:143]
    s_add_u32 m0, s49, 0
    s_xor_b32 s56, s56, 0x1000
    s_waitcnt vmcnt(20)
    buffer_load_dwordx4 v5, s[8:11], s56 offen offset:0 nt lds
    v_mfma_f32_16x16x32_bf16 v[144:147], a[240:243], a[80:83], v[144:147]
    s_waitcnt vmcnt(20)
    buffer_load_dwordx4 v6, s[8:11], s56 offen offset:1024 nt lds
    s_waitcnt lgkmcnt(2)
    v_mfma_f32_16x16x32_bf16 v[148:151], a[244:247], a[56:59], v[148:151]
    ds_read_b64_tr_b16 a[252:253], v196 offset:12288
    ds_read_b64_tr_b16 a[254:255], v196 offset:14336
    v_mfma_f32_16x16x32_bf16 v[152:155], a[244:247], a[60:63], v[152:155]
    s_waitcnt vmcnt(20)
    buffer_load_dwordx4 v5, s[8:11], s56 offen offset:2048 nt lds
    v_mfma_f32_16x16x32_bf16 v[156:159], a[244:247], a[64:67], v[156:159]
    v_mfma_f32_16x16x32_bf16 v[160:163], a[244:247], a[68:71], v[160:163]
    s_waitcnt vmcnt(20)
    buffer_load_dwordx4 v6, s[8:11], s56 offen offset:3072 nt lds
    v_mfma_f32_16x16x32_bf16 v[164:167], a[244:247], a[72:75], v[164:167]
    v_mfma_f32_16x16x32_bf16 v[168:171], a[244:247], a[76:79], v[168:171]
    s_barrier
    s_add_u32 m0, s48, 8192
    s_xor_b32 s56, s47, 32768
    s_waitcnt vmcnt(20)
    buffer_load_dwordx4 v5, s[12:15], s56 offen offset:0 nt lds
    v_mfma_f32_16x16x32_bf16 v[172:175], a[244:247], a[80:83], v[172:175]
    s_waitcnt vmcnt(16)
    buffer_load_dwordx4 v6, s[12:15], s56 offen offset:1024 nt lds
    s_waitcnt lgkmcnt(2)
    v_mfma_f32_16x16x32_bf16 v[120:123], a[248:251], a[84:87], v[120:123]
    ds_read_b64_tr_b16 a[224:225], v195 offset:16384
    ds_read_b64_tr_b16 a[226:227], v195 offset:18432
    v_mfma_f32_16x16x32_bf16 v[124:127], a[248:251], a[88:91], v[124:127]
    s_waitcnt vmcnt(16)
    buffer_load_dwordx4 v5, s[12:15], s56 offen offset:2048 nt lds
    v_mfma_f32_16x16x32_bf16 v[128:131], a[248:251], a[92:95], v[128:131]
    v_mfma_f32_16x16x32_bf16 v[132:135], a[248:251], a[96:99], v[132:135]
    s_waitcnt vmcnt(16)
    buffer_load_dwordx4 v6, s[12:15], s56 offen offset:3072 nt lds
    v_mfma_f32_16x16x32_bf16 v[136:139], a[248:251], a[100:103], v[136:139]
    v_mfma_f32_16x16x32_bf16 v[140:143], a[248:251], a[104:107], v[140:143]
    s_add_u32 m0, s65, 122880
    s_add_u32 s58, s44, 2
    s_and_b32 s58, s58, 7
    s_lshl_b32 s58, s58, 7
    s_add_u32 s58, s58, 32768
    buffer_load_dwordx4 v197, s[20:23], s58 offen offset:0 lds
    v_mfma_f32_16x16x32_bf16 v[144:147], a[248:251], a[108:111], v[144:147]
    s_waitcnt lgkmcnt(2)
    v_mfma_f32_16x16x32_bf16 v[148:151], a[252:255], a[84:87], v[148:151]
    ds_read_b64_tr_b16 a[228:229], v196 offset:16384
    ds_read_b64_tr_b16 a[230:231], v196 offset:18432
    s_addk_i32 s58, 7168
    buffer_load_dwordx4 v197, s[20:23], s58 offen offset:1024 lds
    v_mfma_f32_16x16x32_bf16 v[152:155], a[252:255], a[88:91], v[152:155]
    v_mfma_f32_16x16x32_bf16 v[156:159], a[252:255], a[92:95], v[156:159]
    s_addk_i32 s58, 7168
    buffer_load_dwordx4 v197, s[20:23], s58 offen offset:2048 lds
    v_mfma_f32_16x16x32_bf16 v[160:163], a[252:255], a[96:99], v[160:163]
    s_addk_i32 s58, 7168
    buffer_load_dwordx4 v197, s[20:23], s58 offen offset:3072 lds
    v_mfma_f32_16x16x32_bf16 v[164:167], a[252:255], a[100:103], v[164:167]
    v_mfma_f32_16x16x32_bf16 v[168:171], a[252:255], a[104:107], v[168:171]
    s_add_u32 m0, s49, 8192
    s_xor_b32 s56, s56, 0x1000
    s_waitcnt vmcnt(20)
    buffer_load_dwordx4 v5, s[12:15], s56 offen offset:0 nt lds
    v_mfma_f32_16x16x32_bf16 v[172:175], a[252:255], a[108:111], v[172:175]
    s_waitcnt lgkmcnt(2)
    v_mfma_f32_16x16x32_bf16 v[120:123], a[224:227], a[112:115], v[120:123]
    ds_read_b64_tr_b16 a[232:233], v195 offset:20480
    ds_read_b64_tr_b16 a[234:235], v195 offset:22528
    s_waitcnt vmcnt(20)
    buffer_load_dwordx4 v6, s[12:15], s56 offen offset:1024 nt lds
    v_mfma_f32_16x16x32_bf16 v[124:127], a[224:227], a[116:119], v[124:127]
    v_mfma_f32_16x16x32_bf16 v[128:131], a[224:227], a[120:123], v[128:131]
    s_waitcnt vmcnt(20)
    buffer_load_dwordx4 v5, s[12:15], s56 offen offset:2048 nt lds
    v_mfma_f32_16x16x32_bf16 v[132:135], a[224:227], a[124:127], v[132:135]
    v_mfma_f32_16x16x32_bf16 v[136:139], a[224:227], a[128:131], v[136:139]
    s_waitcnt vmcnt(20)
    buffer_load_dwordx4 v6, s[12:15], s56 offen offset:3072 nt lds
    v_mfma_f32_16x16x32_bf16 v[140:143], a[224:227], a[132:135], v[140:143]
    v_mfma_f32_16x16x32_bf16 v[144:147], a[224:227], a[136:139], v[144:147]
    s_barrier
    s_add_u32 m0, s48, 16384
    s_xor_b32 s56, s47, 40960
    s_waitcnt vmcnt(20)
    buffer_load_dwordx4 v5, s[8:11], s56 offen offset:0 nt lds
    s_waitcnt lgkmcnt(2)
    v_mfma_f32_16x16x32_bf16 v[148:151], a[228:231], a[112:115], v[148:151]
    ds_read_b64_tr_b16 a[236:237], v196 offset:20480
    ds_read_b64_tr_b16 a[238:239], v196 offset:22528
    s_waitcnt vmcnt(16)
    buffer_load_dwordx4 v6, s[8:11], s56 offen offset:1024 nt lds
    v_mfma_f32_16x16x32_bf16 v[152:155], a[228:231], a[116:119], v[152:155]
    v_mfma_f32_16x16x32_bf16 v[156:159], a[228:231], a[120:123], v[156:159]
    s_waitcnt vmcnt(16)
    buffer_load_dwordx4 v5, s[8:11], s56 offen offset:2048 nt lds
    v_mfma_f32_16x16x32_bf16 v[160:163], a[228:231], a[124:127], v[160:163]
    v_mfma_f32_16x16x32_bf16 v[164:167], a[228:231], a[128:131], v[164:167]
    s_waitcnt vmcnt(16)
    buffer_load_dwordx4 v6, s[8:11], s56 offen offset:3072 nt lds
    v_mfma_f32_16x16x32_bf16 v[168:171], a[228:231], a[132:135], v[168:171]
    v_mfma_f32_16x16x32_bf16 v[172:175], a[228:231], a[136:139], v[172:175]
    s_add_u32 m0, s65, 131072
    s_add_u32 s58, s44, 2
    s_and_b32 s58, s58, 7
    s_lshl_b32 s58, s58, 7
    s_add_u32 s58, s58, 65536
    buffer_load_dwordx4 v197, s[20:23], s58 offen offset:0 lds
    s_waitcnt lgkmcnt(2)
    v_mfma_f32_16x16x32_bf16 v[120:123], a[232:235], a[140:143], v[120:123]
    ds_read_b64_tr_b16 a[240:241], v195 offset:24576
    ds_read_b64_tr_b16 a[242:243], v195 offset:26624
    v_mfma_f32_16x16x32_bf16 v[124:127], a[232:235], a[144:147], v[124:127]
    s_addk_i32 s58, 7168
    buffer_load_dwordx4 v197, s[20:23], s58 offen offset:1024 lds
    v_mfma_f32_16x16x32_bf16 v[128:131], a[232:235], a[148:151], v[128:131]
    v_mfma_f32_16x16x32_bf16 v[132:135], a[232:235], a[152:155], v[132:135]
    s_addk_i32 s58, 7168
    buffer_load_dwordx4 v197, s[20:23], s58 offen offset:2048 lds
    v_mfma_f32_16x16x32_bf16 v[136:139], a[232:235], a[156:159], v[136:139]
    s_addk_i32 s58, 7168
    buffer_load_dwordx4 v197, s[20:23], s58 offen offset:3072 lds
    v_mfma_f32_16x16x32_bf16 v[140:143], a[232:235], a[160:163], v[140:143]
    v_mfma_f32_16x16x32_bf16 v[144:147], a[232:235], a[164:167], v[144:147]
    s_add_u32 m0, s49, 16384
    s_xor_b32 s56, s56, 0x1000
    s_waitcnt vmcnt(20)
    buffer_load_dwordx4 v5, s[8:11], s56 offen offset:0 nt lds
    s_waitcnt lgkmcnt(2)
    v_mfma_f32_16x16x32_bf16 v[148:151], a[236:239], a[140:143], v[148:151]
    ds_read_b64_tr_b16 a[244:245], v196 offset:24576
    ds_read_b64_tr_b16 a[246:247], v196 offset:26624
    v_mfma_f32_16x16x32_bf16 v[152:155], a[236:239], a[144:147], v[152:155]
    s_waitcnt vmcnt(20)
    buffer_load_dwordx4 v6, s[8:11], s56 offen offset:1024 nt lds
    v_mfma_f32_16x16x32_bf16 v[156:159], a[236:239], a[148:151], v[156:159]
    v_mfma_f32_16x16x32_bf16 v[160:163], a[236:239], a[152:155], v[160:163]
    s_waitcnt vmcnt(20)
    buffer_load_dwordx4 v5, s[8:11], s56 offen offset:2048 nt lds
    v_mfma_f32_16x16x32_bf16 v[164:167], a[236:239], a[156:159], v[164:167]
    v_mfma_f32_16x16x32_bf16 v[168:171], a[236:239], a[160:163], v[168:171]
    s_waitcnt vmcnt(20)
    buffer_load_dwordx4 v6, s[8:11], s56 offen offset:3072 nt lds
    v_mfma_f32_16x16x32_bf16 v[172:175], a[236:239], a[164:167], v[172:175]
    s_waitcnt lgkmcnt(2)
    v_mfma_f32_16x16x32_bf16 v[120:123], a[240:243], a[168:171], v[120:123]
    ds_read_b64_tr_b16 a[248:249], v195 offset:28672
    ds_read_b64_tr_b16 a[250:251], v195 offset:30720
    s_barrier
    s_add_u32 m0, s48, 24576
    s_xor_b32 s56, s47, 40960
    s_waitcnt vmcnt(20)
    buffer_load_dwordx4 v5, s[12:15], s56 offen offset:0 nt lds
    v_mfma_f32_16x16x32_bf16 v[124:127], a[240:243], a[172:175], v[124:127]
    v_mfma_f32_16x16x32_bf16 v[128:131], a[240:243], a[176:179], v[128:131]
    s_waitcnt vmcnt(16)
    buffer_load_dwordx4 v6, s[12:15], s56 offen offset:1024 nt lds
    v_mfma_f32_16x16x32_bf16 v[132:135], a[240:243], a[180:183], v[132:135]
    v_mfma_f32_16x16x32_bf16 v[136:139], a[240:243], a[184:187], v[136:139]
    v_mfma_f32_16x16x32_bf16 v[140:143], a[240:243], a[188:191], v[140:143]
    s_waitcnt vmcnt(16)
    buffer_load_dwordx4 v5, s[12:15], s56 offen offset:2048 nt lds
    v_mfma_f32_16x16x32_bf16 v[144:147], a[240:243], a[192:195], v[144:147]
    s_waitcnt lgkmcnt(2)
    v_mfma_f32_16x16x32_bf16 v[148:151], a[244:247], a[168:171], v[148:151]
    ds_read_b64_tr_b16 a[252:253], v196 offset:28672
    ds_read_b64_tr_b16 a[254:255], v196 offset:30720
    v_mfma_f32_16x16x32_bf16 v[152:155], a[244:247], a[172:175], v[152:155]
    s_waitcnt vmcnt(16)
    buffer_load_dwordx4 v6, s[12:15], s56 offen offset:3072 nt lds
    v_mfma_f32_16x16x32_bf16 v[156:159], a[244:247], a[176:179], v[156:159]
    v_mfma_f32_16x16x32_bf16 v[160:163], a[244:247], a[180:183], v[160:163]
    v_mfma_f32_16x16x32_bf16 v[164:167], a[244:247], a[184:187], v[164:167]
    s_add_u32 m0, s49, 24576
    s_xor_b32 s56, s56, 0x1000
    s_waitcnt vmcnt(16)
    buffer_load_dwordx4 v5, s[12:15], s56 offen offset:0 nt lds
    v_mfma_f32_16x16x32_bf16 v[168:171], a[244:247], a[188:191], v[168:171]
    v_mfma_f32_16x16x32_bf16 v[172:175], a[244:247], a[192:195], v[172:175]
    s_waitcnt lgkmcnt(2)
    v_mfma_f32_16x16x32_bf16 v[120:123], a[248:251], a[196:199], v[120:123]
    ds_read_b64_tr_b16 a[224:225], v195 offset:32768
    ds_read_b64_tr_b16 a[226:227], v195 offset:34816
    s_waitcnt vmcnt(16)
    buffer_load_dwordx4 v6, s[12:15], s56 offen offset:1024 nt lds
    v_mfma_f32_16x16x32_bf16 v[124:127], a[248:251], a[200:203], v[124:127]
    v_mfma_f32_16x16x32_bf16 v[128:131], a[248:251], a[204:207], v[128:131]
    v_mfma_f32_16x16x32_bf16 v[132:135], a[248:251], a[208:211], v[132:135]
    s_waitcnt vmcnt(16)
    buffer_load_dwordx4 v5, s[12:15], s56 offen offset:2048 nt lds
    v_mfma_f32_16x16x32_bf16 v[136:139], a[248:251], a[212:215], v[136:139]
    v_mfma_f32_16x16x32_bf16 v[140:143], a[248:251], a[216:219], v[140:143]
    v_mfma_f32_16x16x32_bf16 v[144:147], a[248:251], a[220:223], v[144:147]
    s_waitcnt vmcnt(16)
    buffer_load_dwordx4 v6, s[12:15], s56 offen offset:3072 nt lds
    s_waitcnt lgkmcnt(2)
    v_mfma_f32_16x16x32_bf16 v[148:151], a[252:255], a[196:199], v[148:151]
    ds_read_b64_tr_b16 a[228:229], v196 offset:32768
    ds_read_b64_tr_b16 a[230:231], v196 offset:34816
    v_mfma_f32_16x16x32_bf16 v[152:155], a[252:255], a[200:203], v[152:155]
    v_mfma_f32_16x16x32_bf16 v[156:159], a[252:255], a[204:207], v[156:159]
    v_cvt_pk_bf16_f32 v8, v120, v121
    v_cvt_pk_bf16_f32 v9, v122, v123
    v_cvt_pk_bf16_f32 v10, v124, v125
    s_barrier
    s_add_u32 m0, s48, 0
    s_xor_b32 s56, s47, 49152
    s_waitcnt vmcnt(16)
    buffer_load_dwordx4 v5, s[8:11], s56 offen offset:0 nt lds
    v_mfma_f32_16x16x32_bf16 v[160:163], a[252:255], a[208:211], v[160:163]
    v_cvt_pk_bf16_f32 v11, v126, v127
    v_cvt_pk_bf16_f32 v12, v128, v129
    v_cvt_pk_bf16_f32 v13, v130, v131
    s_waitcnt vmcnt(12)
    buffer_load_dwordx4 v6, s[8:11], s56 offen offset:1024 nt lds
    v_mfma_f32_16x16x32_bf16 v[164:167], a[252:255], a[212:215], v[164:167]
    v_cvt_pk_bf16_f32 v14, v132, v133
    v_cvt_pk_bf16_f32 v15, v134, v135
    v_cvt_pk_bf16_f32 v16, v136, v137
    v_mfma_f32_16x16x32_bf16 v[168:171], a[252:255], a[216:219], v[168:171]
    v_cvt_pk_bf16_f32 v17, v138, v139
    v_cvt_pk_bf16_f32 v18, v140, v141
    v_cvt_pk_bf16_f32 v19, v142, v143
    s_waitcnt vmcnt(12)
    buffer_load_dwordx4 v5, s[8:11], s56 offen offset:2048 nt lds
    v_mfma_f32_16x16x32_bf16 v[172:175], a[252:255], a[220:223], v[172:175]
    v_cvt_pk_bf16_f32 v20, v144, v145
    v_cvt_pk_bf16_f32 v21, v146, v147
    s_waitcnt lgkmcnt(2)
    v_mfma_f32_16x16x32_bf16 v[120:123], a[224:227], a[0:3], 0
    ds_read_b64_tr_b16 a[232:233], v195 offset:36864
    ds_read_b64_tr_b16 a[234:235], v195 offset:38912
    s_waitcnt vmcnt(12)
    buffer_load_dwordx4 v6, s[8:11], s56 offen offset:3072 nt lds
    v_mfma_f32_16x16x32_bf16 v[124:127], a[224:227], a[4:7], 0
    v_mfma_f32_16x16x32_bf16 v[128:131], a[224:227], a[8:11], 0
    v_cvt_pk_bf16_f32 v148, v148, v149
    v_cvt_pk_bf16_f32 v149, v150, v151
    v_cvt_pk_bf16_f32 v150, v152, v153
    v_cvt_pk_bf16_f32 v151, v154, v155
    s_add_u32 m0, s65, 139264
    s_add_u32 s58, s44, 2
    s_and_b32 s58, s58, 7
    s_lshl_b32 s58, s58, 7
    s_add_u32 s58, s58, 98304
    buffer_load_dwordx4 v197, s[20:23], s58 offen offset:0 lds
    v_mfma_f32_16x16x32_bf16 v[132:135], a[224:227], a[12:15], 0
    v_cvt_pk_bf16_f32 v152, v156, v157
    v_cvt_pk_bf16_f32 v153, v158, v159
    v_cvt_pk_bf16_f32 v154, v160, v161
    v_cvt_pk_bf16_f32 v155, v162, v163
    v_mfma_f32_16x16x32_bf16 v[136:139], a[224:227], a[16:19], 0
    v_cvt_pk_bf16_f32 v156, v164, v165
    v_cvt_pk_bf16_f32 v157, v166, v167
    v_cvt_pk_bf16_f32 v158, v168, v169
    s_addk_i32 s58, 7168
    buffer_load_dwordx4 v197, s[20:23], s58 offen offset:1024 lds
    v_mfma_f32_16x16x32_bf16 v[140:143], a[224:227], a[20:23], 0
    v_cvt_pk_bf16_f32 v159, v170, v171
    v_cvt_pk_bf16_f32 v160, v172, v173
    v_cvt_pk_bf16_f32 v161, v174, v175
    ds_write_b128 v208, v[148:151] offset:0
    v_mfma_f32_16x16x32_bf16 v[144:147], a[224:227], a[24:27], 0
    ds_write_b128 v208, v[152:155] offset:1024
    ds_write_b128 v208, v[156:159] offset:2048
    ds_write_b64 v209, v[160:161] offset:3072
    s_addk_i32 s58, 7168
    buffer_load_dwordx4 v197, s[20:23], s58 offen offset:2048 lds
    s_waitcnt lgkmcnt(0)
    v_mfma_f32_16x16x32_bf16 v[148:151], a[228:231], a[0:3], 0
    ds_read_b64_tr_b16 a[236:237], v196 offset:36864
    ds_read_b64_tr_b16 a[238:239], v196 offset:38912
    v_mfma_f32_16x16x32_bf16 v[152:155], a[228:231], a[4:7], 0
    s_addk_i32 s58, 7168
    buffer_load_dwordx4 v197, s[20:23], s58 offen offset:3072 lds
    v_mfma_f32_16x16x32_bf16 v[156:159], a[228:231], a[8:11], 0
    v_mfma_f32_16x16x32_bf16 v[160:163], a[228:231], a[12:15], 0
    s_add_u32 m0, s49, 0
    s_xor_b32 s56, s56, 0x1000
    s_waitcnt vmcnt(16)
    buffer_load_dwordx4 v5, s[8:11], s56 offen offset:0 nt lds
    v_mfma_f32_16x16x32_bf16 v[164:167], a[228:231], a[16:19], 0
    v_mfma_f32_16x16x32_bf16 v[168:171], a[228:231], a[20:23], 0
    s_waitcnt vmcnt(16)
    buffer_load_dwordx4 v6, s[8:11], s56 offen offset:1024 nt lds
    v_mfma_f32_16x16x32_bf16 v[172:175], a[228:231], a[24:27], 0
    v_mfma_f32_16x16x32_bf16 v[120:123], a[232:235], a[28:31], v[120:123]
    ds_read_b64_tr_b16 a[240:241], v195 offset:0
    ds_read_b64_tr_b16 a[242:243], v195 offset:2048
    s_waitcnt vmcnt(16)
    buffer_load_dwordx4 v5, s[8:11], s56 offen offset:2048 nt lds
    v_mfma_f32_16x16x32_bf16 v[124:127], a[232:235], a[32:35], v[124:127]
    v_mfma_f32_16x16x32_bf16 v[128:131], a[232:235], a[36:39], v[128:131]
    s_waitcnt vmcnt(16)
    buffer_load_dwordx4 v6, s[8:11], s56 offen offset:3072 nt lds
    v_mfma_f32_16x16x32_bf16 v[132:135], a[232:235], a[40:43], v[132:135]
    v_mfma_f32_16x16x32_bf16 v[136:139], a[232:235], a[44:47], v[136:139]
    s_barrier
    s_add_u32 m0, s48, 8192
    s_xor_b32 s56, s47, 49152
    s_waitcnt vmcnt(13)
    buffer_load_dwordx4 v5, s[12:15], s56 offen offset:0 nt lds
    v_mfma_f32_16x16x32_bf16 v[140:143], a[232:235], a[48:51], v[140:143]
    v_mfma_f32_16x16x32_bf16 v[144:147], a[232:235], a[52:55], v[144:147]
    s_waitcnt vmcnt(13)
    buffer_load_dwordx4 v6, s[12:15], s56 offen offset:1024 nt lds
    s_waitcnt lgkmcnt(2)
    v_mfma_f32_16x16x32_bf16 v[148:151], a[236:239], a[28:31], v[148:151]
    ds_read_b64_tr_b16 a[244:245], v196 offset:0
    ds_read_b64_tr_b16 a[246:247], v196 offset:2048
    v_mfma_f32_16x16x32_bf16 v[152:155], a[236:239], a[32:35], v[152:155]
    s_waitcnt vmcnt(13)
    buffer_load_dwordx4 v5, s[12:15], s56 offen offset:2048 nt lds
    v_mfma_f32_16x16x32_bf16 v[156:159], a[236:239], a[36:39], v[156:159]
    v_mfma_f32_16x16x32_bf16 v[160:163], a[236:239], a[40:43], v[160:163]
    s_waitcnt vmcnt(13)
    buffer_load_dwordx4 v6, s[12:15], s56 offen offset:3072 nt lds
    v_mfma_f32_16x16x32_bf16 v[164:167], a[236:239], a[44:47], v[164:167]
    v_mfma_f32_16x16x32_bf16 v[168:171], a[236:239], a[48:51], v[168:171]
    s_add_u32 m0, s65, 147456
    s_add_u32 s58, s44, 3
    s_and_b32 s58, s58, 7
    s_lshl_b32 s58, s58, 7
    buffer_load_dwordx4 v197, s[20:23], s58 offen offset:0 lds
    v_mfma_f32_16x16x32_bf16 v[172:175], a[236:239], a[52:55], v[172:175]
    s_waitcnt lgkmcnt(2)
    v_mfma_f32_16x16x32_bf16 v[120:123], a[240:243], a[56:59], v[120:123]
    ds_read_b64_tr_b16 a[248:249], v195 offset:4096
    ds_read_b64_tr_b16 a[250:251], v195 offset:6144
    s_addk_i32 s58, 7168
    buffer_load_dwordx4 v197, s[20:23], s58 offen offset:1024 lds
    v_mfma_f32_16x16x32_bf16 v[124:127], a[240:243], a[60:63], v[124:127]
    v_mfma_f32_16x16x32_bf16 v[128:131], a[240:243], a[64:67], v[128:131]
    s_addk_i32 s58, 7168
    buffer_load_dwordx4 v197, s[20:23], s58 offen offset:2048 lds
    v_mfma_f32_16x16x32_bf16 v[132:135], a[240:243], a[68:71], v[132:135]
    v_mfma_f32_16x16x32_bf16 v[136:139], a[240:243], a[72:75], v[136:139]
    s_addk_i32 s58, 7168
    buffer_load_dwordx4 v197, s[20:23], s58 offen offset:3072 lds
    v_mfma_f32_16x16x32_bf16 v[140:143], a[240:243], a[76:79], v[140:143]
    v_mfma_f32_16x16x32_bf16 v[144:147], a[240:243], a[80:83], v[144:147]
    s_add_u32 m0, s49, 8192
    s_xor_b32 s56, s56, 0x1000
    s_waitcnt vmcnt(17)
    buffer_load_dwordx4 v5, s[12:15], s56 offen offset:0 nt lds
    s_waitcnt lgkmcnt(2)
    v_mfma_f32_16x16x32_bf16 v[148:151], a[244:247], a[56:59], v[148:151]
    ds_read_b64_tr_b16 a[252:253], v196 offset:4096
    ds_read_b64_tr_b16 a[254:255], v196 offset:6144
    v_mfma_f32_16x16x32_bf16 v[152:155], a[244:247], a[60:63], v[152:155]
    s_waitcnt vmcnt(17)
    buffer_load_dwordx4 v6, s[12:15], s56 offen offset:1024 nt lds
    v_mfma_f32_16x16x32_bf16 v[156:159], a[244:247], a[64:67], v[156:159]
    v_mfma_f32_16x16x32_bf16 v[160:163], a[244:247], a[68:71], v[160:163]
    s_waitcnt vmcnt(13)
    buffer_load_dwordx4 v5, s[12:15], s56 offen offset:2048 nt lds
    v_mfma_f32_16x16x32_bf16 v[164:167], a[244:247], a[72:75], v[164:167]
    v_mfma_f32_16x16x32_bf16 v[168:171], a[244:247], a[76:79], v[168:171]
    s_waitcnt vmcnt(13)
    buffer_load_dwordx4 v6, s[12:15], s56 offen offset:3072 nt lds
    v_mfma_f32_16x16x32_bf16 v[172:175], a[244:247], a[80:83], v[172:175]
    s_waitcnt lgkmcnt(2)
    v_mfma_f32_16x16x32_bf16 v[120:123], a[248:251], a[84:87], v[120:123]
    ds_read_b64_tr_b16 a[224:225], v195 offset:8192
    ds_read_b64_tr_b16 a[226:227], v195 offset:10240
    s_barrier
    s_add_u32 m0, s48, 16384
    s_xor_b32 s56, s47, 57344
    s_waitcnt vmcnt(13)
    buffer_load_dwordx4 v5, s[8:11], s56 offen offset:0 nt lds
    v_mfma_f32_16x16x32_bf16 v[124:127], a[248:251], a[88:91], v[124:127]
    v_mfma_f32_16x16x32_bf16 v[128:131], a[248:251], a[92:95], v[128:131]
    s_waitcnt vmcnt(13)
    buffer_load_dwordx4 v6, s[8:11], s56 offen offset:1024 nt lds
    v_mfma_f32_16x16x32_bf16 v[132:135], a[248:251], a[96:99], v[132:135]
    v_mfma_f32_16x16x32_bf16 v[136:139], a[248:251], a[100:103], v[136:139]
    s_waitcnt vmcnt(13)
    buffer_load_dwordx4 v5, s[8:11], s56 offen offset:2048 nt lds
    v_mfma_f32_16x16x32_bf16 v[140:143], a[248:251], a[104:107], v[140:143]
    v_mfma_f32_16x16x32_bf16 v[144:147], a[248:251], a[108:111], v[144:147]
    s_waitcnt vmcnt(13)
    buffer_load_dwordx4 v6, s[8:11], s56 offen offset:3072 nt lds
    s_waitcnt lgkmcnt(2)
    v_mfma_f32_16x16x32_bf16 v[148:151], a[252:255], a[84:87], v[148:151]
    ds_read_b64_tr_b16 a[228:229], v196 offset:8192
    ds_read_b64_tr_b16 a[230:231], v196 offset:10240
    v_mfma_f32_16x16x32_bf16 v[152:155], a[252:255], a[88:91], v[152:155]
    s_add_u32 m0, s65, 155648
    s_add_u32 s58, s44, 3
    s_and_b32 s58, s58, 7
    s_lshl_b32 s58, s58, 7
    s_add_u32 s58, s58, 32768
    buffer_load_dwordx4 v197, s[20:23], s58 offen offset:0 lds
    v_mfma_f32_16x16x32_bf16 v[156:159], a[252:255], a[92:95], v[156:159]
    v_mfma_f32_16x16x32_bf16 v[160:163], a[252:255], a[96:99], v[160:163]
    s_addk_i32 s58, 7168
    buffer_load_dwordx4 v197, s[20:23], s58 offen offset:1024 lds
    v_mfma_f32_16x16x32_bf16 v[164:167], a[252:255], a[100:103], v[164:167]
    v_mfma_f32_16x16x32_bf16 v[168:171], a[252:255], a[104:107], v[168:171]
    s_addk_i32 s58, 7168
    buffer_load_dwordx4 v197, s[20:23], s58 offen offset:2048 lds
    v_mfma_f32_16x16x32_bf16 v[172:175], a[252:255], a[108:111], v[172:175]
    s_waitcnt lgkmcnt(2)
    v_mfma_f32_16x16x32_bf16 v[120:123], a[224:227], a[112:115], v[120:123]
    ds_read_b64_tr_b16 a[232:233], v195 offset:12288
    ds_read_b64_tr_b16 a[234:235], v195 offset:14336
    s_addk_i32 s58, 7168
    buffer_load_dwordx4 v197, s[20:23], s58 offen offset:3072 lds
    v_mfma_f32_16x16x32_bf16 v[124:127], a[224:227], a[116:119], v[124:127]
    v_mfma_f32_16x16x32_bf16 v[128:131], a[224:227], a[120:123], v[128:131]
    s_add_u32 m0, s49, 16384
    s_xor_b32 s56, s56, 0x1000
    s_waitcnt vmcnt(17)
    buffer_load_dwordx4 v5, s[8:11], s56 offen offset:0 nt lds
    v_mfma_f32_16x16x32_bf16 v[132:135], a[224:227], a[124:127], v[132:135]
    v_mfma_f32_16x16x32_bf16 v[136:139], a[224:227], a[128:131], v[136:139]
    s_waitcnt vmcnt(17)
    buffer_load_dwordx4 v6, s[8:11], s56 offen offset:1024 nt lds
    v_mfma_f32_16x16x32_bf16 v[140:143], a[224:227], a[132:135], v[140:143]
    v_mfma_f32_16x16x32_bf16 v[144:147], a[224:227], a[136:139], v[144:147]
    s_waitcnt vmcnt(13)
    buffer_load_dwordx4 v5, s[8:11], s56 offen offset:2048 nt lds
    s_waitcnt lgkmcnt(2)
    v_mfma_f32_16x16x32_bf16 v[148:151], a[228:231], a[112:115], v[148:151]
    ds_read_b64_tr_b16 a[236:237], v196 offset:12288
    ds_read_b64_tr_b16 a[238:239], v196 offset:14336
    v_mfma_f32_16x16x32_bf16 v[152:155], a[228:231], a[116:119], v[152:155]
    s_waitcnt vmcnt(13)
    buffer_load_dwordx4 v6, s[8:11], s56 offen offset:3072 nt lds
    v_mfma_f32_16x16x32_bf16 v[156:159], a[228:231], a[120:123], v[156:159]
    v_mfma_f32_16x16x32_bf16 v[160:163], a[228:231], a[124:127], v[160:163]
    v_mfma_f32_16x16x32_bf16 v[164:167], a[228:231], a[128:131], v[164:167]
    s_barrier
    s_add_u32 m0, s48, 24576
    s_xor_b32 s56, s47, 57344
    s_waitcnt vmcnt(13)
    buffer_load_dwordx4 v5, s[12:15], s56 offen offset:0 nt lds
    v_mfma_f32_16x16x32_bf16 v[168:171], a[228:231], a[132:135], v[168:171]
    v_mfma_f32_16x16x32_bf16 v[172:175], a[228:231], a[136:139], v[172:175]
    s_waitcnt vmcnt(13)
    buffer_load_dwordx4 v6, s[12:15], s56 offen offset:1024 nt lds
    s_waitcnt lgkmcnt(2)
    v_mfma_f32_16x16x32_bf16 v[120:123], a[232:235], a[140:143], v[120:123]
    ds_read_b64_tr_b16 a[240:241], v195 offset:16384
    ds_read_b64_tr_b16 a[242:243], v195 offset:18432
    v_mfma_f32_16x16x32_bf16 v[124:127], a[232:235], a[144:147], v[124:127]
    s_waitcnt vmcnt(13)
    buffer_load_dwordx4 v5, s[12:15], s56 offen offset:2048 nt lds
    v_mfma_f32_16x16x32_bf16 v[128:131], a[232:235], a[148:151], v[128:131]
    v_mfma_f32_16x16x32_bf16 v[132:135], a[232:235], a[152:155], v[132:135]
    s_waitcnt vmcnt(13)
    buffer_load_dwordx4 v6, s[12:15], s56 offen offset:3072 nt lds
    v_mfma_f32_16x16x32_bf16 v[136:139], a[232:235], a[156:159], v[136:139]
    v_mfma_f32_16x16x32_bf16 v[140:143], a[232:235], a[160:163], v[140:143]
    s_add_u32 m0, s65, 122880
    s_add_u32 s58, s44, 3
    s_and_b32 s58, s58, 7
    s_lshl_b32 s58, s58, 7
    s_add_u32 s58, s58, 65536
    buffer_load_dwordx4 v197, s[20:23], s58 offen offset:0 lds
    v_mfma_f32_16x16x32_bf16 v[144:147], a[232:235], a[164:167], v[144:147]
    s_waitcnt lgkmcnt(2)
    v_mfma_f32_16x16x32_bf16 v[148:151], a[236:239], a[140:143], v[148:151]
    ds_read_b64_tr_b16 a[244:245], v196 offset:16384
    ds_read_b64_tr_b16 a[246:247], v196 offset:18432
    s_addk_i32 s58, 7168
    buffer_load_dwordx4 v197, s[20:23], s58 offen offset:1024 lds
    v_mfma_f32_16x16x32_bf16 v[152:155], a[236:239], a[144:147], v[152:155]
    v_mfma_f32_16x16x32_bf16 v[156:159], a[236:239], a[148:151], v[156:159]
    s_addk_i32 s58, 7168
    buffer_load_dwordx4 v197, s[20:23], s58 offen offset:2048 lds
    v_mfma_f32_16x16x32_bf16 v[160:163], a[236:239], a[152:155], v[160:163]
    v_mfma_f32_16x16x32_bf16 v[164:167], a[236:239], a[156:159], v[164:167]
    s_addk_i32 s58, 7168
    buffer_load_dwordx4 v197, s[20:23], s58 offen offset:3072 lds
    v_mfma_f32_16x16x32_bf16 v[168:171], a[236:239], a[160:163], v[168:171]
    v_mfma_f32_16x16x32_bf16 v[172:175], a[236:239], a[164:167], v[172:175]
    s_add_u32 m0, s49, 24576
    s_xor_b32 s56, s56, 0x1000
    s_waitcnt vmcnt(17)
    buffer_load_dwordx4 v5, s[12:15], s56 offen offset:0 nt lds
    s_waitcnt lgkmcnt(2)
    v_mfma_f32_16x16x32_bf16 v[120:123], a[240:243], a[168:171], v[120:123]
    ds_read_b64_tr_b16 a[248:249], v195 offset:20480
    ds_read_b64_tr_b16 a[250:251], v195 offset:22528
    v_mfma_f32_16x16x32_bf16 v[124:127], a[240:243], a[172:175], v[124:127]
    s_waitcnt vmcnt(17)
    buffer_load_dwordx4 v6, s[12:15], s56 offen offset:1024 nt lds
    v_mfma_f32_16x16x32_bf16 v[128:131], a[240:243], a[176:179], v[128:131]
    v_mfma_f32_16x16x32_bf16 v[132:135], a[240:243], a[180:183], v[132:135]
    s_waitcnt vmcnt(13)
    buffer_load_dwordx4 v5, s[12:15], s56 offen offset:2048 nt lds
    v_mfma_f32_16x16x32_bf16 v[136:139], a[240:243], a[184:187], v[136:139]
    v_mfma_f32_16x16x32_bf16 v[140:143], a[240:243], a[188:191], v[140:143]
    s_waitcnt vmcnt(13)
    buffer_load_dwordx4 v6, s[12:15], s56 offen offset:3072 nt lds
    v_mfma_f32_16x16x32_bf16 v[144:147], a[240:243], a[192:195], v[144:147]
    s_waitcnt lgkmcnt(2)
    v_mfma_f32_16x16x32_bf16 v[148:151], a[244:247], a[168:171], v[148:151]
    ds_read_b64_tr_b16 a[252:253], v196 offset:20480
    ds_read_b64_tr_b16 a[254:255], v196 offset:22528
    v_mfma_f32_16x16x32_bf16 v[152:155], a[244:247], a[172:175], v[152:155]
    s_barrier
    s_add_u32 m0, s48, 0
    s_xor_b32 s56, s47, 65536
    s_waitcnt vmcnt(13)
    buffer_load_dwordx4 v5, s[8:11], s56 offen offset:0 nt lds
    v_mfma_f32_16x16x32_bf16 v[156:159], a[244:247], a[176:179], v[156:159]
    v_mfma_f32_16x16x32_bf16 v[160:163], a[244:247], a[180:183], v[160:163]
    s_waitcnt vmcnt(13)
    buffer_load_dwordx4 v6, s[8:11], s56 offen offset:1024 nt lds
    v_mfma_f32_16x16x32_bf16 v[164:167], a[244:247], a[184:187], v[164:167]
    v_mfma_f32_16x16x32_bf16 v[168:171], a[244:247], a[188:191], v[168:171]
    s_waitcnt vmcnt(13)
    buffer_load_dwordx4 v5, s[8:11], s56 offen offset:2048 nt lds
    v_mfma_f32_16x16x32_bf16 v[172:175], a[244:247], a[192:195], v[172:175]
    s_waitcnt lgkmcnt(2)
    v_mfma_f32_16x16x32_bf16 v[120:123], a[248:251], a[196:199], v[120:123]
    ds_read_b64_tr_b16 a[224:225], v195 offset:24576
    ds_read_b64_tr_b16 a[226:227], v195 offset:26624
    s_waitcnt vmcnt(13)
    buffer_load_dwordx4 v6, s[8:11], s56 offen offset:3072 nt lds
    v_mfma_f32_16x16x32_bf16 v[124:127], a[248:251], a[200:203], v[124:127]
    v_mfma_f32_16x16x32_bf16 v[128:131], a[248:251], a[204:207], v[128:131]
    s_add_u32 m0, s65, 131072
    s_add_u32 s58, s44, 3
    s_and_b32 s58, s58, 7
    s_lshl_b32 s58, s58, 7
    s_add_u32 s58, s58, 98304
    buffer_load_dwordx4 v197, s[20:23], s58 offen offset:0 lds
    v_mfma_f32_16x16x32_bf16 v[132:135], a[248:251], a[208:211], v[132:135]
    v_mfma_f32_16x16x32_bf16 v[136:139], a[248:251], a[212:215], v[136:139]
    s_addk_i32 s58, 7168
    buffer_load_dwordx4 v197, s[20:23], s58 offen offset:1024 lds
    v_mfma_f32_16x16x32_bf16 v[140:143], a[248:251], a[216:219], v[140:143]
    v_mfma_f32_16x16x32_bf16 v[144:147], a[248:251], a[220:223], v[144:147]
    s_addk_i32 s58, 7168
    buffer_load_dwordx4 v197, s[20:23], s58 offen offset:2048 lds
    s_waitcnt lgkmcnt(2)
    v_mfma_f32_16x16x32_bf16 v[148:151], a[252:255], a[196:199], v[148:151]
    ds_read_b64_tr_b16 a[228:229], v196 offset:24576
    ds_read_b64_tr_b16 a[230:231], v196 offset:26624
    v_mfma_f32_16x16x32_bf16 v[152:155], a[252:255], a[200:203], v[152:155]
    s_addk_i32 s58, 7168
    buffer_load_dwordx4 v197, s[20:23], s58 offen offset:3072 lds
    v_mfma_f32_16x16x32_bf16 v[156:159], a[252:255], a[204:207], v[156:159]
    v_cvt_pk_bf16_f32 v22, v120, v121
    v_cvt_pk_bf16_f32 v23, v122, v123
    v_cvt_pk_bf16_f32 v24, v124, v125
    v_mfma_f32_16x16x32_bf16 v[160:163], a[252:255], a[208:211], v[160:163]
    v_cvt_pk_bf16_f32 v25, v126, v127
    v_cvt_pk_bf16_f32 v26, v128, v129
    v_cvt_pk_bf16_f32 v27, v130, v131
    s_add_u32 m0, s49, 0
    s_xor_b32 s56, s56, 0x1000
    s_waitcnt vmcnt(17)
    buffer_load_dwordx4 v5, s[8:11], s56 offen offset:0 nt lds
    v_mfma_f32_16x16x32_bf16 v[164:167], a[252:255], a[212:215], v[164:167]
    v_cvt_pk_bf16_f32 v28, v132, v133
    v_cvt_pk_bf16_f32 v29, v134, v135
    v_cvt_pk_bf16_f32 v30, v136, v137
    v_mfma_f32_16x16x32_bf16 v[168:171], a[252:255], a[216:219], v[168:171]
    v_cvt_pk_bf16_f32 v31, v138, v139
    v_cvt_pk_bf16_f32 v32, v140, v141
    v_cvt_pk_bf16_f32 v33, v142, v143
    s_waitcnt vmcnt(17)
    buffer_load_dwordx4 v6, s[8:11], s56 offen offset:1024 nt lds
    v_mfma_f32_16x16x32_bf16 v[172:175], a[252:255], a[220:223], v[172:175]
    v_cvt_pk_bf16_f32 v34, v144, v145
    v_cvt_pk_bf16_f32 v35, v146, v147
    s_waitcnt lgkmcnt(2)
    v_mfma_f32_16x16x32_bf16 v[120:123], a[224:227], a[0:3], 0
    ds_read_b64_tr_b16 a[232:233], v195 offset:28672
    ds_read_b64_tr_b16 a[234:235], v195 offset:30720
    s_waitcnt vmcnt(13)
    buffer_load_dwordx4 v5, s[8:11], s56 offen offset:2048 nt lds
    v_mfma_f32_16x16x32_bf16 v[124:127], a[224:227], a[4:7], 0
    v_mfma_f32_16x16x32_bf16 v[128:131], a[224:227], a[8:11], 0
    v_cvt_pk_bf16_f32 v148, v148, v149
    v_cvt_pk_bf16_f32 v149, v150, v151
    v_cvt_pk_bf16_f32 v150, v152, v153
    v_cvt_pk_bf16_f32 v151, v154, v155
    s_waitcnt vmcnt(13)
    buffer_load_dwordx4 v6, s[8:11], s56 offen offset:3072 nt lds
    v_mfma_f32_16x16x32_bf16 v[132:135], a[224:227], a[12:15], 0
    v_cvt_pk_bf16_f32 v152, v156, v157
    v_cvt_pk_bf16_f32 v153, v158, v159
    v_cvt_pk_bf16_f32 v154, v160, v161
    v_cvt_pk_bf16_f32 v155, v162, v163
    v_mfma_f32_16x16x32_bf16 v[136:139], a[224:227], a[16:19], 0
    v_cvt_pk_bf16_f32 v156, v164, v165
    v_cvt_pk_bf16_f32 v157, v166, v167
    v_cvt_pk_bf16_f32 v158, v168, v169
    v_mfma_f32_16x16x32_bf16 v[140:143], a[224:227], a[20:23], 0
    v_cvt_pk_bf16_f32 v159, v170, v171
    v_cvt_pk_bf16_f32 v160, v172, v173
    v_cvt_pk_bf16_f32 v161, v174, v175
    ds_write_b128 v208, v[148:151] offset:3584
    s_barrier
    s_add_u32 m0, s48, 8192
    s_xor_b32 s56, s47, 65536
    s_waitcnt vmcnt(13)
    buffer_load_dwordx4 v5, s[12:15], s56 offen offset:0 nt lds
    v_mfma_f32_16x16x32_bf16 v[144:147], a[224:227], a[24:27], 0
    ds_write_b128 v208, v[152:155] offset:4608
    ds_write_b128 v208, v[156:159] offset:5632
    ds_write_b64 v209, v[160:161] offset:6656
    s_waitcnt lgkmcnt(0)
    v_mfma_f32_16x16x32_bf16 v[148:151], a[228:231], a[0:3], 0
    ds_read_b64_tr_b16 a[236:237], v196 offset:28672
    ds_read_b64_tr_b16 a[238:239], v196 offset:30720
    s_waitcnt vmcnt(13)
    buffer_load_dwordx4 v6, s[12:15], s56 offen offset:1024 nt lds
    v_mfma_f32_16x16x32_bf16 v[152:155], a[228:231], a[4:7], 0
    v_mfma_f32_16x16x32_bf16 v[156:159], a[228:231], a[8:11], 0
    s_waitcnt vmcnt(13)
    buffer_load_dwordx4 v5, s[12:15], s56 offen offset:2048 nt lds
    v_mfma_f32_16x16x32_bf16 v[160:163], a[228:231], a[12:15], 0
    v_mfma_f32_16x16x32_bf16 v[164:167], a[228:231], a[16:19], 0
    s_waitcnt vmcnt(13)
    buffer_load_dwordx4 v6, s[12:15], s56 offen offset:3072 nt lds
    v_mfma_f32_16x16x32_bf16 v[168:171], a[228:231], a[20:23], 0
    v_mfma_f32_16x16x32_bf16 v[172:175], a[228:231], a[24:27], 0
    s_add_u32 m0, s65, 139264
    s_add_u32 s58, s44, 4
    s_and_b32 s58, s58, 7
    s_lshl_b32 s58, s58, 7
    buffer_load_dwordx4 v197, s[20:23], s58 offen offset:0 lds
    v_mfma_f32_16x16x32_bf16 v[120:123], a[232:235], a[28:31], v[120:123]
    ds_read_b64_tr_b16 a[240:241], v195 offset:32768
    ds_read_b64_tr_b16 a[242:243], v195 offset:34816
    v_mfma_f32_16x16x32_bf16 v[124:127], a[232:235], a[32:35], v[124:127]
    s_addk_i32 s58, 7168
    buffer_load_dwordx4 v197, s[20:23], s58 offen offset:1024 lds
    v_mfma_f32_16x16x32_bf16 v[128:131], a[232:235], a[36:39], v[128:131]
    v_mfma_f32_16x16x32_bf16 v[132:135], a[232:235], a[40:43], v[132:135]
    v_mfma_f32_16x16x32_bf16 v[136:139], a[232:235], a[44:47], v[136:139]
    s_addk_i32 s58, 7168
    buffer_load_dwordx4 v197, s[20:23], s58 offen offset:2048 lds
    v_mfma_f32_16x16x32_bf16 v[140:143], a[232:235], a[48:51], v[140:143]
    v_mfma_f32_16x16x32_bf16 v[144:147], a[232:235], a[52:55], v[144:147]
    s_addk_i32 s58, 7168
    buffer_load_dwordx4 v197, s[20:23], s58 offen offset:3072 lds
    s_waitcnt lgkmcnt(2)
    v_mfma_f32_16x16x32_bf16 v[148:151], a[236:239], a[28:31], v[148:151]
    ds_read_b64_tr_b16 a[244:245], v196 offset:32768
    ds_read_b64_tr_b16 a[246:247], v196 offset:34816
    v_mfma_f32_16x16x32_bf16 v[152:155], a[236:239], a[32:35], v[152:155]
    s_add_u32 m0, s49, 8192
    s_xor_b32 s56, s56, 0x1000
    s_waitcnt vmcnt(17)
    buffer_load_dwordx4 v5, s[12:15], s56 offen offset:0 nt lds
    v_mfma_f32_16x16x32_bf16 v[156:159], a[236:239], a[36:39], v[156:159]
    v_mfma_f32_16x16x32_bf16 v[160:163], a[236:239], a[40:43], v[160:163]
    s_waitcnt vmcnt(17)
    buffer_load_dwordx4 v6, s[12:15], s56 offen offset:1024 nt lds
    v_mfma_f32_16x16x32_bf16 v[164:167], a[236:239], a[44:47], v[164:167]
    v_mfma_f32_16x16x32_bf16 v[168:171], a[236:239], a[48:51], v[168:171]
    s_waitcnt vmcnt(13)
    buffer_load_dwordx4 v5, s[12:15], s56 offen offset:2048 nt lds
    v_mfma_f32_16x16x32_bf16 v[172:175], a[236:239], a[52:55], v[172:175]
    s_waitcnt lgkmcnt(2)
    v_mfma_f32_16x16x32_bf16 v[120:123], a[240:243], a[56:59], v[120:123]
    ds_read_b64_tr_b16 a[248:249], v195 offset:36864
    ds_read_b64_tr_b16 a[250:251], v195 offset:38912
    s_waitcnt vmcnt(13)
    buffer_load_dwordx4 v6, s[12:15], s56 offen offset:3072 nt lds
    v_mfma_f32_16x16x32_bf16 v[124:127], a[240:243], a[60:63], v[124:127]
    v_mfma_f32_16x16x32_bf16 v[128:131], a[240:243], a[64:67], v[128:131]
    v_mfma_f32_16x16x32_bf16 v[132:135], a[240:243], a[68:71], v[132:135]
    s_barrier
    s_add_u32 m0, s48, 16384
    s_xor_b32 s56, s47, 73728
    s_waitcnt vmcnt(13)
    buffer_load_dwordx4 v5, s[8:11], s56 offen offset:0 nt lds
    v_mfma_f32_16x16x32_bf16 v[136:139], a[240:243], a[72:75], v[136:139]
    v_mfma_f32_16x16x32_bf16 v[140:143], a[240:243], a[76:79], v[140:143]
    s_waitcnt vmcnt(13)
    buffer_load_dwordx4 v6, s[8:11], s56 offen offset:1024 nt lds
    v_mfma_f32_16x16x32_bf16 v[144:147], a[240:243], a[80:83], v[144:147]
    s_waitcnt lgkmcnt(2)
    v_mfma_f32_16x16x32_bf16 v[148:151], a[244:247], a[56:59], v[148:151]
    ds_read_b64_tr_b16 a[252:253], v196 offset:36864
    ds_read_b64_tr_b16 a[254:255], v196 offset:38912
    s_waitcnt vmcnt(13)
    buffer_load_dwordx4 v5, s[8:11], s56 offen offset:2048 nt lds
    v_mfma_f32_16x16x32_bf16 v[152:155], a[244:247], a[60:63], v[152:155]
    v_mfma_f32_16x16x32_bf16 v[156:159], a[244:247], a[64:67], v[156:159]
    s_waitcnt vmcnt(13)
    buffer_load_dwordx4 v6, s[8:11], s56 offen offset:3072 nt lds
    v_mfma_f32_16x16x32_bf16 v[160:163], a[244:247], a[68:71], v[160:163]
    v_mfma_f32_16x16x32_bf16 v[164:167], a[244:247], a[72:75], v[164:167]
    v_mfma_f32_16x16x32_bf16 v[168:171], a[244:247], a[76:79], v[168:171]
    s_add_u32 m0, s65, 147456
    s_add_u32 s58, s44, 4
    s_and_b32 s58, s58, 7
    s_lshl_b32 s58, s58, 7
    s_add_u32 s58, s58, 32768
    buffer_load_dwordx4 v197, s[20:23], s58 offen offset:0 lds
    v_mfma_f32_16x16x32_bf16 v[172:175], a[244:247], a[80:83], v[172:175]
    s_waitcnt lgkmcnt(2)
    v_mfma_f32_16x16x32_bf16 v[120:123], a[248:251], a[84:87], v[120:123]
    ds_read_b64_tr_b16 a[224:225], v195 offset:0
    ds_read_b64_tr_b16 a[226:227], v195 offset:2048
    s_addk_i32 s58, 7168
    buffer_load_dwordx4 v197, s[20:23], s58 offen offset:1024 lds
    v_mfma_f32_16x16x32_bf16 v[124:127], a[248:251], a[88:91], v[124:127]
    v_mfma_f32_16x16x32_bf16 v[128:131], a[248:251], a[92:95], v[128:131]
    s_addk_i32 s58, 7168
    buffer_load_dwordx4 v197, s[20:23], s58 offen offset:2048 lds
    v_mfma_f32_16x16x32_bf16 v[132:135], a[248:251], a[96:99], v[132:135]
    v_mfma_f32_16x16x32_bf16 v[136:139], a[248:251], a[100:103], v[136:139]
    s_addk_i32 s58, 7168
    buffer_load_dwordx4 v197, s[20:23], s58 offen offset:3072 lds
    v_mfma_f32_16x16x32_bf16 v[140:143], a[248:251], a[104:107], v[140:143]
    v_mfma_f32_16x16x32_bf16 v[144:147], a[248:251], a[108:111], v[144:147]
    s_waitcnt lgkmcnt(2)
    v_mfma_f32_16x16x32_bf16 v[148:151], a[252:255], a[84:87], v[148:151]
    ds_read_b64_tr_b16 a[228:229], v196 offset:0
    ds_read_b64_tr_b16 a[230:231], v196 offset:2048
    s_add_u32 m0, s49, 16384
    s_xor_b32 s56, s56, 0x1000
    s_waitcnt vmcnt(17)
    buffer_load_dwordx4 v5, s[8:11], s56 offen offset:0 nt lds
    v_mfma_f32_16x16x32_bf16 v[152:155], a[252:255], a[88:91], v[152:155]
    v_mfma_f32_16x16x32_bf16 v[156:159], a[252:255], a[92:95], v[156:159]
    s_waitcnt vmcnt(17)
    buffer_load_dwordx4 v6, s[8:11], s56 offen offset:1024 nt lds
    v_mfma_f32_16x16x32_bf16 v[160:163], a[252:255], a[96:99], v[160:163]
    v_mfma_f32_16x16x32_bf16 v[164:167], a[252:255], a[100:103], v[164:167]
    s_waitcnt vmcnt(13)
    buffer_load_dwordx4 v5, s[8:11], s56 offen offset:2048 nt lds
    v_mfma_f32_16x16x32_bf16 v[168:171], a[252:255], a[104:107], v[168:171]
    v_mfma_f32_16x16x32_bf16 v[172:175], a[252:255], a[108:111], v[172:175]
    s_waitcnt vmcnt(13)
    buffer_load_dwordx4 v6, s[8:11], s56 offen offset:3072 nt lds
    s_waitcnt lgkmcnt(2)
    v_mfma_f32_16x16x32_bf16 v[120:123], a[224:227], a[112:115], v[120:123]
    ds_read_b64_tr_b16 a[232:233], v195 offset:4096
    ds_read_b64_tr_b16 a[234:235], v195 offset:6144
    v_mfma_f32_16x16x32_bf16 v[124:127], a[224:227], a[116:119], v[124:127]
    v_mfma_f32_16x16x32_bf16 v[128:131], a[224:227], a[120:123], v[128:131]
    s_barrier
    s_add_u32 m0, s48, 24576
    s_xor_b32 s56, s47, 73728
    s_waitcnt vmcnt(13)
    buffer_load_dwordx4 v5, s[12:15], s56 offen offset:0 nt lds
    v_mfma_f32_16x16x32_bf16 v[132:135], a[224:227], a[124:127], v[132:135]
    v_mfma_f32_16x16x32_bf16 v[136:139], a[224:227], a[128:131], v[136:139]
    s_waitcnt vmcnt(13)
    buffer_load_dwordx4 v6, s[12:15], s56 offen offset:1024 nt lds
    v_mfma_f32_16x16x32_bf16 v[140:143], a[224:227], a[132:135], v[140:143]
    v_mfma_f32_16x16x32_bf16 v[144:147], a[224:227], a[136:139], v[144:147]
    s_waitcnt vmcnt(13)
    buffer_load_dwordx4 v5, s[12:15], s56 offen offset:2048 nt lds
    s_waitcnt lgkmcnt(2)
    v_mfma_f32_16x16x32_bf16 v[148:151], a[228:231], a[112:115], v[148:151]
    ds_read_b64_tr_b16 a[236:237], v196 offset:4096
    ds_read_b64_tr_b16 a[238:239], v196 offset:6144
    v_mfma_f32_16x16x32_bf16 v[152:155], a[228:231], a[116:119], v[152:155]
    s_waitcnt vmcnt(13)
    buffer_load_dwordx4 v6, s[12:15], s56 offen offset:3072 nt lds
    v_mfma_f32_16x16x32_bf16 v[156:159], a[228:231], a[120:123], v[156:159]
    v_mfma_f32_16x16x32_bf16 v[160:163], a[228:231], a[124:127], v[160:163]
    v_mfma_f32_16x16x32_bf16 v[164:167], a[228:231], a[128:131], v[164:167]
    s_add_u32 m0, s65, 155648
    s_add_u32 s58, s44, 4
    s_and_b32 s58, s58, 7
    s_lshl_b32 s58, s58, 7
    s_add_u32 s58, s58, 65536
    buffer_load_dwordx4 v197, s[20:23], s58 offen offset:0 lds
    v_mfma_f32_16x16x32_bf16 v[168:171], a[228:231], a[132:135], v[168:171]
    v_mfma_f32_16x16x32_bf16 v[172:175], a[228:231], a[136:139], v[172:175]
    s_addk_i32 s58, 7168
    buffer_load_dwordx4 v197, s[20:23], s58 offen offset:1024 lds
    s_waitcnt lgkmcnt(2)
    v_mfma_f32_16x16x32_bf16 v[120:123], a[232:235], a[140:143], v[120:123]
    ds_read_b64_tr_b16 a[240:241], v195 offset:8192
    ds_read_b64_tr_b16 a[242:243], v195 offset:10240
    v_mfma_f32_16x16x32_bf16 v[124:127], a[232:235], a[144:147], v[124:127]
    s_addk_i32 s58, 7168
    buffer_load_dwordx4 v197, s[20:23], s58 offen offset:2048 lds
    v_mfma_f32_16x16x32_bf16 v[128:131], a[232:235], a[148:151], v[128:131]
    v_mfma_f32_16x16x32_bf16 v[132:135], a[232:235], a[152:155], v[132:135]
    s_addk_i32 s58, 7168
    buffer_load_dwordx4 v197, s[20:23], s58 offen offset:3072 lds
    v_mfma_f32_16x16x32_bf16 v[136:139], a[232:235], a[156:159], v[136:139]
    v_mfma_f32_16x16x32_bf16 v[140:143], a[232:235], a[160:163], v[140:143]
    v_mfma_f32_16x16x32_bf16 v[144:147], a[232:235], a[164:167], v[144:147]
    s_add_u32 m0, s49, 24576
    s_xor_b32 s56, s56, 0x1000
    s_waitcnt vmcnt(17)
    buffer_load_dwordx4 v5, s[12:15], s56 offen offset:0 nt lds
    s_waitcnt lgkmcnt(2)
    v_mfma_f32_16x16x32_bf16 v[148:151], a[236:239], a[140:143], v[148:151]
    ds_read_b64_tr_b16 a[244:245], v196 offset:8192
    ds_read_b64_tr_b16 a[246:247], v196 offset:10240
    v_mfma_f32_16x16x32_bf16 v[152:155], a[236:239], a[144:147], v[152:155]
    s_waitcnt vmcnt(17)
    buffer_load_dwordx4 v6, s[12:15], s56 offen offset:1024 nt lds
    v_mfma_f32_16x16x32_bf16 v[156:159], a[236:239], a[148:151], v[156:159]
    v_mfma_f32_16x16x32_bf16 v[160:163], a[236:239], a[152:155], v[160:163]
    s_waitcnt vmcnt(13)
    buffer_load_dwordx4 v5, s[12:15], s56 offen offset:2048 nt lds
    v_mfma_f32_16x16x32_bf16 v[164:167], a[236:239], a[156:159], v[164:167]
    v_mfma_f32_16x16x32_bf16 v[168:171], a[236:239], a[160:163], v[168:171]
    s_waitcnt vmcnt(13)
    buffer_load_dwordx4 v6, s[12:15], s56 offen offset:3072 nt lds
    v_mfma_f32_16x16x32_bf16 v[172:175], a[236:239], a[164:167], v[172:175]
    s_waitcnt lgkmcnt(2)
    v_mfma_f32_16x16x32_bf16 v[120:123], a[240:243], a[168:171], v[120:123]
    ds_read_b64_tr_b16 a[248:249], v195 offset:12288
    ds_read_b64_tr_b16 a[250:251], v195 offset:14336
    v_mfma_f32_16x16x32_bf16 v[124:127], a[240:243], a[172:175], v[124:127]
    s_barrier
    s_add_u32 m0, s48, 0
    s_xor_b32 s56, s47, 81920
    s_waitcnt vmcnt(13)
    buffer_load_dwordx4 v5, s[8:11], s56 offen offset:0 nt lds
    v_mfma_f32_16x16x32_bf16 v[128:131], a[240:243], a[176:179], v[128:131]
    v_mfma_f32_16x16x32_bf16 v[132:135], a[240:243], a[180:183], v[132:135]
    s_waitcnt vmcnt(13)
    buffer_load_dwordx4 v6, s[8:11], s56 offen offset:1024 nt lds
    v_mfma_f32_16x16x32_bf16 v[136:139], a[240:243], a[184:187], v[136:139]
    v_mfma_f32_16x16x32_bf16 v[140:143], a[240:243], a[188:191], v[140:143]
    s_waitcnt vmcnt(13)
    buffer_load_dwordx4 v5, s[8:11], s56 offen offset:2048 nt lds
    v_mfma_f32_16x16x32_bf16 v[144:147], a[240:243], a[192:195], v[144:147]
    s_waitcnt lgkmcnt(2)
    v_mfma_f32_16x16x32_bf16 v[148:151], a[244:247], a[168:171], v[148:151]
    ds_read_b64_tr_b16 a[252:253], v196 offset:12288
    ds_read_b64_tr_b16 a[254:255], v196 offset:14336
    v_mfma_f32_16x16x32_bf16 v[152:155], a[244:247], a[172:175], v[152:155]
    s_waitcnt vmcnt(13)
    buffer_load_dwordx4 v6, s[8:11], s56 offen offset:3072 nt lds
    v_mfma_f32_16x16x32_bf16 v[156:159], a[244:247], a[176:179], v[156:159]
    v_mfma_f32_16x16x32_bf16 v[160:163], a[244:247], a[180:183], v[160:163]
    s_add_u32 m0, s65, 122880
    s_add_u32 s58, s44, 4
    s_and_b32 s58, s58, 7
    s_lshl_b32 s58, s58, 7
    s_add_u32 s58, s58, 98304
    buffer_load_dwordx4 v197, s[20:23], s58 offen offset:0 lds
    v_mfma_f32_16x16x32_bf16 v[164:167], a[244:247], a[184:187], v[164:167]
    v_mfma_f32_16x16x32_bf16 v[168:171], a[244:247], a[188:191], v[168:171]
    s_addk_i32 s58, 7168
    buffer_load_dwordx4 v197, s[20:23], s58 offen offset:1024 lds
    v_mfma_f32_16x16x32_bf16 v[172:175], a[244:247], a[192:195], v[172:175]
    s_waitcnt lgkmcnt(2)
    v_mfma_f32_16x16x32_bf16 v[120:123], a[248:251], a[196:199], v[120:123]
    ds_read_b64_tr_b16 a[224:225], v195 offset:16384
    ds_read_b64_tr_b16 a[226:227], v195 offset:18432
    v_mfma_f32_16x16x32_bf16 v[124:127], a[248:251], a[200:203], v[124:127]
    s_addk_i32 s58, 7168
    buffer_load_dwordx4 v197, s[20:23], s58 offen offset:2048 lds
    v_mfma_f32_16x16x32_bf16 v[128:131], a[248:251], a[204:207], v[128:131]
    v_mfma_f32_16x16x32_bf16 v[132:135], a[248:251], a[208:211], v[132:135]
    s_addk_i32 s58, 7168
    buffer_load_dwordx4 v197, s[20:23], s58 offen offset:3072 lds
    v_mfma_f32_16x16x32_bf16 v[136:139], a[248:251], a[212:215], v[136:139]
    v_mfma_f32_16x16x32_bf16 v[140:143], a[248:251], a[216:219], v[140:143]
    s_add_u32 m0, s49, 0
    s_xor_b32 s56, s56, 0x1000
    s_waitcnt vmcnt(17)
    buffer_load_dwordx4 v5, s[8:11], s56 offen offset:0 nt lds
    v_mfma_f32_16x16x32_bf16 v[144:147], a[248:251], a[220:223], v[144:147]
    s_waitcnt lgkmcnt(2)
    v_mfma_f32_16x16x32_bf16 v[148:151], a[252:255], a[196:199], v[148:151]
    ds_read_b64_tr_b16 a[228:229], v196 offset:16384
    ds_read_b64_tr_b16 a[230:231], v196 offset:18432
    v_mfma_f32_16x16x32_bf16 v[152:155], a[252:255], a[200:203], v[152:155]
    s_waitcnt vmcnt(17)
    buffer_load_dwordx4 v6, s[8:11], s56 offen offset:1024 nt lds
    v_mfma_f32_16x16x32_bf16 v[156:159], a[252:255], a[204:207], v[156:159]
    v_cvt_pk_bf16_f32 v36, v120, v121
    v_cvt_pk_bf16_f32 v37, v122, v123
    v_cvt_pk_bf16_f32 v38, v124, v125
    v_mfma_f32_16x16x32_bf16 v[160:163], a[252:255], a[208:211], v[160:163]
    v_cvt_pk_bf16_f32 v39, v126, v127
    v_cvt_pk_bf16_f32 v40, v128, v129
    v_cvt_pk_bf16_f32 v41, v130, v131
    s_waitcnt vmcnt(13)
    buffer_load_dwordx4 v5, s[8:11], s56 offen offset:2048 nt lds
    v_mfma_f32_16x16x32_bf16 v[164:167], a[252:255], a[212:215], v[164:167]
    v_cvt_pk_bf16_f32 v42, v132, v133
    v_cvt_pk_bf16_f32 v43, v134, v135
    v_cvt_pk_bf16_f32 v44, v136, v137
    v_mfma_f32_16x16x32_bf16 v[168:171], a[252:255], a[216:219], v[168:171]
    v_cvt_pk_bf16_f32 v45, v138, v139
    v_cvt_pk_bf16_f32 v46, v140, v141
    v_cvt_pk_bf16_f32 v47, v142, v143
    s_waitcnt vmcnt(13)
    buffer_load_dwordx4 v6, s[8:11], s56 offen offset:3072 nt lds
    v_mfma_f32_16x16x32_bf16 v[172:175], a[252:255], a[220:223], v[172:175]
    v_cvt_pk_bf16_f32 v48, v144, v145
    v_cvt_pk_bf16_f32 v49, v146, v147
    s_waitcnt lgkmcnt(2)
    v_mfma_f32_16x16x32_bf16 v[120:123], a[224:227], a[0:3], 0
    ds_read_b64_tr_b16 a[232:233], v195 offset:20480
    ds_read_b64_tr_b16 a[234:235], v195 offset:22528
    v_mfma_f32_16x16x32_bf16 v[124:127], a[224:227], a[4:7], 0
    s_barrier
    s_add_u32 m0, s48, 8192
    s_xor_b32 s56, s47, 81920
    s_waitcnt vmcnt(13)
    buffer_load_dwordx4 v5, s[12:15], s56 offen offset:0 nt lds
    v_mfma_f32_16x16x32_bf16 v[128:131], a[224:227], a[8:11], 0
    v_cvt_pk_bf16_f32 v148, v148, v149
    v_cvt_pk_bf16_f32 v149, v150, v151
    v_cvt_pk_bf16_f32 v150, v152, v153
    v_cvt_pk_bf16_f32 v151, v154, v155
    v_mfma_f32_16x16x32_bf16 v[132:135], a[224:227], a[12:15], 0
    v_cvt_pk_bf16_f32 v152, v156, v157
    v_cvt_pk_bf16_f32 v153, v158, v159
    v_cvt_pk_bf16_f32 v154, v160, v161
    v_cvt_pk_bf16_f32 v155, v162, v163
    s_waitcnt vmcnt(13)
    buffer_load_dwordx4 v6, s[12:15], s56 offen offset:1024 nt lds
    v_mfma_f32_16x16x32_bf16 v[136:139], a[224:227], a[16:19], 0
    v_cvt_pk_bf16_f32 v156, v164, v165
    v_cvt_pk_bf16_f32 v157, v166, v167
    v_cvt_pk_bf16_f32 v158, v168, v169
    v_mfma_f32_16x16x32_bf16 v[140:143], a[224:227], a[20:23], 0
    v_cvt_pk_bf16_f32 v159, v170, v171
    v_cvt_pk_bf16_f32 v160, v172, v173
    v_cvt_pk_bf16_f32 v161, v174, v175
    ds_write_b128 v208, v[148:151] offset:7168
    s_waitcnt vmcnt(13)
    buffer_load_dwordx4 v5, s[12:15], s56 offen offset:2048 nt lds
    v_mfma_f32_16x16x32_bf16 v[144:147], a[224:227], a[24:27], 0
    ds_write_b128 v208, v[152:155] offset:8192
    ds_write_b128 v208, v[156:159] offset:9216
    ds_write_b64 v209, v[160:161] offset:10240
    s_waitcnt lgkmcnt(0)
    v_mfma_f32_16x16x32_bf16 v[148:151], a[228:231], a[0:3], 0
    ds_read_b64_tr_b16 a[236:237], v196 offset:20480
    ds_read_b64_tr_b16 a[238:239], v196 offset:22528
    v_mfma_f32_16x16x32_bf16 v[152:155], a[228:231], a[4:7], 0
    s_waitcnt vmcnt(13)
    buffer_load_dwordx4 v6, s[12:15], s56 offen offset:3072 nt lds
    v_mfma_f32_16x16x32_bf16 v[156:159], a[228:231], a[8:11], 0
    v_mfma_f32_16x16x32_bf16 v[160:163], a[228:231], a[12:15], 0
    s_add_u32 m0, s65, 131072
    s_add_u32 s58, s44, 5
    s_and_b32 s58, s58, 7
    s_lshl_b32 s58, s58, 7
    buffer_load_dwordx4 v197, s[20:23], s58 offen offset:0 lds
    v_mfma_f32_16x16x32_bf16 v[164:167], a[228:231], a[16:19], 0
    v_mfma_f32_16x16x32_bf16 v[168:171], a[228:231], a[20:23], 0
    s_addk_i32 s58, 7168
    buffer_load_dwordx4 v197, s[20:23], s58 offen offset:1024 lds
    v_mfma_f32_16x16x32_bf16 v[172:175], a[228:231], a[24:27], 0
    v_mfma_f32_16x16x32_bf16 v[120:123], a[232:235], a[28:31], v[120:123]
    ds_read_b64_tr_b16 a[240:241], v195 offset:24576
    ds_read_b64_tr_b16 a[242:243], v195 offset:26624
    v_mfma_f32_16x16x32_bf16 v[124:127], a[232:235], a[32:35], v[124:127]
    s_addk_i32 s58, 7168
    buffer_load_dwordx4 v197, s[20:23], s58 offen offset:2048 lds
    v_mfma_f32_16x16x32_bf16 v[128:131], a[232:235], a[36:39], v[128:131]
    v_mfma_f32_16x16x32_bf16 v[132:135], a[232:235], a[40:43], v[132:135]
    s_addk_i32 s58, 7168
    buffer_load_dwordx4 v197, s[20:23], s58 offen offset:3072 lds
    v_mfma_f32_16x16x32_bf16 v[136:139], a[232:235], a[44:47], v[136:139]
    v_mfma_f32_16x16x32_bf16 v[140:143], a[232:235], a[48:51], v[140:143]
    s_add_u32 m0, s49, 8192
    s_xor_b32 s56, s56, 0x1000
    s_waitcnt vmcnt(17)
    buffer_load_dwordx4 v5, s[12:15], s56 offen offset:0 nt lds
    v_mfma_f32_16x16x32_bf16 v[144:147], a[232:235], a[52:55], v[144:147]
    s_waitcnt lgkmcnt(2)
    v_mfma_f32_16x16x32_bf16 v[148:151], a[236:239], a[28:31], v[148:151]
    ds_read_b64_tr_b16 a[244:245], v196 offset:24576
    ds_read_b64_tr_b16 a[246:247], v196 offset:26624
    v_mfma_f32_16x16x32_bf16 v[152:155], a[236:239], a[32:35], v[152:155]
    s_waitcnt vmcnt(17)
    buffer_load_dwordx4 v6, s[12:15], s56 offen offset:1024 nt lds
    v_mfma_f32_16x16x32_bf16 v[156:159], a[236:239], a[36:39], v[156:159]
    v_mfma_f32_16x16x32_bf16 v[160:163], a[236:239], a[40:43], v[160:163]
    s_waitcnt vmcnt(13)
    buffer_load_dwordx4 v5, s[12:15], s56 offen offset:2048 nt lds
    v_mfma_f32_16x16x32_bf16 v[164:167], a[236:239], a[44:47], v[164:167]
    v_mfma_f32_16x16x32_bf16 v[168:171], a[236:239], a[48:51], v[168:171]
    s_waitcnt vmcnt(13)
    buffer_load_dwordx4 v6, s[12:15], s56 offen offset:3072 nt lds
    v_mfma_f32_16x16x32_bf16 v[172:175], a[236:239], a[52:55], v[172:175]
    s_waitcnt lgkmcnt(2)
    v_mfma_f32_16x16x32_bf16 v[120:123], a[240:243], a[56:59], v[120:123]
    ds_read_b64_tr_b16 a[248:249], v195 offset:28672
    ds_read_b64_tr_b16 a[250:251], v195 offset:30720
    v_mfma_f32_16x16x32_bf16 v[124:127], a[240:243], a[60:63], v[124:127]
    s_barrier
    s_add_u32 m0, s48, 16384
    s_xor_b32 s56, s47, 90112
    s_waitcnt vmcnt(13)
    buffer_load_dwordx4 v5, s[8:11], s56 offen offset:0 nt lds
    v_mfma_f32_16x16x32_bf16 v[128:131], a[240:243], a[64:67], v[128:131]
    v_mfma_f32_16x16x32_bf16 v[132:135], a[240:243], a[68:71], v[132:135]
    s_waitcnt vmcnt(13)
    buffer_load_dwordx4 v6, s[8:11], s56 offen offset:1024 nt lds
    v_mfma_f32_16x16x32_bf16 v[136:139], a[240:243], a[72:75], v[136:139]
    v_mfma_f32_16x16x32_bf16 v[140:143], a[240:243], a[76:79], v[140:143]
    s_waitcnt vmcnt(13)
    buffer_load_dwordx4 v5, s[8:11], s56 offen offset:2048 nt lds
    v_mfma_f32_16x16x32_bf16 v[144:147], a[240:243], a[80:83], v[144:147]
    s_waitcnt lgkmcnt(2)
    v_mfma_f32_16x16x32_bf16 v[148:151], a[244:247], a[56:59], v[148:151]
    ds_read_b64_tr_b16 a[252:253], v196 offset:28672
    ds_read_b64_tr_b16 a[254:255], v196 offset:30720
    v_mfma_f32_16x16x32_bf16 v[152:155], a[244:247], a[60:63], v[152:155]
    s_waitcnt vmcnt(13)
    buffer_load_dwordx4 v6, s[8:11], s56 offen offset:3072 nt lds
    v_mfma_f32_16x16x32_bf16 v[156:159], a[244:247], a[64:67], v[156:159]
    v_mfma_f32_16x16x32_bf16 v[160:163], a[244:247], a[68:71], v[160:163]
    s_add_u32 m0, s65, 139264
    s_add_u32 s58, s44, 5
    s_and_b32 s58, s58, 7
    s_lshl_b32 s58, s58, 7
    s_add_u32 s58, s58, 32768
    buffer_load_dwordx4 v197, s[20:23], s58 offen offset:0 lds
    v_mfma_f32_16x16x32_bf16 v[164:167], a[244:247], a[72:75], v[164:167]
    v_mfma_f32_16x16x32_bf16 v[168:171], a[244:247], a[76:79], v[168:171]
    v_mfma_f32_16x16x32_bf16 v[172:175], a[244:247], a[80:83], v[172:175]
    s_addk_i32 s58, 7168
    buffer_load_dwordx4 v197, s[20:23], s58 offen offset:1024 lds
    s_waitcnt lgkmcnt(2)
    v_mfma_f32_16x16x32_bf16 v[120:123], a[248:251], a[84:87], v[120:123]
    ds_read_b64_tr_b16 a[224:225], v195 offset:32768
    ds_read_b64_tr_b16 a[226:227], v195 offset:34816
    v_mfma_f32_16x16x32_bf16 v[124:127], a[248:251], a[88:91], v[124:127]
    s_addk_i32 s58, 7168
    buffer_load_dwordx4 v197, s[20:23], s58 offen offset:2048 lds
    v_mfma_f32_16x16x32_bf16 v[128:131], a[248:251], a[92:95], v[128:131]
    v_mfma_f32_16x16x32_bf16 v[132:135], a[248:251], a[96:99], v[132:135]
    s_addk_i32 s58, 7168
    buffer_load_dwordx4 v197, s[20:23], s58 offen offset:3072 lds
    v_mfma_f32_16x16x32_bf16 v[136:139], a[248:251], a[100:103], v[136:139]
    v_mfma_f32_16x16x32_bf16 v[140:143], a[248:251], a[104:107], v[140:143]
    v_mfma_f32_16x16x32_bf16 v[144:147], a[248:251], a[108:111], v[144:147]
    s_add_u32 m0, s49, 16384
    s_xor_b32 s56, s56, 0x1000
    s_waitcnt vmcnt(17)
    buffer_load_dwordx4 v5, s[8:11], s56 offen offset:0 nt lds
    s_waitcnt lgkmcnt(2)
    v_mfma_f32_16x16x32_bf16 v[148:151], a[252:255], a[84:87], v[148:151]
    ds_read_b64_tr_b16 a[228:229], v196 offset:32768
    ds_read_b64_tr_b16 a[230:231], v196 offset:34816
    v_mfma_f32_16x16x32_bf16 v[152:155], a[252:255], a[88:91], v[152:155]
    s_waitcnt vmcnt(17)
    buffer_load_dwordx4 v6, s[8:11], s56 offen offset:1024 nt lds
    v_mfma_f32_16x16x32_bf16 v[156:159], a[252:255], a[92:95], v[156:159]
    v_mfma_f32_16x16x32_bf16 v[160:163], a[252:255], a[96:99], v[160:163]
    v_mfma_f32_16x16x32_bf16 v[164:167], a[252:255], a[100:103], v[164:167]
    s_waitcnt vmcnt(13)
    buffer_load_dwordx4 v5, s[8:11], s56 offen offset:2048 nt lds
    v_mfma_f32_16x16x32_bf16 v[168:171], a[252:255], a[104:107], v[168:171]
    v_mfma_f32_16x16x32_bf16 v[172:175], a[252:255], a[108:111], v[172:175]
    s_waitcnt vmcnt(13)
    buffer_load_dwordx4 v6, s[8:11], s56 offen offset:3072 nt lds
    s_waitcnt lgkmcnt(2)
    v_mfma_f32_16x16x32_bf16 v[120:123], a[224:227], a[112:115], v[120:123]
    ds_read_b64_tr_b16 a[232:233], v195 offset:36864
    ds_read_b64_tr_b16 a[234:235], v195 offset:38912
    v_mfma_f32_16x16x32_bf16 v[124:127], a[224:227], a[116:119], v[124:127]
    v_mfma_f32_16x16x32_bf16 v[128:131], a[224:227], a[120:123], v[128:131]
    s_barrier
    s_add_u32 m0, s48, 24576
    s_xor_b32 s56, s47, 90112
    s_waitcnt vmcnt(13)
    buffer_load_dwordx4 v5, s[12:15], s56 offen offset:0 nt lds
    v_mfma_f32_16x16x32_bf16 v[132:135], a[224:227], a[124:127], v[132:135]
    v_mfma_f32_16x16x32_bf16 v[136:139], a[224:227], a[128:131], v[136:139]
    s_waitcnt vmcnt(13)
    buffer_load_dwordx4 v6, s[12:15], s56 offen offset:1024 nt lds
    v_mfma_f32_16x16x32_bf16 v[140:143], a[224:227], a[132:135], v[140:143]
    v_mfma_f32_16x16x32_bf16 v[144:147], a[224:227], a[136:139], v[144:147]
    s_waitcnt lgkmcnt(2)
    v_mfma_f32_16x16x32_bf16 v[148:151], a[228:231], a[112:115], v[148:151]
    ds_read_b64_tr_b16 a[236:237], v196 offset:36864
    ds_read_b64_tr_b16 a[238:239], v196 offset:38912
    s_waitcnt vmcnt(13)
    buffer_load_dwordx4 v5, s[12:15], s56 offen offset:2048 nt lds
    v_mfma_f32_16x16x32_bf16 v[152:155], a[228:231], a[116:119], v[152:155]
    v_mfma_f32_16x16x32_bf16 v[156:159], a[228:231], a[120:123], v[156:159]
    s_waitcnt vmcnt(13)
    buffer_load_dwordx4 v6, s[12:15], s56 offen offset:3072 nt lds
    v_mfma_f32_16x16x32_bf16 v[160:163], a[228:231], a[124:127], v[160:163]
    v_mfma_f32_16x16x32_bf16 v[164:167], a[228:231], a[128:131], v[164:167]
    v_mfma_f32_16x16x32_bf16 v[168:171], a[228:231], a[132:135], v[168:171]
    s_add_u32 m0, s65, 147456
    s_add_u32 s58, s44, 5
    s_and_b32 s58, s58, 7
    s_lshl_b32 s58, s58, 7
    s_add_u32 s58, s58, 65536
    buffer_load_dwordx4 v197, s[20:23], s58 offen offset:0 lds
    v_mfma_f32_16x16x32_bf16 v[172:175], a[228:231], a[136:139], v[172:175]
    s_waitcnt lgkmcnt(2)
    v_mfma_f32_16x16x32_bf16 v[120:123], a[232:235], a[140:143], v[120:123]
    ds_read_b64_tr_b16 a[240:241], v195 offset:0
    ds_read_b64_tr_b16 a[242:243], v195 offset:2048
    s_addk_i32 s58, 7168
    buffer_load_dwordx4 v197, s[20:23], s58 offen offset:1024 lds
    v_mfma_f32_16x16x32_bf16 v[124:127], a[232:235], a[144:147], v[124:127]
    v_mfma_f32_16x16x32_bf16 v[128:131], a[232:235], a[148:151], v[128:131]
    v_mfma_f32_16x16x32_bf16 v[132:135], a[232:235], a[152:155], v[132:135]
    s_addk_i32 s58, 7168
    buffer_load_dwordx4 v197, s[20:23], s58 offen offset:2048 lds
    v_mfma_f32_16x16x32_bf16 v[136:139], a[232:235], a[156:159], v[136:139]
    v_mfma_f32_16x16x32_bf16 v[140:143], a[232:235], a[160:163], v[140:143]
    s_addk_i32 s58, 7168
    buffer_load_dwordx4 v197, s[20:23], s58 offen offset:3072 lds
    v_mfma_f32_16x16x32_bf16 v[144:147], a[232:235], a[164:167], v[144:147]
    s_waitcnt lgkmcnt(2)
    v_mfma_f32_16x16x32_bf16 v[148:151], a[236:239], a[140:143], v[148:151]
    ds_read_b64_tr_b16 a[244:245], v196 offset:0
    ds_read_b64_tr_b16 a[246:247], v196 offset:2048
    v_mfma_f32_16x16x32_bf16 v[152:155], a[236:239], a[144:147], v[152:155]
    s_add_u32 m0, s49, 24576
    s_xor_b32 s56, s56, 0x1000
    s_waitcnt vmcnt(17)
    buffer_load_dwordx4 v5, s[12:15], s56 offen offset:0 nt lds
    v_mfma_f32_16x16x32_bf16 v[156:159], a[236:239], a[148:151], v[156:159]
    v_mfma_f32_16x16x32_bf16 v[160:163], a[236:239], a[152:155], v[160:163]
    s_waitcnt vmcnt(17)
    buffer_load_dwordx4 v6, s[12:15], s56 offen offset:1024 nt lds
    v_mfma_f32_16x16x32_bf16 v[164:167], a[236:239], a[156:159], v[164:167]
    v_mfma_f32_16x16x32_bf16 v[168:171], a[236:239], a[160:163], v[168:171]
    v_mfma_f32_16x16x32_bf16 v[172:175], a[236:239], a[164:167], v[172:175]
    s_waitcnt vmcnt(13)
    buffer_load_dwordx4 v5, s[12:15], s56 offen offset:2048 nt lds
    s_waitcnt lgkmcnt(2)
    v_mfma_f32_16x16x32_bf16 v[120:123], a[240:243], a[168:171], v[120:123]
    ds_read_b64_tr_b16 a[248:249], v195 offset:4096
    ds_read_b64_tr_b16 a[250:251], v195 offset:6144
    v_mfma_f32_16x16x32_bf16 v[124:127], a[240:243], a[172:175], v[124:127]
    s_waitcnt vmcnt(13)
    buffer_load_dwordx4 v6, s[12:15], s56 offen offset:3072 nt lds
    v_mfma_f32_16x16x32_bf16 v[128:131], a[240:243], a[176:179], v[128:131]
    v_mfma_f32_16x16x32_bf16 v[132:135], a[240:243], a[180:183], v[132:135]
    v_mfma_f32_16x16x32_bf16 v[136:139], a[240:243], a[184:187], v[136:139]
    s_barrier
    s_add_u32 m0, s48, 0
    s_xor_b32 s56, s47, 98304
    s_waitcnt vmcnt(13)
    buffer_load_dwordx4 v5, s[8:11], s56 offen offset:0 nt lds
    v_mfma_f32_16x16x32_bf16 v[140:143], a[240:243], a[188:191], v[140:143]
    v_mfma_f32_16x16x32_bf16 v[144:147], a[240:243], a[192:195], v[144:147]
    s_waitcnt vmcnt(13)
    buffer_load_dwordx4 v6, s[8:11], s56 offen offset:1024 nt lds
    s_waitcnt lgkmcnt(2)
    v_mfma_f32_16x16x32_bf16 v[148:151], a[244:247], a[168:171], v[148:151]
    ds_read_b64_tr_b16 a[252:253], v196 offset:4096
    ds_read_b64_tr_b16 a[254:255], v196 offset:6144
    v_mfma_f32_16x16x32_bf16 v[152:155], a[244:247], a[172:175], v[152:155]
    v_mfma_f32_16x16x32_bf16 v[156:159], a[244:247], a[176:179], v[156:159]
    s_waitcnt vmcnt(13)
    buffer_load_dwordx4 v5, s[8:11], s56 offen offset:2048 nt lds
    v_mfma_f32_16x16x32_bf16 v[160:163], a[244:247], a[180:183], v[160:163]
    v_mfma_f32_16x16x32_bf16 v[164:167], a[244:247], a[184:187], v[164:167]
    s_waitcnt vmcnt(13)
    buffer_load_dwordx4 v6, s[8:11], s56 offen offset:3072 nt lds
    v_mfma_f32_16x16x32_bf16 v[168:171], a[244:247], a[188:191], v[168:171]
    v_mfma_f32_16x16x32_bf16 v[172:175], a[244:247], a[192:195], v[172:175]
    s_waitcnt lgkmcnt(2)
    v_mfma_f32_16x16x32_bf16 v[120:123], a[248:251], a[196:199], v[120:123]
    ds_read_b64_tr_b16 a[224:225], v195 offset:8192
    ds_read_b64_tr_b16 a[226:227], v195 offset:10240
    s_add_u32 m0, s65, 155648
    s_add_u32 s58, s44, 5
    s_and_b32 s58, s58, 7
    s_lshl_b32 s58, s58, 7
    s_add_u32 s58, s58, 98304
    buffer_load_dwordx4 v197, s[20:23], s58 offen offset:0 lds
    v_mfma_f32_16x16x32_bf16 v[124:127], a[248:251], a[200:203], v[124:127]
    v_mfma_f32_16x16x32_bf16 v[128:131], a[248:251], a[204:207], v[128:131]
    s_addk_i32 s58, 7168
    buffer_load_dwordx4 v197, s[20:23], s58 offen offset:1024 lds
    v_mfma_f32_16x16x32_bf16 v[132:135], a[248:251], a[208:211], v[132:135]
    v_mfma_f32_16x16x32_bf16 v[136:139], a[248:251], a[212:215], v[136:139]
    v_mfma_f32_16x16x32_bf16 v[140:143], a[248:251], a[216:219], v[140:143]
    s_addk_i32 s58, 7168
    buffer_load_dwordx4 v197, s[20:23], s58 offen offset:2048 lds
    v_mfma_f32_16x16x32_bf16 v[144:147], a[248:251], a[220:223], v[144:147]
    s_waitcnt lgkmcnt(2)
    v_mfma_f32_16x16x32_bf16 v[148:151], a[252:255], a[196:199], v[148:151]
    ds_read_b64_tr_b16 a[228:229], v196 offset:8192
    ds_read_b64_tr_b16 a[230:231], v196 offset:10240
    s_addk_i32 s58, 7168
    buffer_load_dwordx4 v197, s[20:23], s58 offen offset:3072 lds
    v_mfma_f32_16x16x32_bf16 v[152:155], a[252:255], a[200:203], v[152:155]
    v_mfma_f32_16x16x32_bf16 v[156:159], a[252:255], a[204:207], v[156:159]
    v_cvt_pk_bf16_f32 v50, v120, v121
    v_cvt_pk_bf16_f32 v51, v122, v123
    v_cvt_pk_bf16_f32 v52, v124, v125
    v_mfma_f32_16x16x32_bf16 v[160:163], a[252:255], a[208:211], v[160:163]
    v_cvt_pk_bf16_f32 v53, v126, v127
    v_cvt_pk_bf16_f32 v54, v128, v129
    v_cvt_pk_bf16_f32 v55, v130, v131
    s_add_u32 m0, s49, 0
    s_xor_b32 s56, s56, 0x1000
    s_waitcnt vmcnt(17)
    buffer_load_dwordx4 v5, s[8:11], s56 offen offset:0 nt lds
    v_mfma_f32_16x16x32_bf16 v[164:167], a[252:255], a[212:215], v[164:167]
    v_cvt_pk_bf16_f32 v56, v132, v133
    v_cvt_pk_bf16_f32 v57, v134, v135
    v_cvt_pk_bf16_f32 v58, v136, v137
    v_mfma_f32_16x16x32_bf16 v[168:171], a[252:255], a[216:219], v[168:171]
    v_cvt_pk_bf16_f32 v59, v138, v139
    v_cvt_pk_bf16_f32 v60, v140, v141
    v_cvt_pk_bf16_f32 v61, v142, v143
    s_waitcnt vmcnt(17)
    buffer_load_dwordx4 v6, s[8:11], s56 offen offset:1024 nt lds
    v_mfma_f32_16x16x32_bf16 v[172:175], a[252:255], a[220:223], v[172:175]
    v_cvt_pk_bf16_f32 v62, v144, v145
    v_cvt_pk_bf16_f32 v63, v146, v147
    s_waitcnt lgkmcnt(2)
    v_mfma_f32_16x16x32_bf16 v[120:123], a[224:227], a[0:3], 0
    ds_read_b64_tr_b16 a[232:233], v195 offset:12288
    ds_read_b64_tr_b16 a[234:235], v195 offset:14336
    v_mfma_f32_16x16x32_bf16 v[124:127], a[224:227], a[4:7], 0
    s_waitcnt vmcnt(13)
    buffer_load_dwordx4 v5, s[8:11], s56 offen offset:2048 nt lds
    v_mfma_f32_16x16x32_bf16 v[128:131], a[224:227], a[8:11], 0
    v_cvt_pk_bf16_f32 v148, v148, v149
    v_cvt_pk_bf16_f32 v149, v150, v151
    v_cvt_pk_bf16_f32 v150, v152, v153
    v_cvt_pk_bf16_f32 v151, v154, v155
    v_mfma_f32_16x16x32_bf16 v[132:135], a[224:227], a[12:15], 0
    v_cvt_pk_bf16_f32 v152, v156, v157
    v_cvt_pk_bf16_f32 v153, v158, v159
    v_cvt_pk_bf16_f32 v154, v160, v161
    v_cvt_pk_bf16_f32 v155, v162, v163
    s_waitcnt vmcnt(13)
    buffer_load_dwordx4 v6, s[8:11], s56 offen offset:3072 nt lds
    v_mfma_f32_16x16x32_bf16 v[136:139], a[224:227], a[16:19], 0
    v_cvt_pk_bf16_f32 v156, v164, v165
    v_cvt_pk_bf16_f32 v157, v166, v167
    v_cvt_pk_bf16_f32 v158, v168, v169
    v_mfma_f32_16x16x32_bf16 v[140:143], a[224:227], a[20:23], 0
    v_cvt_pk_bf16_f32 v159, v170, v171
    v_cvt_pk_bf16_f32 v160, v172, v173
    v_cvt_pk_bf16_f32 v161, v174, v175
    ds_write_b128 v208, v[148:151] offset:10752
    v_mfma_f32_16x16x32_bf16 v[144:147], a[224:227], a[24:27], 0
    ds_write_b128 v208, v[152:155] offset:11776
    ds_write_b128 v208, v[156:159] offset:12800
    ds_write_b64 v209, v[160:161] offset:13824
    s_barrier
    s_add_u32 m0, s48, 8192
    s_xor_b32 s56, s47, 98304
    s_waitcnt vmcnt(13)
    buffer_load_dwordx4 v5, s[12:15], s56 offen offset:0 nt lds
    s_waitcnt lgkmcnt(0)
    v_mfma_f32_16x16x32_bf16 v[148:151], a[228:231], a[0:3], 0
    ds_read_b64_tr_b16 a[236:237], v196 offset:12288
    ds_read_b64_tr_b16 a[238:239], v196 offset:14336
    v_mfma_f32_16x16x32_bf16 v[152:155], a[228:231], a[4:7], 0
    s_waitcnt vmcnt(13)
    buffer_load_dwordx4 v6, s[12:15], s56 offen offset:1024 nt lds
    v_mfma_f32_16x16x32_bf16 v[156:159], a[228:231], a[8:11], 0
    v_mfma_f32_16x16x32_bf16 v[160:163], a[228:231], a[12:15], 0
    v_mfma_f32_16x16x32_bf16 v[164:167], a[228:231], a[16:19], 0
    s_waitcnt vmcnt(13)
    buffer_load_dwordx4 v5, s[12:15], s56 offen offset:2048 nt lds
    v_mfma_f32_16x16x32_bf16 v[168:171], a[228:231], a[20:23], 0
    v_mfma_f32_16x16x32_bf16 v[172:175], a[228:231], a[24:27], 0
    s_waitcnt vmcnt(13)
    buffer_load_dwordx4 v6, s[12:15], s56 offen offset:3072 nt lds
    v_mfma_f32_16x16x32_bf16 v[120:123], a[232:235], a[28:31], v[120:123]
    ds_read_b64_tr_b16 a[240:241], v195 offset:16384
    ds_read_b64_tr_b16 a[242:243], v195 offset:18432
    v_mfma_f32_16x16x32_bf16 v[124:127], a[232:235], a[32:35], v[124:127]
    v_mfma_f32_16x16x32_bf16 v[128:131], a[232:235], a[36:39], v[128:131]
    s_add_u32 m0, s65, 122880
    s_add_u32 s58, s44, 6
    s_and_b32 s58, s58, 7
    s_lshl_b32 s58, s58, 7
    buffer_load_dwordx4 v197, s[20:23], s58 offen offset:0 lds
    v_mfma_f32_16x16x32_bf16 v[132:135], a[232:235], a[40:43], v[132:135]
    v_mfma_f32_16x16x32_bf16 v[136:139], a[232:235], a[44:47], v[136:139]
    s_addk_i32 s58, 7168
    buffer_load_dwordx4 v197, s[20:23], s58 offen offset:1024 lds
    v_mfma_f32_16x16x32_bf16 v[140:143], a[232:235], a[48:51], v[140:143]
    v_mfma_f32_16x16x32_bf16 v[144:147], a[232:235], a[52:55], v[144:147]
    s_waitcnt lgkmcnt(2)
    v_mfma_f32_16x16x32_bf16 v[148:151], a[236:239], a[28:31], v[148:151]
    ds_read_b64_tr_b16 a[244:245], v196 offset:16384
    ds_read_b64_tr_b16 a[246:247], v196 offset:18432
    s_addk_i32 s58, 7168
    buffer_load_dwordx4 v197, s[20:23], s58 offen offset:2048 lds
    v_mfma_f32_16x16x32_bf16 v[152:155], a[236:239], a[32:35], v[152:155]
    v_mfma_f32_16x16x32_bf16 v[156:159], a[236:239], a[36:39], v[156:159]
    v_mfma_f32_16x16x32_bf16 v[160:163], a[236:239], a[40:43], v[160:163]
    s_addk_i32 s58, 7168
    buffer_load_dwordx4 v197, s[20:23], s58 offen offset:3072 lds
    v_mfma_f32_16x16x32_bf16 v[164:167], a[236:239], a[44:47], v[164:167]
    v_mfma_f32_16x16x32_bf16 v[168:171], a[236:239], a[48:51], v[168:171]
    s_add_u32 m0, s49, 8192
    s_xor_b32 s56, s56, 0x1000
    s_waitcnt vmcnt(17)
    buffer_load_dwordx4 v5, s[12:15], s56 offen offset:0 nt lds
    v_mfma_f32_16x16x32_bf16 v[172:175], a[236:239], a[52:55], v[172:175]
    s_waitcnt lgkmcnt(2)
    v_mfma_f32_16x16x32_bf16 v[120:123], a[240:243], a[56:59], v[120:123]
    ds_read_b64_tr_b16 a[248:249], v195 offset:20480
    ds_read_b64_tr_b16 a[250:251], v195 offset:22528
    v_mfma_f32_16x16x32_bf16 v[124:127], a[240:243], a[60:63], v[124:127]
    s_waitcnt vmcnt(17)
    buffer_load_dwordx4 v6, s[12:15], s56 offen offset:1024 nt lds
    v_mfma_f32_16x16x32_bf16 v[128:131], a[240:243], a[64:67], v[128:131]
    v_mfma_f32_16x16x32_bf16 v[132:135], a[240:243], a[68:71], v[132:135]
    s_waitcnt vmcnt(13)
    buffer_load_dwordx4 v5, s[12:15], s56 offen offset:2048 nt lds
    v_mfma_f32_16x16x32_bf16 v[136:139], a[240:243], a[72:75], v[136:139]
    v_mfma_f32_16x16x32_bf16 v[140:143], a[240:243], a[76:79], v[140:143]
    v_mfma_f32_16x16x32_bf16 v[144:147], a[240:243], a[80:83], v[144:147]
    s_waitcnt vmcnt(13)
    buffer_load_dwordx4 v6, s[12:15], s56 offen offset:3072 nt lds
    s_waitcnt lgkmcnt(2)
    v_mfma_f32_16x16x32_bf16 v[148:151], a[244:247], a[56:59], v[148:151]
    ds_read_b64_tr_b16 a[252:253], v196 offset:20480
    ds_read_b64_tr_b16 a[254:255], v196 offset:22528
    v_mfma_f32_16x16x32_bf16 v[152:155], a[244:247], a[60:63], v[152:155]
    v_mfma_f32_16x16x32_bf16 v[156:159], a[244:247], a[64:67], v[156:159]
    s_barrier
    s_add_u32 m0, s48, 16384
    s_xor_b32 s56, s47, 106496
    s_waitcnt vmcnt(13)
    buffer_load_dwordx4 v5, s[8:11], s56 offen offset:0 nt lds
    v_mfma_f32_16x16x32_bf16 v[160:163], a[244:247], a[68:71], v[160:163]
    v_mfma_f32_16x16x32_bf16 v[164:167], a[244:247], a[72:75], v[164:167]
    s_waitcnt vmcnt(13)
    buffer_load_dwordx4 v6, s[8:11], s56 offen offset:1024 nt lds
    v_mfma_f32_16x16x32_bf16 v[168:171], a[244:247], a[76:79], v[168:171]
    v_mfma_f32_16x16x32_bf16 v[172:175], a[244:247], a[80:83], v[172:175]
    s_waitcnt lgkmcnt(2)
    v_mfma_f32_16x16x32_bf16 v[120:123], a[248:251], a[84:87], v[120:123]
    ds_read_b64_tr_b16 a[224:225], v195 offset:24576
    ds_read_b64_tr_b16 a[226:227], v195 offset:26624
    s_waitcnt vmcnt(13)
    buffer_load_dwordx4 v5, s[8:11], s56 offen offset:2048 nt lds
    v_mfma_f32_16x16x32_bf16 v[124:127], a[248:251], a[88:91], v[124:127]
    v_mfma_f32_16x16x32_bf16 v[128:131], a[248:251], a[92:95], v[128:131]
    s_waitcnt vmcnt(13)
    buffer_load_dwordx4 v6, s[8:11], s56 offen offset:3072 nt lds
    v_mfma_f32_16x16x32_bf16 v[132:135], a[248:251], a[96:99], v[132:135]
    v_mfma_f32_16x16x32_bf16 v[136:139], a[248:251], a[100:103], v[136:139]
    v_mfma_f32_16x16x32_bf16 v[140:143], a[248:251], a[104:107], v[140:143]
    s_add_u32 m0, s65, 131072
    s_add_u32 s58, s44, 6
    s_and_b32 s58, s58, 7
    s_lshl_b32 s58, s58, 7
    s_add_u32 s58, s58, 32768
    buffer_load_dwordx4 v197, s[20:23], s58 offen offset:0 lds
    v_mfma_f32_16x16x32_bf16 v[144:147], a[248:251], a[108:111], v[144:147]
    s_waitcnt lgkmcnt(2)
    v_mfma_f32_16x16x32_bf16 v[148:151], a[252:255], a[84:87], v[148:151]
    ds_read_b64_tr_b16 a[228:229], v196 offset:24576
    ds_read_b64_tr_b16 a[230:231], v196 offset:26624
    s_addk_i32 s58, 7168
    buffer_load_dwordx4 v197, s[20:23], s58 offen offset:1024 lds
    v_mfma_f32_16x16x32_bf16 v[152:155], a[252:255], a[88:91], v[152:155]
    v_mfma_f32_16x16x32_bf16 v[156:159], a[252:255], a[92:95], v[156:159]
    v_mfma_f32_16x16x32_bf16 v[160:163], a[252:255], a[96:99], v[160:163]
    s_addk_i32 s58, 7168
    buffer_load_dwordx4 v197, s[20:23], s58 offen offset:2048 lds
    v_mfma_f32_16x16x32_bf16 v[164:167], a[252:255], a[100:103], v[164:167]
    v_mfma_f32_16x16x32_bf16 v[168:171], a[252:255], a[104:107], v[168:171]
    v_mfma_f32_16x16x32_bf16 v[172:175], a[252:255], a[108:111], v[172:175]
    s_addk_i32 s58, 7168
    buffer_load_dwordx4 v197, s[20:23], s58 offen offset:3072 lds
    s_waitcnt lgkmcnt(2)
    v_mfma_f32_16x16x32_bf16 v[120:123], a[224:227], a[112:115], v[120:123]
    ds_read_b64_tr_b16 a[232:233], v195 offset:28672
    ds_read_b64_tr_b16 a[234:235], v195 offset:30720
    v_mfma_f32_16x16x32_bf16 v[124:127], a[224:227], a[116:119], v[124:127]
    s_add_u32 m0, s49, 16384
    s_xor_b32 s56, s56, 0x1000
    s_waitcnt vmcnt(17)
    buffer_load_dwordx4 v5, s[8:11], s56 offen offset:0 nt lds
    v_mfma_f32_16x16x32_bf16 v[128:131], a[224:227], a[120:123], v[128:131]
    v_mfma_f32_16x16x32_bf16 v[132:135], a[224:227], a[124:127], v[132:135]
    v_mfma_f32_16x16x32_bf16 v[136:139], a[224:227], a[128:131], v[136:139]
    s_waitcnt vmcnt(17)
    buffer_load_dwordx4 v6, s[8:11], s56 offen offset:1024 nt lds
    v_mfma_f32_16x16x32_bf16 v[140:143], a[224:227], a[132:135], v[140:143]
    v_mfma_f32_16x16x32_bf16 v[144:147], a[224:227], a[136:139], v[144:147]
    s_waitcnt vmcnt(13)
    buffer_load_dwordx4 v5, s[8:11], s56 offen offset:2048 nt lds
    s_waitcnt lgkmcnt(2)
    v_mfma_f32_16x16x32_bf16 v[148:151], a[228:231], a[112:115], v[148:151]
    ds_read_b64_tr_b16 a[236:237], v196 offset:28672
    ds_read_b64_tr_b16 a[238:239], v196 offset:30720
    v_mfma_f32_16x16x32_bf16 v[152:155], a[228:231], a[116:119], v[152:155]
    v_mfma_f32_16x16x32_bf16 v[156:159], a[228:231], a[120:123], v[156:159]
    s_waitcnt vmcnt(13)
    buffer_load_dwordx4 v6, s[8:11], s56 offen offset:3072 nt lds
    v_mfma_f32_16x16x32_bf16 v[160:163], a[228:231], a[124:127], v[160:163]
    v_mfma_f32_16x16x32_bf16 v[164:167], a[228:231], a[128:131], v[164:167]
    v_mfma_f32_16x16x32_bf16 v[168:171], a[228:231], a[132:135], v[168:171]
    s_barrier
    s_add_u32 m0, s48, 24576
    s_xor_b32 s56, s47, 106496
    s_waitcnt vmcnt(13)
    buffer_load_dwordx4 v5, s[12:15], s56 offen offset:0 nt lds
    v_mfma_f32_16x16x32_bf16 v[172:175], a[228:231], a[136:139], v[172:175]
    s_waitcnt lgkmcnt(2)
    v_mfma_f32_16x16x32_bf16 v[120:123], a[232:235], a[140:143], v[120:123]
    ds_read_b64_tr_b16 a[240:241], v195 offset:32768
    ds_read_b64_tr_b16 a[242:243], v195 offset:34816
    s_waitcnt vmcnt(13)
    buffer_load_dwordx4 v6, s[12:15], s56 offen offset:1024 nt lds
    v_mfma_f32_16x16x32_bf16 v[124:127], a[232:235], a[144:147], v[124:127]
    v_mfma_f32_16x16x32_bf16 v[128:131], a[232:235], a[148:151], v[128:131]
    v_mfma_f32_16x16x32_bf16 v[132:135], a[232:235], a[152:155], v[132:135]
    s_waitcnt vmcnt(13)
    buffer_load_dwordx4 v5, s[12:15], s56 offen offset:2048 nt lds
    v_mfma_f32_16x16x32_bf16 v[136:139], a[232:235], a[156:159], v[136:139]
    v_mfma_f32_16x16x32_bf16 v[140:143], a[232:235], a[160:163], v[140:143]
    v_mfma_f32_16x16x32_bf16 v[144:147], a[232:235], a[164:167], v[144:147]
    s_waitcnt vmcnt(13)
    buffer_load_dwordx4 v6, s[12:15], s56 offen offset:3072 nt lds
    s_waitcnt lgkmcnt(2)
    v_mfma_f32_16x16x32_bf16 v[148:151], a[236:239], a[140:143], v[148:151]
    ds_read_b64_tr_b16 a[244:245], v196 offset:32768
    ds_read_b64_tr_b16 a[246:247], v196 offset:34816
    v_mfma_f32_16x16x32_bf16 v[152:155], a[236:239], a[144:147], v[152:155]
    s_add_u32 m0, s65, 139264
    s_add_u32 s58, s44, 6
    s_and_b32 s58, s58, 7
    s_lshl_b32 s58, s58, 7
    s_add_u32 s58, s58, 65536
    buffer_load_dwordx4 v197, s[20:23], s58 offen offset:0 lds
    v_mfma_f32_16x16x32_bf16 v[156:159], a[236:239], a[148:151], v[156:159]
    v_mfma_f32_16x16x32_bf16 v[160:163], a[236:239], a[152:155], v[160:163]
    v_mfma_f32_16x16x32_bf16 v[164:167], a[236:239], a[156:159], v[164:167]
    s_addk_i32 s58, 7168
    buffer_load_dwordx4 v197, s[20:23], s58 offen offset:1024 lds
    v_mfma_f32_16x16x32_bf16 v[168:171], a[236:239], a[160:163], v[168:171]
    v_mfma_f32_16x16x32_bf16 v[172:175], a[236:239], a[164:167], v[172:175]
    s_waitcnt lgkmcnt(2)
    v_mfma_f32_16x16x32_bf16 v[120:123], a[240:243], a[168:171], v[120:123]
    ds_read_b64_tr_b16 a[248:249], v195 offset:36864
    ds_read_b64_tr_b16 a[250:251], v195 offset:38912
    s_addk_i32 s58, 7168
    buffer_load_dwordx4 v197, s[20:23], s58 offen offset:2048 lds
    v_mfma_f32_16x16x32_bf16 v[124:127], a[240:243], a[172:175], v[124:127]
    v_mfma_f32_16x16x32_bf16 v[128:131], a[240:243], a[176:179], v[128:131]
    s_addk_i32 s58, 7168
    buffer_load_dwordx4 v197, s[20:23], s58 offen offset:3072 lds
    v_mfma_f32_16x16x32_bf16 v[132:135], a[240:243], a[180:183], v[132:135]
    v_mfma_f32_16x16x32_bf16 v[136:139], a[240:243], a[184:187], v[136:139]
    v_mfma_f32_16x16x32_bf16 v[140:143], a[240:243], a[188:191], v[140:143]
    s_add_u32 m0, s49, 24576
    s_xor_b32 s56, s56, 0x1000
    s_waitcnt vmcnt(17)
    buffer_load_dwordx4 v5, s[12:15], s56 offen offset:0 nt lds
    v_mfma_f32_16x16x32_bf16 v[144:147], a[240:243], a[192:195], v[144:147]
    s_waitcnt lgkmcnt(2)
    v_mfma_f32_16x16x32_bf16 v[148:151], a[244:247], a[168:171], v[148:151]
    ds_read_b64_tr_b16 a[252:253], v196 offset:36864
    ds_read_b64_tr_b16 a[254:255], v196 offset:38912
    v_mfma_f32_16x16x32_bf16 v[152:155], a[244:247], a[172:175], v[152:155]
    s_waitcnt vmcnt(17)
    buffer_load_dwordx4 v6, s[12:15], s56 offen offset:1024 nt lds
    v_mfma_f32_16x16x32_bf16 v[156:159], a[244:247], a[176:179], v[156:159]
    v_mfma_f32_16x16x32_bf16 v[160:163], a[244:247], a[180:183], v[160:163]
    s_waitcnt vmcnt(13)
    buffer_load_dwordx4 v5, s[12:15], s56 offen offset:2048 nt lds
    v_mfma_f32_16x16x32_bf16 v[164:167], a[244:247], a[184:187], v[164:167]
    v_mfma_f32_16x16x32_bf16 v[168:171], a[244:247], a[188:191], v[168:171]
    v_mfma_f32_16x16x32_bf16 v[172:175], a[244:247], a[192:195], v[172:175]
    s_waitcnt vmcnt(13)
    buffer_load_dwordx4 v6, s[12:15], s56 offen offset:3072 nt lds
    s_waitcnt lgkmcnt(2)
    v_mfma_f32_16x16x32_bf16 v[120:123], a[248:251], a[196:199], v[120:123]
    ds_read_b64_tr_b16 a[224:225], v195 offset:0
    ds_read_b64_tr_b16 a[226:227], v195 offset:2048
    v_mfma_f32_16x16x32_bf16 v[124:127], a[248:251], a[200:203], v[124:127]
    v_mfma_f32_16x16x32_bf16 v[128:131], a[248:251], a[204:207], v[128:131]
    s_barrier
    s_add_u32 m0, s48, 0
    s_xor_b32 s56, s47, 114688
    s_waitcnt vmcnt(13)
    buffer_load_dwordx4 v5, s[8:11], s56 offen offset:0 nt lds
    v_mfma_f32_16x16x32_bf16 v[132:135], a[248:251], a[208:211], v[132:135]
    v_mfma_f32_16x16x32_bf16 v[136:139], a[248:251], a[212:215], v[136:139]
    s_waitcnt vmcnt(13)
    buffer_load_dwordx4 v6, s[8:11], s56 offen offset:1024 nt lds
    v_mfma_f32_16x16x32_bf16 v[140:143], a[248:251], a[216:219], v[140:143]
    v_mfma_f32_16x16x32_bf16 v[144:147], a[248:251], a[220:223], v[144:147]
    s_waitcnt lgkmcnt(2)
    v_mfma_f32_16x16x32_bf16 v[148:151], a[252:255], a[196:199], v[148:151]
    ds_read_b64_tr_b16 a[228:229], v196 offset:0
    ds_read_b64_tr_b16 a[230:231], v196 offset:2048
    s_waitcnt vmcnt(13)
    buffer_load_dwordx4 v5, s[8:11], s56 offen offset:2048 nt lds
    v_mfma_f32_16x16x32_bf16 v[152:155], a[252:255], a[200:203], v[152:155]
    v_mfma_f32_16x16x32_bf16 v[156:159], a[252:255], a[204:207], v[156:159]
    v_cvt_pk_bf16_f32 v64, v120, v121
    v_cvt_pk_bf16_f32 v65, v122, v123
    v_cvt_pk_bf16_f32 v66, v124, v125
    v_mfma_f32_16x16x32_bf16 v[160:163], a[252:255], a[208:211], v[160:163]
    v_cvt_pk_bf16_f32 v67, v126, v127
    v_cvt_pk_bf16_f32 v68, v128, v129
    v_cvt_pk_bf16_f32 v69, v130, v131
    s_waitcnt vmcnt(13)
    buffer_load_dwordx4 v6, s[8:11], s56 offen offset:3072 nt lds
    v_mfma_f32_16x16x32_bf16 v[164:167], a[252:255], a[212:215], v[164:167]
    v_cvt_pk_bf16_f32 v70, v132, v133
    v_cvt_pk_bf16_f32 v71, v134, v135
    v_cvt_pk_bf16_f32 v72, v136, v137
    v_mfma_f32_16x16x32_bf16 v[168:171], a[252:255], a[216:219], v[168:171]
    v_cvt_pk_bf16_f32 v73, v138, v139
    v_cvt_pk_bf16_f32 v74, v140, v141
    v_cvt_pk_bf16_f32 v75, v142, v143
    s_add_u32 m0, s65, 147456
    s_add_u32 s58, s44, 6
    s_and_b32 s58, s58, 7
    s_lshl_b32 s58, s58, 7
    s_add_u32 s58, s58, 98304
    buffer_load_dwordx4 v197, s[20:23], s58 offen offset:0 lds
    v_mfma_f32_16x16x32_bf16 v[172:175], a[252:255], a[220:223], v[172:175]
    v_cvt_pk_bf16_f32 v76, v144, v145
    v_cvt_pk_bf16_f32 v77, v146, v147
    s_waitcnt lgkmcnt(2)
    v_mfma_f32_16x16x32_bf16 v[120:123], a[224:227], a[0:3], 0
    ds_read_b64_tr_b16 a[232:233], v195 offset:4096
    ds_read_b64_tr_b16 a[234:235], v195 offset:6144
    v_mfma_f32_16x16x32_bf16 v[124:127], a[224:227], a[4:7], 0
    s_addk_i32 s58, 7168
    buffer_load_dwordx4 v197, s[20:23], s58 offen offset:1024 lds
    v_mfma_f32_16x16x32_bf16 v[128:131], a[224:227], a[8:11], 0
    v_cvt_pk_bf16_f32 v148, v148, v149
    v_cvt_pk_bf16_f32 v149, v150, v151
    v_cvt_pk_bf16_f32 v150, v152, v153
    v_cvt_pk_bf16_f32 v151, v154, v155
    v_mfma_f32_16x16x32_bf16 v[132:135], a[224:227], a[12:15], 0
    v_cvt_pk_bf16_f32 v152, v156, v157
    v_cvt_pk_bf16_f32 v153, v158, v159
    v_cvt_pk_bf16_f32 v154, v160, v161
    v_cvt_pk_bf16_f32 v155, v162, v163
    v_mfma_f32_16x16x32_bf16 v[136:139], a[224:227], a[16:19], 0
    v_cvt_pk_bf16_f32 v156, v164, v165
    v_cvt_pk_bf16_f32 v157, v166, v167
    v_cvt_pk_bf16_f32 v158, v168, v169
    s_addk_i32 s58, 7168
    buffer_load_dwordx4 v197, s[20:23], s58 offen offset:2048 lds
    v_mfma_f32_16x16x32_bf16 v[140:143], a[224:227], a[20:23], 0
    v_cvt_pk_bf16_f32 v159, v170, v171
    v_cvt_pk_bf16_f32 v160, v172, v173
    v_cvt_pk_bf16_f32 v161, v174, v175
    ds_write_b128 v208, v[148:151] offset:14336
    v_mfma_f32_16x16x32_bf16 v[144:147], a[224:227], a[24:27], 0
    ds_write_b128 v208, v[152:155] offset:15360
    ds_write_b128 v208, v[156:159] offset:16384
    ds_write_b64 v209, v[160:161] offset:17408
    s_addk_i32 s58, 7168
    buffer_load_dwordx4 v197, s[20:23], s58 offen offset:3072 lds
    s_waitcnt lgkmcnt(0)
    v_mfma_f32_16x16x32_bf16 v[148:151], a[228:231], a[0:3], 0
    ds_read_b64_tr_b16 a[236:237], v196 offset:4096
    ds_read_b64_tr_b16 a[238:239], v196 offset:6144
    v_mfma_f32_16x16x32_bf16 v[152:155], a[228:231], a[4:7], 0
    v_mfma_f32_16x16x32_bf16 v[156:159], a[228:231], a[8:11], 0
    s_add_u32 m0, s49, 0
    s_xor_b32 s56, s56, 0x1000
    s_waitcnt vmcnt(17)
    buffer_load_dwordx4 v5, s[8:11], s56 offen offset:0 nt lds
    v_mfma_f32_16x16x32_bf16 v[160:163], a[228:231], a[12:15], 0
    v_mfma_f32_16x16x32_bf16 v[164:167], a[228:231], a[16:19], 0
    v_mfma_f32_16x16x32_bf16 v[168:171], a[228:231], a[20:23], 0
    s_waitcnt vmcnt(17)
    buffer_load_dwordx4 v6, s[8:11], s56 offen offset:1024 nt lds
    v_mfma_f32_16x16x32_bf16 v[172:175], a[228:231], a[24:27], 0
    v_mfma_f32_16x16x32_bf16 v[120:123], a[232:235], a[28:31], v[120:123]
    ds_read_b64_tr_b16 a[240:241], v195 offset:8192
    ds_read_b64_tr_b16 a[242:243], v195 offset:10240
    s_waitcnt vmcnt(13)
    buffer_load_dwordx4 v5, s[8:11], s56 offen offset:2048 nt lds
    v_mfma_f32_16x16x32_bf16 v[124:127], a[232:235], a[32:35], v[124:127]
    v_mfma_f32_16x16x32_bf16 v[128:131], a[232:235], a[36:39], v[128:131]
    v_mfma_f32_16x16x32_bf16 v[132:135], a[232:235], a[40:43], v[132:135]
    s_waitcnt vmcnt(13)
    buffer_load_dwordx4 v6, s[8:11], s56 offen offset:3072 nt lds
    v_mfma_f32_16x16x32_bf16 v[136:139], a[232:235], a[44:47], v[136:139]
    v_mfma_f32_16x16x32_bf16 v[140:143], a[232:235], a[48:51], v[140:143]
    v_mfma_f32_16x16x32_bf16 v[144:147], a[232:235], a[52:55], v[144:147]
    s_barrier
    s_add_u32 m0, s48, 8192
    s_xor_b32 s56, s47, 114688
    s_waitcnt vmcnt(13)
    buffer_load_dwordx4 v5, s[12:15], s56 offen offset:0 nt lds
    s_waitcnt lgkmcnt(2)
    v_mfma_f32_16x16x32_bf16 v[148:151], a[236:239], a[28:31], v[148:151]
    ds_read_b64_tr_b16 a[244:245], v196 offset:8192
    ds_read_b64_tr_b16 a[246:247], v196 offset:10240
    v_mfma_f32_16x16x32_bf16 v[152:155], a[236:239], a[32:35], v[152:155]
    s_waitcnt vmcnt(13)
    buffer_load_dwordx4 v6, s[12:15], s56 offen offset:1024 nt lds
    v_mfma_f32_16x16x32_bf16 v[156:159], a[236:239], a[36:39], v[156:159]
    v_mfma_f32_16x16x32_bf16 v[160:163], a[236:239], a[40:43], v[160:163]
    v_mfma_f32_16x16x32_bf16 v[164:167], a[236:239], a[44:47], v[164:167]
    s_waitcnt vmcnt(13)
    buffer_load_dwordx4 v5, s[12:15], s56 offen offset:2048 nt lds
    v_mfma_f32_16x16x32_bf16 v[168:171], a[236:239], a[48:51], v[168:171]
    v_mfma_f32_16x16x32_bf16 v[172:175], a[236:239], a[52:55], v[172:175]
    s_waitcnt lgkmcnt(2)
    v_mfma_f32_16x16x32_bf16 v[120:123], a[240:243], a[56:59], v[120:123]
    ds_read_b64_tr_b16 a[248:249], v195 offset:12288
    ds_read_b64_tr_b16 a[250:251], v195 offset:14336
    s_waitcnt vmcnt(13)
    buffer_load_dwordx4 v6, s[12:15], s56 offen offset:3072 nt lds
    v_mfma_f32_16x16x32_bf16 v[124:127], a[240:243], a[60:63], v[124:127]
    v_mfma_f32_16x16x32_bf16 v[128:131], a[240:243], a[64:67], v[128:131]
    v_mfma_f32_16x16x32_bf16 v[132:135], a[240:243], a[68:71], v[132:135]
    s_add_u32 m0, s65, 155648
    s_add_u32 s58, s44, 7
    s_and_b32 s58, s58, 7
    s_lshl_b32 s58, s58, 7
    buffer_load_dwordx4 v197, s[20:23], s58 offen offset:0 lds
    v_mfma_f32_16x16x32_bf16 v[136:139], a[240:243], a[72:75], v[136:139]
    v_mfma_f32_16x16x32_bf16 v[140:143], a[240:243], a[76:79], v[140:143]
    s_addk_i32 s58, 7168
    buffer_load_dwordx4 v197, s[20:23], s58 offen offset:1024 lds
    v_mfma_f32_16x16x32_bf16 v[144:147], a[240:243], a[80:83], v[144:147]
    s_waitcnt lgkmcnt(2)
    v_mfma_f32_16x16x32_bf16 v[148:151], a[244:247], a[56:59], v[148:151]
    ds_read_b64_tr_b16 a[252:253], v196 offset:12288
    ds_read_b64_tr_b16 a[254:255], v196 offset:14336
    v_mfma_f32_16x16x32_bf16 v[152:155], a[244:247], a[60:63], v[152:155]
    s_addk_i32 s58, 7168
    buffer_load_dwordx4 v197, s[20:23], s58 offen offset:2048 lds
    v_mfma_f32_16x16x32_bf16 v[156:159], a[244:247], a[64:67], v[156:159]
    v_mfma_f32_16x16x32_bf16 v[160:163], a[244:247], a[68:71], v[160:163]
    v_mfma_f32_16x16x32_bf16 v[164:167], a[244:247], a[72:75], v[164:167]
    s_addk_i32 s58, 7168
    buffer_load_dwordx4 v197, s[20:23], s58 offen offset:3072 lds
    v_mfma_f32_16x16x32_bf16 v[168:171], a[244:247], a[76:79], v[168:171]
    v_mfma_f32_16x16x32_bf16 v[172:175], a[244:247], a[80:83], v[172:175]
    s_waitcnt lgkmcnt(2)
    v_mfma_f32_16x16x32_bf16 v[120:123], a[248:251], a[84:87], v[120:123]
    ds_read_b64_tr_b16 a[224:225], v195 offset:16384
    ds_read_b64_tr_b16 a[226:227], v195 offset:18432
    s_add_u32 m0, s49, 8192
    s_xor_b32 s56, s56, 0x1000
    s_waitcnt vmcnt(17)
    buffer_load_dwordx4 v5, s[12:15], s56 offen offset:0 nt lds
    v_mfma_f32_16x16x32_bf16 v[124:127], a[248:251], a[88:91], v[124:127]
    v_mfma_f32_16x16x32_bf16 v[128:131], a[248:251], a[92:95], v[128:131]
    s_waitcnt vmcnt(17)
    buffer_load_dwordx4 v6, s[12:15], s56 offen offset:1024 nt lds
    v_mfma_f32_16x16x32_bf16 v[132:135], a[248:251], a[96:99], v[132:135]
    v_mfma_f32_16x16x32_bf16 v[136:139], a[248:251], a[100:103], v[136:139]
    v_mfma_f32_16x16x32_bf16 v[140:143], a[248:251], a[104:107], v[140:143]
    s_waitcnt vmcnt(13)
    buffer_load_dwordx4 v5, s[12:15], s56 offen offset:2048 nt lds
    v_mfma_f32_16x16x32_bf16 v[144:147], a[248:251], a[108:111], v[144:147]
    s_waitcnt lgkmcnt(2)
    v_mfma_f32_16x16x32_bf16 v[148:151], a[252:255], a[84:87], v[148:151]
    ds_read_b64_tr_b16 a[228:229], v196 offset:16384
    ds_read_b64_tr_b16 a[230:231], v196 offset:18432
    v_mfma_f32_16x16x32_bf16 v[152:155], a[252:255], a[88:91], v[152:155]
    s_waitcnt vmcnt(13)
    buffer_load_dwordx4 v6, s[12:15], s56 offen offset:3072 nt lds
    v_mfma_f32_16x16x32_bf16 v[156:159], a[252:255], a[92:95], v[156:159]
    v_mfma_f32_16x16x32_bf16 v[160:163], a[252:255], a[96:99], v[160:163]
    v_mfma_f32_16x16x32_bf16 v[164:167], a[252:255], a[100:103], v[164:167]
    s_barrier
    s_add_u32 m0, s48, 16384
    s_xor_b32 s56, s47, 122880
    s_waitcnt vmcnt(13)
    buffer_load_dwordx4 v5, s[8:11], s56 offen offset:0 nt lds
    v_mfma_f32_16x16x32_bf16 v[168:171], a[252:255], a[104:107], v[168:171]
    v_mfma_f32_16x16x32_bf16 v[172:175], a[252:255], a[108:111], v[172:175]
    s_waitcnt vmcnt(13)
    buffer_load_dwordx4 v6, s[8:11], s56 offen offset:1024 nt lds
    s_waitcnt lgkmcnt(2)
    v_mfma_f32_16x16x32_bf16 v[120:123], a[224:227], a[112:115], v[120:123]
    ds_read_b64_tr_b16 a[232:233], v195 offset:20480
    ds_read_b64_tr_b16 a[234:235], v195 offset:22528
    v_mfma_f32_16x16x32_bf16 v[124:127], a[224:227], a[116:119], v[124:127]
    s_waitcnt vmcnt(13)
    buffer_load_dwordx4 v5, s[8:11], s56 offen offset:2048 nt lds
    v_mfma_f32_16x16x32_bf16 v[128:131], a[224:227], a[120:123], v[128:131]
    v_mfma_f32_16x16x32_bf16 v[132:135], a[224:227], a[124:127], v[132:135]
    s_waitcnt vmcnt(13)
    buffer_load_dwordx4 v6, s[8:11], s56 offen offset:3072 nt lds
    v_mfma_f32_16x16x32_bf16 v[136:139], a[224:227], a[128:131], v[136:139]
    v_mfma_f32_16x16x32_bf16 v[140:143], a[224:227], a[132:135], v[140:143]
    s_add_u32 m0, s65, 122880
    s_add_u32 s58, s44, 7
    s_and_b32 s58, s58, 7
    s_lshl_b32 s58, s58, 7
    s_add_u32 s58, s58, 32768
    buffer_load_dwordx4 v197, s[20:23], s58 offen offset:0 lds
    v_mfma_f32_16x16x32_bf16 v[144:147], a[224:227], a[136:139], v[144:147]
    s_waitcnt lgkmcnt(2)
    v_mfma_f32_16x16x32_bf16 v[148:151], a[228:231], a[112:115], v[148:151]
    ds_read_b64_tr_b16 a[236:237], v196 offset:20480
    ds_read_b64_tr_b16 a[238:239], v196 offset:22528
    s_addk_i32 s58, 7168
    buffer_load_dwordx4 v197, s[20:23], s58 offen offset:1024 lds
    v_mfma_f32_16x16x32_bf16 v[152:155], a[228:231], a[116:119], v[152:155]
    v_mfma_f32_16x16x32_bf16 v[156:159], a[228:231], a[120:123], v[156:159]
    s_addk_i32 s58, 7168
    buffer_load_dwordx4 v197, s[20:23], s58 offen offset:2048 lds
    v_mfma_f32_16x16x32_bf16 v[160:163], a[228:231], a[124:127], v[160:163]
    v_mfma_f32_16x16x32_bf16 v[164:167], a[228:231], a[128:131], v[164:167]
    s_addk_i32 s58, 7168
    buffer_load_dwordx4 v197, s[20:23], s58 offen offset:3072 lds
    v_mfma_f32_16x16x32_bf16 v[168:171], a[228:231], a[132:135], v[168:171]
    v_mfma_f32_16x16x32_bf16 v[172:175], a[228:231], a[136:139], v[172:175]
    s_waitcnt lgkmcnt(2)
    v_mfma_f32_16x16x32_bf16 v[120:123], a[232:235], a[140:143], v[120:123]
    ds_read_b64_tr_b16 a[240:241], v195 offset:24576
    ds_read_b64_tr_b16 a[242:243], v195 offset:26624
    s_add_u32 m0, s65, 131072
    s_add_u32 s58, s44, 7
    s_and_b32 s58, s58, 7
    s_lshl_b32 s58, s58, 7
    s_add_u32 s58, s58, 65536
    buffer_load_dwordx4 v197, s[20:23], s58 offen offset:0 lds
    v_mfma_f32_16x16x32_bf16 v[124:127], a[232:235], a[144:147], v[124:127]
    v_mfma_f32_16x16x32_bf16 v[128:131], a[232:235], a[148:151], v[128:131]
    s_addk_i32 s58, 7168
    buffer_load_dwordx4 v197, s[20:23], s58 offen offset:1024 lds
    v_mfma_f32_16x16x32_bf16 v[132:135], a[232:235], a[152:155], v[132:135]
    v_mfma_f32_16x16x32_bf16 v[136:139], a[232:235], a[156:159], v[136:139]
    s_addk_i32 s58, 7168
    buffer_load_dwordx4 v197, s[20:23], s58 offen offset:2048 lds
    v_mfma_f32_16x16x32_bf16 v[140:143], a[232:235], a[160:163], v[140:143]
    v_mfma_f32_16x16x32_bf16 v[144:147], a[232:235], a[164:167], v[144:147]
    s_addk_i32 s58, 7168
    buffer_load_dwordx4 v197, s[20:23], s58 offen offset:3072 lds
    s_waitcnt lgkmcnt(2)
    v_mfma_f32_16x16x32_bf16 v[148:151], a[236:239], a[140:143], v[148:151]
    ds_read_b64_tr_b16 a[244:245], v196 offset:24576
    ds_read_b64_tr_b16 a[246:247], v196 offset:26624
    v_mfma_f32_16x16x32_bf16 v[152:155], a[236:239], a[144:147], v[152:155]
    s_add_u32 m0, s49, 16384
    s_xor_b32 s56, s56, 0x1000
    s_waitcnt vmcnt(21)
    buffer_load_dwordx4 v5, s[8:11], s56 offen offset:0 nt lds
    v_mfma_f32_16x16x32_bf16 v[156:159], a[236:239], a[148:151], v[156:159]
    v_mfma_f32_16x16x32_bf16 v[160:163], a[236:239], a[152:155], v[160:163]
    s_waitcnt vmcnt(21)
    buffer_load_dwordx4 v6, s[8:11], s56 offen offset:1024 nt lds
    v_mfma_f32_16x16x32_bf16 v[164:167], a[236:239], a[156:159], v[164:167]
    v_mfma_f32_16x16x32_bf16 v[168:171], a[236:239], a[160:163], v[168:171]
    s_waitcnt vmcnt(17)
    buffer_load_dwordx4 v5, s[8:11], s56 offen offset:2048 nt lds
    v_mfma_f32_16x16x32_bf16 v[172:175], a[236:239], a[164:167], v[172:175]
    s_waitcnt lgkmcnt(2)
    v_mfma_f32_16x16x32_bf16 v[120:123], a[240:243], a[168:171], v[120:123]
    ds_read_b64_tr_b16 a[248:249], v195 offset:28672
    ds_read_b64_tr_b16 a[250:251], v195 offset:30720
    s_waitcnt vmcnt(17)
    buffer_load_dwordx4 v6, s[8:11], s56 offen offset:3072 nt lds
    v_mfma_f32_16x16x32_bf16 v[124:127], a[240:243], a[172:175], v[124:127]
    v_mfma_f32_16x16x32_bf16 v[128:131], a[240:243], a[176:179], v[128:131]
    v_mfma_f32_16x16x32_bf16 v[132:135], a[240:243], a[180:183], v[132:135]
    s_barrier
    s_add_u32 m0, s48, 24576
    s_xor_b32 s56, s47, 122880
    s_waitcnt vmcnt(17)
    buffer_load_dwordx4 v5, s[12:15], s56 offen offset:0 nt lds
    v_mfma_f32_16x16x32_bf16 v[136:139], a[240:243], a[184:187], v[136:139]
    v_mfma_f32_16x16x32_bf16 v[140:143], a[240:243], a[188:191], v[140:143]
    s_waitcnt vmcnt(17)
    buffer_load_dwordx4 v6, s[12:15], s56 offen offset:1024 nt lds
    v_mfma_f32_16x16x32_bf16 v[144:147], a[240:243], a[192:195], v[144:147]
    s_waitcnt lgkmcnt(2)
    v_mfma_f32_16x16x32_bf16 v[148:151], a[244:247], a[168:171], v[148:151]
    ds_read_b64_tr_b16 a[252:253], v196 offset:28672
    ds_read_b64_tr_b16 a[254:255], v196 offset:30720
    v_mfma_f32_16x16x32_bf16 v[152:155], a[244:247], a[172:175], v[152:155]
    s_waitcnt vmcnt(17)
    buffer_load_dwordx4 v5, s[12:15], s56 offen offset:2048 nt lds
    v_mfma_f32_16x16x32_bf16 v[156:159], a[244:247], a[176:179], v[156:159]
    v_mfma_f32_16x16x32_bf16 v[160:163], a[244:247], a[180:183], v[160:163]
    v_mfma_f32_16x16x32_bf16 v[164:167], a[244:247], a[184:187], v[164:167]
    s_waitcnt vmcnt(17)
    buffer_load_dwordx4 v6, s[12:15], s56 offen offset:3072 nt lds
    v_mfma_f32_16x16x32_bf16 v[168:171], a[244:247], a[188:191], v[168:171]
    v_mfma_f32_16x16x32_bf16 v[172:175], a[244:247], a[192:195], v[172:175]
    s_waitcnt lgkmcnt(2)
    v_mfma_f32_16x16x32_bf16 v[120:123], a[248:251], a[196:199], v[120:123]
    ds_read_b64_tr_b16 a[224:225], v195 offset:32768
    ds_read_b64_tr_b16 a[226:227], v195 offset:34816
    s_add_u32 m0, s65, 139264
    s_add_u32 s58, s44, 7
    s_and_b32 s58, s58, 7
    s_lshl_b32 s58, s58, 7
    s_add_u32 s58, s58, 98304
    buffer_load_dwordx4 v197, s[20:23], s58 offen offset:0 lds
    v_mfma_f32_16x16x32_bf16 v[124:127], a[248:251], a[200:203], v[124:127]
    v_mfma_f32_16x16x32_bf16 v[128:131], a[248:251], a[204:207], v[128:131]
    v_mfma_f32_16x16x32_bf16 v[132:135], a[248:251], a[208:211], v[132:135]
    s_addk_i32 s58, 7168
    buffer_load_dwordx4 v197, s[20:23], s58 offen offset:1024 lds
    v_mfma_f32_16x16x32_bf16 v[136:139], a[248:251], a[212:215], v[136:139]
    v_mfma_f32_16x16x32_bf16 v[140:143], a[248:251], a[216:219], v[140:143]
    v_mfma_f32_16x16x32_bf16 v[144:147], a[248:251], a[220:223], v[144:147]
    s_addk_i32 s58, 7168
    buffer_load_dwordx4 v197, s[20:23], s58 offen offset:2048 lds
    s_waitcnt lgkmcnt(2)
    v_mfma_f32_16x16x32_bf16 v[148:151], a[252:255], a[196:199], v[148:151]
    ds_read_b64_tr_b16 a[228:229], v196 offset:32768
    ds_read_b64_tr_b16 a[230:231], v196 offset:34816
    v_mfma_f32_16x16x32_bf16 v[152:155], a[252:255], a[200:203], v[152:155]
    s_addk_i32 s58, 7168
    buffer_load_dwordx4 v197, s[20:23], s58 offen offset:3072 lds
    v_mfma_f32_16x16x32_bf16 v[156:159], a[252:255], a[204:207], v[156:159]
    v_cvt_pk_bf16_f32 v78, v120, v121
    v_cvt_pk_bf16_f32 v79, v122, v123
    v_cvt_pk_bf16_f32 v80, v124, v125
    v_mfma_f32_16x16x32_bf16 v[160:163], a[252:255], a[208:211], v[160:163]
    v_cvt_pk_bf16_f32 v81, v126, v127
    v_cvt_pk_bf16_f32 v82, v128, v129
    v_cvt_pk_bf16_f32 v83, v130, v131
    v_mfma_f32_16x16x32_bf16 v[164:167], a[252:255], a[212:215], v[164:167]
    v_cvt_pk_bf16_f32 v84, v132, v133
    v_cvt_pk_bf16_f32 v85, v134, v135
    v_cvt_pk_bf16_f32 v86, v136, v137
    s_add_u32 m0, s49, 24576
    s_xor_b32 s56, s56, 0x1000
    s_waitcnt vmcnt(21)
    buffer_load_dwordx4 v5, s[12:15], s56 offen offset:0 nt lds
    v_mfma_f32_16x16x32_bf16 v[168:171], a[252:255], a[216:219], v[168:171]
    v_cvt_pk_bf16_f32 v87, v138, v139
    v_cvt_pk_bf16_f32 v88, v140, v141
    v_cvt_pk_bf16_f32 v89, v142, v143
    v_mfma_f32_16x16x32_bf16 v[172:175], a[252:255], a[220:223], v[172:175]
    v_cvt_pk_bf16_f32 v90, v144, v145
    v_cvt_pk_bf16_f32 v91, v146, v147
    s_waitcnt lgkmcnt(2)
    v_mfma_f32_16x16x32_bf16 v[120:123], a[224:227], a[0:3], 0
    ds_read_b64_tr_b16 a[232:233], v195 offset:36864
    ds_read_b64_tr_b16 a[234:235], v195 offset:38912
    s_waitcnt vmcnt(21)
    buffer_load_dwordx4 v6, s[12:15], s56 offen offset:1024 nt lds
    v_mfma_f32_16x16x32_bf16 v[124:127], a[224:227], a[4:7], 0
    v_mfma_f32_16x16x32_bf16 v[128:131], a[224:227], a[8:11], 0
    v_cvt_pk_bf16_f32 v148, v148, v149
    v_cvt_pk_bf16_f32 v149, v150, v151
    v_cvt_pk_bf16_f32 v150, v152, v153
    v_cvt_pk_bf16_f32 v151, v154, v155
    v_mfma_f32_16x16x32_bf16 v[132:135], a[224:227], a[12:15], 0
    v_cvt_pk_bf16_f32 v152, v156, v157
    v_cvt_pk_bf16_f32 v153, v158, v159
    v_cvt_pk_bf16_f32 v154, v160, v161
    v_cvt_pk_bf16_f32 v155, v162, v163
    s_waitcnt vmcnt(13)
    buffer_load_dwordx4 v5, s[12:15], s56 offen offset:2048 nt lds
    v_mfma_f32_16x16x32_bf16 v[136:139], a[224:227], a[16:19], 0
    v_cvt_pk_bf16_f32 v156, v164, v165
    v_cvt_pk_bf16_f32 v157, v166, v167
    v_cvt_pk_bf16_f32 v158, v168, v169
    v_mfma_f32_16x16x32_bf16 v[140:143], a[224:227], a[20:23], 0
    v_cvt_pk_bf16_f32 v159, v170, v171
    v_cvt_pk_bf16_f32 v160, v172, v173
    v_cvt_pk_bf16_f32 v161, v174, v175
    ds_write_b128 v208, v[148:151] offset:17920
    v_mfma_f32_16x16x32_bf16 v[144:147], a[224:227], a[24:27], 0
    ds_write_b128 v208, v[152:155] offset:18944
    ds_write_b128 v208, v[156:159] offset:19968
    ds_write_b64 v209, v[160:161] offset:20992
    s_waitcnt vmcnt(13)
    buffer_load_dwordx4 v6, s[12:15], s56 offen offset:3072 nt lds
    s_waitcnt lgkmcnt(0)
    v_mfma_f32_16x16x32_bf16 v[148:151], a[228:231], a[0:3], 0
    ds_read_b64_tr_b16 a[236:237], v196 offset:36864
    ds_read_b64_tr_b16 a[238:239], v196 offset:38912
    v_mfma_f32_16x16x32_bf16 v[152:155], a[228:231], a[4:7], 0
    v_mfma_f32_16x16x32_bf16 v[156:159], a[228:231], a[8:11], 0
    s_barrier
    s_add_u32 m0, s65, 147456
    s_add_u32 s58, s44, 8
    s_and_b32 s58, s58, 7
    s_lshl_b32 s58, s58, 7
    buffer_load_dwordx4 v197, s[20:23], s58 offen offset:0 lds
    v_mfma_f32_16x16x32_bf16 v[160:163], a[228:231], a[12:15], 0
    v_mfma_f32_16x16x32_bf16 v[164:167], a[228:231], a[16:19], 0
    v_mfma_f32_16x16x32_bf16 v[168:171], a[228:231], a[20:23], 0
    v_mfma_f32_16x16x32_bf16 v[172:175], a[228:231], a[24:27], 0
    v_mfma_f32_16x16x32_bf16 v[120:123], a[232:235], a[28:31], v[120:123]
    ds_read_b64_tr_b16 a[240:241], v195 offset:0
    ds_read_b64_tr_b16 a[242:243], v195 offset:2048
    v_mfma_f32_16x16x32_bf16 v[124:127], a[232:235], a[32:35], v[124:127]
    s_addk_i32 s58, 7168
    buffer_load_dwordx4 v197, s[20:23], s58 offen offset:1024 lds
    v_mfma_f32_16x16x32_bf16 v[128:131], a[232:235], a[36:39], v[128:131]
    v_mfma_f32_16x16x32_bf16 v[132:135], a[232:235], a[40:43], v[132:135]
    v_mfma_f32_16x16x32_bf16 v[136:139], a[232:235], a[44:47], v[136:139]
    v_mfma_f32_16x16x32_bf16 v[140:143], a[232:235], a[48:51], v[140:143]
    v_mfma_f32_16x16x32_bf16 v[144:147], a[232:235], a[52:55], v[144:147]
    s_waitcnt lgkmcnt(2)
    v_mfma_f32_16x16x32_bf16 v[148:151], a[236:239], a[28:31], v[148:151]
    ds_read_b64_tr_b16 a[244:245], v196 offset:0
    ds_read_b64_tr_b16 a[246:247], v196 offset:2048
    v_mfma_f32_16x16x32_bf16 v[152:155], a[236:239], a[32:35], v[152:155]
    s_addk_i32 s58, 7168
    buffer_load_dwordx4 v197, s[20:23], s58 offen offset:2048 lds
    v_mfma_f32_16x16x32_bf16 v[156:159], a[236:239], a[36:39], v[156:159]
    v_mfma_f32_16x16x32_bf16 v[160:163], a[236:239], a[40:43], v[160:163]
    v_mfma_f32_16x16x32_bf16 v[164:167], a[236:239], a[44:47], v[164:167]
    v_mfma_f32_16x16x32_bf16 v[168:171], a[236:239], a[48:51], v[168:171]
    v_mfma_f32_16x16x32_bf16 v[172:175], a[236:239], a[52:55], v[172:175]
    s_waitcnt lgkmcnt(2)
    v_mfma_f32_16x16x32_bf16 v[120:123], a[240:243], a[56:59], v[120:123]
    ds_read_b64_tr_b16 a[248:249], v195 offset:4096
    ds_read_b64_tr_b16 a[250:251], v195 offset:6144
    v_mfma_f32_16x16x32_bf16 v[124:127], a[240:243], a[60:63], v[124:127]
    s_addk_i32 s58, 7168
    buffer_load_dwordx4 v197, s[20:23], s58 offen offset:3072 lds
    v_mfma_f32_16x16x32_bf16 v[128:131], a[240:243], a[64:67], v[128:131]
    v_mfma_f32_16x16x32_bf16 v[132:135], a[240:243], a[68:71], v[132:135]
    v_mfma_f32_16x16x32_bf16 v[136:139], a[240:243], a[72:75], v[136:139]
    v_mfma_f32_16x16x32_bf16 v[140:143], a[240:243], a[76:79], v[140:143]
    v_mfma_f32_16x16x32_bf16 v[144:147], a[240:243], a[80:83], v[144:147]
    s_waitcnt lgkmcnt(2)
    v_mfma_f32_16x16x32_bf16 v[148:151], a[244:247], a[56:59], v[148:151]
    ds_read_b64_tr_b16 a[252:253], v196 offset:4096
    ds_read_b64_tr_b16 a[254:255], v196 offset:6144
    v_mfma_f32_16x16x32_bf16 v[152:155], a[244:247], a[60:63], v[152:155]
    s_lshl1_add_u32 s52, s4, s41
    s_lshl_b32 s52, s52, 13
    s_add_u32 s52, s52, 262144
    v_lshlrev_b32 v1, 7, v0
    buffer_load_dword v2, v1, s[20:23], s52 offen
    v_mfma_f32_16x16x32_bf16 v[156:159], a[244:247], a[64:67], v[156:159]
    v_mfma_f32_16x16x32_bf16 v[160:163], a[244:247], a[68:71], v[160:163]
    v_mfma_f32_16x16x32_bf16 v[164:167], a[244:247], a[72:75], v[164:167]
    v_mfma_f32_16x16x32_bf16 v[168:171], a[244:247], a[76:79], v[168:171]
    v_mfma_f32_16x16x32_bf16 v[172:175], a[244:247], a[80:83], v[172:175]
    s_waitcnt lgkmcnt(2)
    v_mfma_f32_16x16x32_bf16 v[120:123], a[248:251], a[84:87], v[120:123]
    ds_read_b64_tr_b16 a[224:225], v195 offset:8192
    ds_read_b64_tr_b16 a[226:227], v195 offset:10240
    v_mfma_f32_16x16x32_bf16 v[124:127], a[248:251], a[88:91], v[124:127]
    s_waitcnt vmcnt(9)
    s_barrier
    s_add_u32 m0, s65, 155648
    s_add_u32 s58, s44, 8
    s_and_b32 s58, s58, 7
    s_lshl_b32 s58, s58, 7
    s_add_u32 s58, s58, 32768
    buffer_load_dwordx4 v197, s[20:23], s58 offen offset:0 lds
    v_mfma_f32_16x16x32_bf16 v[128:131], a[248:251], a[92:95], v[128:131]
    v_mfma_f32_16x16x32_bf16 v[132:135], a[248:251], a[96:99], v[132:135]
    v_mfma_f32_16x16x32_bf16 v[136:139], a[248:251], a[100:103], v[136:139]
    v_mfma_f32_16x16x32_bf16 v[140:143], a[248:251], a[104:107], v[140:143]
    v_mfma_f32_16x16x32_bf16 v[144:147], a[248:251], a[108:111], v[144:147]
    s_waitcnt lgkmcnt(2)
    v_mfma_f32_16x16x32_bf16 v[148:151], a[252:255], a[84:87], v[148:151]
    ds_read_b64_tr_b16 a[228:229], v196 offset:8192
    ds_read_b64_tr_b16 a[230:231], v196 offset:10240
    v_mfma_f32_16x16x32_bf16 v[152:155], a[252:255], a[88:91], v[152:155]
    v_mfma_f32_16x16x32_bf16 v[156:159], a[252:255], a[92:95], v[156:159]
    s_addk_i32 s58, 7168
    buffer_load_dwordx4 v197, s[20:23], s58 offen offset:1024 lds
    v_mfma_f32_16x16x32_bf16 v[160:163], a[252:255], a[96:99], v[160:163]
    v_mfma_f32_16x16x32_bf16 v[164:167], a[252:255], a[100:103], v[164:167]
    v_mfma_f32_16x16x32_bf16 v[168:171], a[252:255], a[104:107], v[168:171]
    v_mfma_f32_16x16x32_bf16 v[172:175], a[252:255], a[108:111], v[172:175]
    s_waitcnt lgkmcnt(2)
    v_mfma_f32_16x16x32_bf16 v[120:123], a[224:227], a[112:115], v[120:123]
    ds_read_b64_tr_b16 a[232:233], v195 offset:12288
    ds_read_b64_tr_b16 a[234:235], v195 offset:14336
    v_mfma_f32_16x16x32_bf16 v[124:127], a[224:227], a[116:119], v[124:127]
    v_mfma_f32_16x16x32_bf16 v[128:131], a[224:227], a[120:123], v[128:131]
    v_mfma_f32_16x16x32_bf16 v[132:135], a[224:227], a[124:127], v[132:135]
    v_mfma_f32_16x16x32_bf16 v[136:139], a[224:227], a[128:131], v[136:139]
    s_addk_i32 s58, 7168
    buffer_load_dwordx4 v197, s[20:23], s58 offen offset:2048 lds
    v_mfma_f32_16x16x32_bf16 v[140:143], a[224:227], a[132:135], v[140:143]
    v_mfma_f32_16x16x32_bf16 v[144:147], a[224:227], a[136:139], v[144:147]
    s_waitcnt lgkmcnt(2)
    v_mfma_f32_16x16x32_bf16 v[148:151], a[228:231], a[112:115], v[148:151]
    ds_read_b64_tr_b16 a[236:237], v196 offset:12288
    ds_read_b64_tr_b16 a[238:239], v196 offset:14336
    v_mfma_f32_16x16x32_bf16 v[152:155], a[228:231], a[116:119], v[152:155]
    v_mfma_f32_16x16x32_bf16 v[156:159], a[228:231], a[120:123], v[156:159]
    v_mfma_f32_16x16x32_bf16 v[160:163], a[228:231], a[124:127], v[160:163]
    v_mfma_f32_16x16x32_bf16 v[164:167], a[228:231], a[128:131], v[164:167]
    v_mfma_f32_16x16x32_bf16 v[168:171], a[228:231], a[132:135], v[168:171]
    s_addk_i32 s58, 7168
    buffer_load_dwordx4 v197, s[20:23], s58 offen offset:3072 lds
    v_mfma_f32_16x16x32_bf16 v[172:175], a[228:231], a[136:139], v[172:175]
    s_waitcnt lgkmcnt(2)
    v_mfma_f32_16x16x32_bf16 v[120:123], a[232:235], a[140:143], v[120:123]
    ds_read_b64_tr_b16 a[240:241], v195 offset:16384
    ds_read_b64_tr_b16 a[242:243], v195 offset:18432
    v_mfma_f32_16x16x32_bf16 v[124:127], a[232:235], a[144:147], v[124:127]
    v_mfma_f32_16x16x32_bf16 v[128:131], a[232:235], a[148:151], v[128:131]
    v_mfma_f32_16x16x32_bf16 v[132:135], a[232:235], a[152:155], v[132:135]
    v_mfma_f32_16x16x32_bf16 v[136:139], a[232:235], a[156:159], v[136:139]
    v_mfma_f32_16x16x32_bf16 v[140:143], a[232:235], a[160:163], v[140:143]
    v_mfma_f32_16x16x32_bf16 v[144:147], a[232:235], a[164:167], v[144:147]
    s_waitcnt lgkmcnt(2)
    v_mfma_f32_16x16x32_bf16 v[148:151], a[236:239], a[140:143], v[148:151]
    ds_read_b64_tr_b16 a[244:245], v196 offset:16384
    ds_read_b64_tr_b16 a[246:247], v196 offset:18432
    s_waitcnt vmcnt(5)
    s_barrier
    s_add_u32 m0, s65, 122880
    s_add_u32 s58, s44, 8
    s_and_b32 s58, s58, 7
    s_lshl_b32 s58, s58, 7
    s_add_u32 s58, s58, 65536
    buffer_load_dwordx4 v197, s[20:23], s58 offen offset:0 lds
    v_mfma_f32_16x16x32_bf16 v[152:155], a[236:239], a[144:147], v[152:155]
    v_mfma_f32_16x16x32_bf16 v[156:159], a[236:239], a[148:151], v[156:159]
    v_mfma_f32_16x16x32_bf16 v[160:163], a[236:239], a[152:155], v[160:163]
    v_mfma_f32_16x16x32_bf16 v[164:167], a[236:239], a[156:159], v[164:167]
    s_addk_i32 s58, 7168
    buffer_load_dwordx4 v197, s[20:23], s58 offen offset:1024 lds
    v_mfma_f32_16x16x32_bf16 v[168:171], a[236:239], a[160:163], v[168:171]
    v_mfma_f32_16x16x32_bf16 v[172:175], a[236:239], a[164:167], v[172:175]
    s_waitcnt lgkmcnt(2)
    v_mfma_f32_16x16x32_bf16 v[120:123], a[240:243], a[168:171], v[120:123]
    ds_read_b64_tr_b16 a[248:249], v195 offset:20480
    ds_read_b64_tr_b16 a[250:251], v195 offset:22528
    v_mfma_f32_16x16x32_bf16 v[124:127], a[240:243], a[172:175], v[124:127]
    s_addk_i32 s58, 7168
    buffer_load_dwordx4 v197, s[20:23], s58 offen offset:2048 lds
    v_mfma_f32_16x16x32_bf16 v[128:131], a[240:243], a[176:179], v[128:131]
    v_mfma_f32_16x16x32_bf16 v[132:135], a[240:243], a[180:183], v[132:135]
    v_mfma_f32_16x16x32_bf16 v[136:139], a[240:243], a[184:187], v[136:139]
    v_mfma_f32_16x16x32_bf16 v[140:143], a[240:243], a[188:191], v[140:143]
    s_addk_i32 s58, 7168
    buffer_load_dwordx4 v197, s[20:23], s58 offen offset:3072 lds
    v_mfma_f32_16x16x32_bf16 v[144:147], a[240:243], a[192:195], v[144:147]
    s_waitcnt lgkmcnt(2)
    v_mfma_f32_16x16x32_bf16 v[148:151], a[244:247], a[168:171], v[148:151]
    ds_read_b64_tr_b16 a[252:253], v196 offset:20480
    ds_read_b64_tr_b16 a[254:255], v196 offset:22528
    v_mfma_f32_16x16x32_bf16 v[152:155], a[244:247], a[172:175], v[152:155]
    v_mfma_f32_16x16x32_bf16 v[156:159], a[244:247], a[176:179], v[156:159]
    v_mfma_f32_16x16x32_bf16 v[160:163], a[244:247], a[180:183], v[160:163]
    s_add_u32 m0, s65, 131072
    s_add_u32 s58, s44, 8
    s_and_b32 s58, s58, 7
    s_lshl_b32 s58, s58, 7
    s_add_u32 s58, s58, 98304
    buffer_load_dwordx4 v197, s[20:23], s58 offen offset:0 lds
    v_mfma_f32_16x16x32_bf16 v[164:167], a[244:247], a[184:187], v[164:167]
    v_mfma_f32_16x16x32_bf16 v[168:171], a[244:247], a[188:191], v[168:171]
    v_mfma_f32_16x16x32_bf16 v[172:175], a[244:247], a[192:195], v[172:175]
    s_waitcnt lgkmcnt(2)
    v_mfma_f32_16x16x32_bf16 v[120:123], a[248:251], a[196:199], v[120:123]
    ds_read_b64_tr_b16 a[224:225], v195 offset:24576
    ds_read_b64_tr_b16 a[226:227], v195 offset:26624
    s_addk_i32 s58, 7168
    buffer_load_dwordx4 v197, s[20:23], s58 offen offset:1024 lds
    v_mfma_f32_16x16x32_bf16 v[124:127], a[248:251], a[200:203], v[124:127]
    v_mfma_f32_16x16x32_bf16 v[128:131], a[248:251], a[204:207], v[128:131]
    v_mfma_f32_16x16x32_bf16 v[132:135], a[248:251], a[208:211], v[132:135]
    v_mfma_f32_16x16x32_bf16 v[136:139], a[248:251], a[212:215], v[136:139]
    s_addk_i32 s58, 7168
    buffer_load_dwordx4 v197, s[20:23], s58 offen offset:2048 lds
    v_mfma_f32_16x16x32_bf16 v[140:143], a[248:251], a[216:219], v[140:143]
    v_mfma_f32_16x16x32_bf16 v[144:147], a[248:251], a[220:223], v[144:147]
    s_waitcnt lgkmcnt(2)
    v_mfma_f32_16x16x32_bf16 v[148:151], a[252:255], a[196:199], v[148:151]
    ds_read_b64_tr_b16 a[228:229], v196 offset:24576
    ds_read_b64_tr_b16 a[230:231], v196 offset:26624
    v_mfma_f32_16x16x32_bf16 v[152:155], a[252:255], a[200:203], v[152:155]
    s_addk_i32 s58, 7168
    buffer_load_dwordx4 v197, s[20:23], s58 offen offset:3072 lds
    v_mfma_f32_16x16x32_bf16 v[156:159], a[252:255], a[204:207], v[156:159]
    v_cvt_pk_bf16_f32 v92, v120, v121
    v_cvt_pk_bf16_f32 v93, v122, v123
    v_cvt_pk_bf16_f32 v94, v124, v125
    v_mfma_f32_16x16x32_bf16 v[160:163], a[252:255], a[208:211], v[160:163]
    v_cvt_pk_bf16_f32 v95, v126, v127
    v_cvt_pk_bf16_f32 v96, v128, v129
    v_cvt_pk_bf16_f32 v97, v130, v131
    v_mfma_f32_16x16x32_bf16 v[164:167], a[252:255], a[212:215], v[164:167]
    v_cvt_pk_bf16_f32 v98, v132, v133
    v_cvt_pk_bf16_f32 v99, v134, v135
    v_cvt_pk_bf16_f32 v100, v136, v137
    v_mfma_f32_16x16x32_bf16 v[168:171], a[252:255], a[216:219], v[168:171]
    v_cvt_pk_bf16_f32 v101, v138, v139
    v_cvt_pk_bf16_f32 v102, v140, v141
    v_cvt_pk_bf16_f32 v103, v142, v143
    v_mfma_f32_16x16x32_bf16 v[172:175], a[252:255], a[220:223], v[172:175]
    v_cvt_pk_bf16_f32 v104, v144, v145
    v_cvt_pk_bf16_f32 v105, v146, v147
    s_waitcnt vmcnt(0)
    s_barrier
    s_add_u32 m0, s65, 57344
    s_add_u32 s58, s44, 1
    s_and_b32 s58, s58, 7
    s_lshl_b32 s58, s58, 7
    s_add_u32 s58, s58, 262144
    buffer_load_dwordx4 v197, s[20:23], s58 offen offset:0 lds
    s_waitcnt lgkmcnt(2)
    v_mfma_f32_16x16x32_bf16 v[120:123], a[224:227], a[0:3], 0
    ds_read_b64_tr_b16 a[232:233], v195 offset:28672
    ds_read_b64_tr_b16 a[234:235], v195 offset:30720
    v_mfma_f32_16x16x32_bf16 v[124:127], a[224:227], a[4:7], 0
    v_mfma_f32_16x16x32_bf16 v[128:131], a[224:227], a[8:11], 0
    v_cvt_pk_bf16_f32 v148, v148, v149
    v_cvt_pk_bf16_f32 v149, v150, v151
    v_cvt_pk_bf16_f32 v150, v152, v153
    v_cvt_pk_bf16_f32 v151, v154, v155
    v_mfma_f32_16x16x32_bf16 v[132:135], a[224:227], a[12:15], 0
    v_cvt_pk_bf16_f32 v152, v156, v157
    v_cvt_pk_bf16_f32 v153, v158, v159
    v_cvt_pk_bf16_f32 v154, v160, v161
    v_cvt_pk_bf16_f32 v155, v162, v163
    v_mfma_f32_16x16x32_bf16 v[136:139], a[224:227], a[16:19], 0
    v_cvt_pk_bf16_f32 v156, v164, v165
    v_cvt_pk_bf16_f32 v157, v166, v167
    v_cvt_pk_bf16_f32 v158, v168, v169
    v_mfma_f32_16x16x32_bf16 v[140:143], a[224:227], a[20:23], 0
    v_cvt_pk_bf16_f32 v159, v170, v171
    v_cvt_pk_bf16_f32 v160, v172, v173
    v_cvt_pk_bf16_f32 v161, v174, v175
    ds_write_b128 v208, v[148:151] offset:21504
    v_mfma_f32_16x16x32_bf16 v[144:147], a[224:227], a[24:27], 0
    ds_write_b128 v208, v[152:155] offset:22528
    ds_write_b128 v208, v[156:159] offset:23552
    ds_write_b64 v209, v[160:161] offset:24576
    s_waitcnt lgkmcnt(0)
    v_mfma_f32_16x16x32_bf16 v[148:151], a[228:231], a[0:3], 0
    ds_read_b64_tr_b16 a[236:237], v196 offset:28672
    ds_read_b64_tr_b16 a[238:239], v196 offset:30720
    v_mfma_f32_16x16x32_bf16 v[152:155], a[228:231], a[4:7], 0
    v_mfma_f32_16x16x32_bf16 v[156:159], a[228:231], a[8:11], 0
    v_mfma_f32_16x16x32_bf16 v[160:163], a[228:231], a[12:15], 0
    v_mfma_f32_16x16x32_bf16 v[164:167], a[228:231], a[16:19], 0
    v_mfma_f32_16x16x32_bf16 v[168:171], a[228:231], a[20:23], 0
    v_mfma_f32_16x16x32_bf16 v[172:175], a[228:231], a[24:27], 0
    s_addk_i32 s58, 7168
    buffer_load_dwordx4 v197, s[20:23], s58 offen offset:1024 lds
    v_mfma_f32_16x16x32_bf16 v[120:123], a[232:235], a[28:31], v[120:123]
    ds_read_b64_tr_b16 a[240:241], v195 offset:32768
    ds_read_b64_tr_b16 a[242:243], v195 offset:34816
    v_mfma_f32_16x16x32_bf16 v[124:127], a[232:235], a[32:35], v[124:127]
    v_mfma_f32_16x16x32_bf16 v[128:131], a[232:235], a[36:39], v[128:131]
    v_mfma_f32_16x16x32_bf16 v[132:135], a[232:235], a[40:43], v[132:135]
    v_mfma_f32_16x16x32_bf16 v[136:139], a[232:235], a[44:47], v[136:139]
    v_mfma_f32_16x16x32_bf16 v[140:143], a[232:235], a[48:51], v[140:143]
    v_mfma_f32_16x16x32_bf16 v[144:147], a[232:235], a[52:55], v[144:147]
    s_waitcnt lgkmcnt(2)
    v_mfma_f32_16x16x32_bf16 v[148:151], a[236:239], a[28:31], v[148:151]
    ds_read_b64_tr_b16 a[244:245], v196 offset:32768
    ds_read_b64_tr_b16 a[246:247], v196 offset:34816
    v_mfma_f32_16x16x32_bf16 v[152:155], a[236:239], a[32:35], v[152:155]
    v_mfma_f32_16x16x32_bf16 v[156:159], a[236:239], a[36:39], v[156:159]
    v_mfma_f32_16x16x32_bf16 v[160:163], a[236:239], a[40:43], v[160:163]
    v_mfma_f32_16x16x32_bf16 v[164:167], a[236:239], a[44:47], v[164:167]
    v_mfma_f32_16x16x32_bf16 v[168:171], a[236:239], a[48:51], v[168:171]
    v_mfma_f32_16x16x32_bf16 v[172:175], a[236:239], a[52:55], v[172:175]
    s_addk_i32 s58, 7168
    buffer_load_dwordx4 v197, s[20:23], s58 offen offset:2048 lds
    s_waitcnt lgkmcnt(2)
    v_mfma_f32_16x16x32_bf16 v[120:123], a[240:243], a[56:59], v[120:123]
    ds_read_b64_tr_b16 a[248:249], v195 offset:36864
    ds_read_b64_tr_b16 a[250:251], v195 offset:38912
    v_mfma_f32_16x16x32_bf16 v[124:127], a[240:243], a[60:63], v[124:127]
    v_mfma_f32_16x16x32_bf16 v[128:131], a[240:243], a[64:67], v[128:131]
    v_mfma_f32_16x16x32_bf16 v[132:135], a[240:243], a[68:71], v[132:135]
    v_mfma_f32_16x16x32_bf16 v[136:139], a[240:243], a[72:75], v[136:139]
    v_mfma_f32_16x16x32_bf16 v[140:143], a[240:243], a[76:79], v[140:143]
    v_mfma_f32_16x16x32_bf16 v[144:147], a[240:243], a[80:83], v[144:147]
    s_waitcnt lgkmcnt(2)
    v_mfma_f32_16x16x32_bf16 v[148:151], a[244:247], a[56:59], v[148:151]
    ds_read_b64_tr_b16 a[252:253], v196 offset:36864
    ds_read_b64_tr_b16 a[254:255], v196 offset:38912
    v_mfma_f32_16x16x32_bf16 v[152:155], a[244:247], a[60:63], v[152:155]
    v_mfma_f32_16x16x32_bf16 v[156:159], a[244:247], a[64:67], v[156:159]
    v_mfma_f32_16x16x32_bf16 v[160:163], a[244:247], a[68:71], v[160:163]
    v_mfma_f32_16x16x32_bf16 v[164:167], a[244:247], a[72:75], v[164:167]
    v_mfma_f32_16x16x32_bf16 v[168:171], a[244:247], a[76:79], v[168:171]
    v_mfma_f32_16x16x32_bf16 v[172:175], a[244:247], a[80:83], v[172:175]
    s_addk_i32 s58, 7168
    buffer_load_dwordx4 v197, s[20:23], s58 offen offset:3072 lds
    s_waitcnt lgkmcnt(2)
    v_mfma_f32_16x16x32_bf16 v[120:123], a[248:251], a[84:87], v[120:123]
    ds_read_b64_tr_b16 a[224:225], v195 offset:0
    ds_read_b64_tr_b16 a[226:227], v195 offset:2048
    v_mfma_f32_16x16x32_bf16 v[124:127], a[248:251], a[88:91], v[124:127]
    v_mfma_f32_16x16x32_bf16 v[128:131], a[248:251], a[92:95], v[128:131]
    v_mfma_f32_16x16x32_bf16 v[132:135], a[248:251], a[96:99], v[132:135]
    v_mfma_f32_16x16x32_bf16 v[136:139], a[248:251], a[100:103], v[136:139]
    v_mfma_f32_16x16x32_bf16 v[140:143], a[248:251], a[104:107], v[140:143]
    v_mfma_f32_16x16x32_bf16 v[144:147], a[248:251], a[108:111], v[144:147]
    s_waitcnt lgkmcnt(2)
    v_mfma_f32_16x16x32_bf16 v[148:151], a[252:255], a[84:87], v[148:151]
    ds_read_b64_tr_b16 a[228:229], v196 offset:0
    ds_read_b64_tr_b16 a[230:231], v196 offset:2048
    v_mfma_f32_16x16x32_bf16 v[152:155], a[252:255], a[88:91], v[152:155]
    v_mfma_f32_16x16x32_bf16 v[156:159], a[252:255], a[92:95], v[156:159]
    v_mfma_f32_16x16x32_bf16 v[160:163], a[252:255], a[96:99], v[160:163]
    v_mfma_f32_16x16x32_bf16 v[164:167], a[252:255], a[100:103], v[164:167]
    v_mfma_f32_16x16x32_bf16 v[168:171], a[252:255], a[104:107], v[168:171]
    v_mfma_f32_16x16x32_bf16 v[172:175], a[252:255], a[108:111], v[172:175]
    s_add_u32 m0, s65, 139264
    s_add_u32 s58, s44, 1
    s_and_b32 s58, s58, 7
    s_lshl_b32 s58, s58, 7
    s_add_u32 s58, s58, 294912
    buffer_load_dwordx4 v197, s[20:23], s58 offen offset:0 lds
    s_waitcnt lgkmcnt(2)
    v_mfma_f32_16x16x32_bf16 v[120:123], a[224:227], a[112:115], v[120:123]
    ds_read_b64_tr_b16 a[232:233], v195 offset:4096
    ds_read_b64_tr_b16 a[234:235], v195 offset:6144
    v_mfma_f32_16x16x32_bf16 v[124:127], a[224:227], a[116:119], v[124:127]
    v_mfma_f32_16x16x32_bf16 v[128:131], a[224:227], a[120:123], v[128:131]
    v_mfma_f32_16x16x32_bf16 v[132:135], a[224:227], a[124:127], v[132:135]
    v_mfma_f32_16x16x32_bf16 v[136:139], a[224:227], a[128:131], v[136:139]
    v_mfma_f32_16x16x32_bf16 v[140:143], a[224:227], a[132:135], v[140:143]
    v_mfma_f32_16x16x32_bf16 v[144:147], a[224:227], a[136:139], v[144:147]
    s_waitcnt lgkmcnt(2)
    v_mfma_f32_16x16x32_bf16 v[148:151], a[228:231], a[112:115], v[148:151]
    ds_read_b64_tr_b16 a[236:237], v196 offset:4096
    ds_read_b64_tr_b16 a[238:239], v196 offset:6144
    v_mfma_f32_16x16x32_bf16 v[152:155], a[228:231], a[116:119], v[152:155]
    v_mfma_f32_16x16x32_bf16 v[156:159], a[228:231], a[120:123], v[156:159]
    v_mfma_f32_16x16x32_bf16 v[160:163], a[228:231], a[124:127], v[160:163]
    v_mfma_f32_16x16x32_bf16 v[164:167], a[228:231], a[128:131], v[164:167]
    v_mfma_f32_16x16x32_bf16 v[168:171], a[228:231], a[132:135], v[168:171]
    v_mfma_f32_16x16x32_bf16 v[172:175], a[228:231], a[136:139], v[172:175]
    s_addk_i32 s58, 7168
    buffer_load_dwordx4 v197, s[20:23], s58 offen offset:1024 lds
    s_waitcnt lgkmcnt(2)
    v_mfma_f32_16x16x32_bf16 v[120:123], a[232:235], a[140:143], v[120:123]
    ds_read_b64_tr_b16 a[240:241], v195 offset:8192
    ds_read_b64_tr_b16 a[242:243], v195 offset:10240
    v_mfma_f32_16x16x32_bf16 v[124:127], a[232:235], a[144:147], v[124:127]
    v_mfma_f32_16x16x32_bf16 v[128:131], a[232:235], a[148:151], v[128:131]
    v_mfma_f32_16x16x32_bf16 v[132:135], a[232:235], a[152:155], v[132:135]
    v_mfma_f32_16x16x32_bf16 v[136:139], a[232:235], a[156:159], v[136:139]
    v_mfma_f32_16x16x32_bf16 v[140:143], a[232:235], a[160:163], v[140:143]
    v_mfma_f32_16x16x32_bf16 v[144:147], a[232:235], a[164:167], v[144:147]
    s_waitcnt lgkmcnt(2)
    v_mfma_f32_16x16x32_bf16 v[148:151], a[236:239], a[140:143], v[148:151]
    ds_read_b64_tr_b16 a[244:245], v196 offset:8192
    ds_read_b64_tr_b16 a[246:247], v196 offset:10240
    v_mfma_f32_16x16x32_bf16 v[152:155], a[236:239], a[144:147], v[152:155]
    v_mfma_f32_16x16x32_bf16 v[156:159], a[236:239], a[148:151], v[156:159]
    v_mfma_f32_16x16x32_bf16 v[160:163], a[236:239], a[152:155], v[160:163]
    v_mfma_f32_16x16x32_bf16 v[164:167], a[236:239], a[156:159], v[164:167]
    v_mfma_f32_16x16x32_bf16 v[168:171], a[236:239], a[160:163], v[168:171]
    v_mfma_f32_16x16x32_bf16 v[172:175], a[236:239], a[164:167], v[172:175]
    s_addk_i32 s58, 7168
    buffer_load_dwordx4 v197, s[20:23], s58 offen offset:2048 lds
    s_waitcnt lgkmcnt(2)
    v_mfma_f32_16x16x32_bf16 v[120:123], a[240:243], a[168:171], v[120:123]
    ds_read_b64_tr_b16 a[248:249], v195 offset:12288
    ds_read_b64_tr_b16 a[250:251], v195 offset:14336
    v_mfma_f32_16x16x32_bf16 v[124:127], a[240:243], a[172:175], v[124:127]
    v_mfma_f32_16x16x32_bf16 v[128:131], a[240:243], a[176:179], v[128:131]
    v_mfma_f32_16x16x32_bf16 v[132:135], a[240:243], a[180:183], v[132:135]
    v_mfma_f32_16x16x32_bf16 v[136:139], a[240:243], a[184:187], v[136:139]
    v_mfma_f32_16x16x32_bf16 v[140:143], a[240:243], a[188:191], v[140:143]
    v_mfma_f32_16x16x32_bf16 v[144:147], a[240:243], a[192:195], v[144:147]
    s_waitcnt lgkmcnt(2)
    v_mfma_f32_16x16x32_bf16 v[148:151], a[244:247], a[168:171], v[148:151]
    ds_read_b64_tr_b16 a[252:253], v196 offset:12288
    ds_read_b64_tr_b16 a[254:255], v196 offset:14336
    v_mfma_f32_16x16x32_bf16 v[152:155], a[244:247], a[172:175], v[152:155]
    v_mfma_f32_16x16x32_bf16 v[156:159], a[244:247], a[176:179], v[156:159]
    v_mfma_f32_16x16x32_bf16 v[160:163], a[244:247], a[180:183], v[160:163]
    v_mfma_f32_16x16x32_bf16 v[164:167], a[244:247], a[184:187], v[164:167]
    v_mfma_f32_16x16x32_bf16 v[168:171], a[244:247], a[188:191], v[168:171]
    v_mfma_f32_16x16x32_bf16 v[172:175], a[244:247], a[192:195], v[172:175]
    s_addk_i32 s58, 7168
    buffer_load_dwordx4 v197, s[20:23], s58 offen offset:3072 lds
    s_waitcnt lgkmcnt(2)
    v_mfma_f32_16x16x32_bf16 v[120:123], a[248:251], a[196:199], v[120:123]
    v_mfma_f32_16x16x32_bf16 v[124:127], a[248:251], a[200:203], v[124:127]
    v_mfma_f32_16x16x32_bf16 v[128:131], a[248:251], a[204:207], v[128:131]
    v_mfma_f32_16x16x32_bf16 v[132:135], a[248:251], a[208:211], v[132:135]
    v_mfma_f32_16x16x32_bf16 v[136:139], a[248:251], a[212:215], v[136:139]
    v_mfma_f32_16x16x32_bf16 v[140:143], a[248:251], a[216:219], v[140:143]
    v_mfma_f32_16x16x32_bf16 v[144:147], a[248:251], a[220:223], v[144:147]
    s_waitcnt lgkmcnt(0)
    v_mfma_f32_16x16x32_bf16 v[148:151], a[252:255], a[196:199], v[148:151]
    v_mfma_f32_16x16x32_bf16 v[152:155], a[252:255], a[200:203], v[152:155]
    v_mfma_f32_16x16x32_bf16 v[156:159], a[252:255], a[204:207], v[156:159]
    v_cvt_pk_bf16_f32 v106, v120, v121
    v_cvt_pk_bf16_f32 v107, v122, v123
    v_cvt_pk_bf16_f32 v108, v124, v125
    v_mfma_f32_16x16x32_bf16 v[160:163], a[252:255], a[208:211], v[160:163]
    v_cvt_pk_bf16_f32 v109, v126, v127
    v_cvt_pk_bf16_f32 v110, v128, v129
    v_cvt_pk_bf16_f32 v111, v130, v131
    v_mfma_f32_16x16x32_bf16 v[164:167], a[252:255], a[212:215], v[164:167]
    v_cvt_pk_bf16_f32 v112, v132, v133
    v_cvt_pk_bf16_f32 v113, v134, v135
    v_cvt_pk_bf16_f32 v114, v136, v137
    v_mfma_f32_16x16x32_bf16 v[168:171], a[252:255], a[216:219], v[168:171]
    v_cvt_pk_bf16_f32 v115, v138, v139
    v_cvt_pk_bf16_f32 v116, v140, v141
    v_cvt_pk_bf16_f32 v117, v142, v143
    v_mfma_f32_16x16x32_bf16 v[172:175], a[252:255], a[220:223], v[172:175]
    v_cvt_pk_bf16_f32 v118, v144, v145
    v_cvt_pk_bf16_f32 v119, v146, v147
    v_cvt_pk_bf16_f32 v148, v148, v149
    v_cvt_pk_bf16_f32 v149, v150, v151
    v_cvt_pk_bf16_f32 v150, v152, v153
    v_cvt_pk_bf16_f32 v151, v154, v155
    v_cvt_pk_bf16_f32 v152, v156, v157
    v_cvt_pk_bf16_f32 v153, v158, v159
    v_cvt_pk_bf16_f32 v154, v160, v161
    v_cvt_pk_bf16_f32 v155, v162, v163
    v_cvt_pk_bf16_f32 v156, v164, v165
    v_cvt_pk_bf16_f32 v157, v166, v167
    v_cvt_pk_bf16_f32 v158, v168, v169
    v_cvt_pk_bf16_f32 v159, v170, v171
    v_cvt_pk_bf16_f32 v160, v172, v173
    v_cvt_pk_bf16_f32 v161, v174, v175
    ds_write_b128 v208, v[148:151] offset:25088
    ds_write_b128 v208, v[152:155] offset:26112
    ds_write_b128 v208, v[156:159] offset:27136
    ds_write_b64 v209, v[160:161] offset:28160
    s_waitcnt lgkmcnt(0)
    s_barrier
    s_add_u32 m0, s65, 147456
    s_add_u32 s58, s44, 1
    s_and_b32 s58, s58, 7
    s_lshl_b32 s58, s58, 7
    s_add_u32 s58, s58, 327680
    buffer_load_dwordx4 v197, s[20:23], s58 offen offset:0 lds
    s_addk_i32 s58, 7168
    buffer_load_dwordx4 v197, s[20:23], s58 offen offset:1024 lds
    s_addk_i32 s58, 7168
    buffer_load_dwordx4 v197, s[20:23], s58 offen offset:2048 lds
    s_addk_i32 s58, 7168
    buffer_load_dwordx4 v197, s[20:23], s58 offen offset:3072 lds
    s_add_u32 m0, s65, 155648
    s_add_u32 s58, s44, 1
    s_and_b32 s58, s58, 7
    s_lshl_b32 s58, s58, 7
    s_add_u32 s58, s58, 360448
    buffer_load_dwordx4 v197, s[20:23], s58 offen offset:0 lds
    s_addk_i32 s58, 7168
    buffer_load_dwordx4 v197, s[20:23], s58 offen offset:1024 lds
    s_addk_i32 s58, 7168
    buffer_load_dwordx4 v197, s[20:23], s58 offen offset:2048 lds
    s_addk_i32 s58, 7168
    buffer_load_dwordx4 v197, s[20:23], s58 offen offset:3072 lds
    s_waitcnt vmcnt(8)
    s_branch L_tail
L_y:
    s_waitcnt lgkmcnt(2)
    v_mfma_f32_16x16x32_bf16 v[8:11], a[84:87], v[176:179], v[8:11]
    ds_read_b64_tr_b16 a[92:93], v249 offset:0
    ds_read_b64_tr_b16 a[94:95], v249 offset:512
    v_mfma_f32_16x16x32_bf16 v[24:27], a[84:87], v[180:183], v[24:27]
    ds_read_b128 v[204:207], v253 offset:0
    v_mfma_f32_16x16x32_bf16 v[40:43], a[84:87], v[184:187], v[40:43]
    s_cmp_eq_u32 s42, 0
    s_cselect_b32 s52, s48, s49
    s_add_u32 m0, s52, 8192
    v_mfma_f32_16x16x32_bf16 v[56:59], a[84:87], v[188:191], v[56:59]
    s_lshl_b32 s56, s42, 12
    s_xor_b32 s56, s56, s46
    v_mfma_f32_16x16x32_bf16 v[72:75], a[84:87], v[192:195], v[72:75]
    buffer_load_dwordx4 v5, s[12:15], s56 offen offset:0 nt lds
    v_mfma_f32_16x16x32_bf16 v[88:91], a[84:87], v[196:199], v[88:91]
    ds_read_b128 v[208:211], v253 offset:2048
    ds_read_b128 v[212:215], v253 offset:4096
    v_mfma_f32_16x16x32_bf16 v[104:107], a[84:87], v[200:203], v[104:107]
    s_waitcnt lgkmcnt(5)
    v_mfma_f32_16x16x32_bf16 v[12:15], a[88:91], v[176:179], v[12:15]
    buffer_load_dwordx4 v6, s[12:15], s56 offen offset:1024 nt lds
    v_mfma_f32_16x16x32_bf16 v[28:31], a[88:91], v[180:183], v[28:31]
    ds_read_b64_tr_b16 a[96:97], v249 offset:8
    ds_read_b64_tr_b16 a[98:99], v249 offset:520
    v_mfma_f32_16x16x32_bf16 v[44:47], a[88:91], v[184:187], v[44:47]
    ds_read_b128 v[216:219], v253 offset:6144
    ds_read_b128 v[220:223], v253 offset:8192
    v_mfma_f32_16x16x32_bf16 v[60:63], a[88:91], v[188:191], v[60:63]
    buffer_load_dwordx4 v5, s[12:15], s56 offen offset:2048 nt lds
    v_mfma_f32_16x16x32_bf16 v[76:79], a[88:91], v[192:195], v[76:79]
    ds_read_b128 v[224:227], v253 offset:10240
    v_mfma_f32_16x16x32_bf16 v[92:95], a[88:91], v[196:199], v[92:95]
    buffer_load_dwordx4 v6, s[12:15], s56 offen offset:3072 nt lds
    v_mfma_f32_16x16x32_bf16 v[108:111], a[88:91], v[200:203], v[108:111]
    ds_read_b128 v[228:231], v253 offset:12288
    s_waitcnt lgkmcnt(9)
    v_mfma_f32_16x16x32_bf16 v[16:19], a[92:95], v[176:179], v[16:19]
    ds_read_b64_tr_b16 a[84:85], v248 offset:4096
    ds_read_b64_tr_b16 a[86:87], v248 offset:4608
    v_mfma_f32_16x16x32_bf16 v[32:35], a[92:95], v[180:183], v[32:35]
    v_mfma_f32_16x16x32_bf16 v[48:51], a[92:95], v[184:187], v[48:51]
    v_lshrrev_b32 v7, 4, v0
    v_and_b32 v2, 15, v0
    v_mfma_f32_16x16x32_bf16 v[64:67], a[92:95], v[188:191], v[64:67]
    v_lshlrev_b32 v254, 2, v7
    v_xor_b32 v254, v254, v2
    v_mfma_f32_16x16x32_bf16 v[80:83], a[92:95], v[192:195], v[80:83]
    v_lshlrev_b32 v254, 4, v254
    v_lshl_add_u32 v254, v7, 13, v254
    v_mfma_f32_16x16x32_bf16 v[96:99], a[92:95], v[196:199], v[96:99]
    s_lshl2_add_u32 s52, s5, s40
    s_lshl_b32 s54, s52, 8
    v_add_u32 v254, s54, v254
    v_mfma_f32_16x16x32_bf16 v[112:115], a[92:95], v[200:203], v[112:115]
    s_mov_b32 s62, s63
    s_xor_b32 s45, s45, 7
    s_waitcnt lgkmcnt(6)
    v_mfma_f32_16x16x32_bf16 v[20:23], a[96:99], v[176:179], v[20:23]
    s_lshl_b32 s60, s45, 1
    s_mov_b32 m0, s62
    s_xor_b32 s58, s60, 0
    v_mfma_f32_16x16x32_bf16 v[36:39], a[96:99], v[180:183], v[36:39]
    s_lshl_b32 s58, s58, 18
    v_mfma_f32_16x16x32_bf16 v[52:55], a[96:99], v[184:187], v[52:55]
    buffer_load_dwordx4 v254, s[16:19], s58 offen offset:0 lds
    v_mfma_f32_16x16x32_bf16 v[68:71], a[96:99], v[188:191], v[68:71]
    ds_read_b64_tr_b16 a[88:89], v248 offset:4104
    ds_read_b64_tr_b16 a[90:91], v248 offset:4616
    v_mfma_f32_16x16x32_bf16 v[84:87], a[96:99], v[192:195], v[84:87]
    s_addk_i32 s58, 31744
    v_mfma_f32_16x16x32_bf16 v[100:103], a[96:99], v[196:199], v[100:103]
    buffer_load_dwordx4 v254, s[16:19], s58 offen offset:1024 lds
    v_mfma_f32_16x16x32_bf16 v[116:119], a[96:99], v[200:203], v[116:119]
    s_addk_i32 s58, 31744
    s_waitcnt lgkmcnt(2)
    v_mfma_f32_16x16x32_bf16 v[8:11], a[84:87], v[204:207], v[8:11]
    buffer_load_dwordx4 v254, s[16:19], s58 offen offset:2048 lds
    v_mfma_f32_16x16x32_bf16 v[24:27], a[84:87], v[208:211], v[24:27]
    ds_read_b64_tr_b16 a[92:93], v249 offset:4096
    ds_read_b64_tr_b16 a[94:95], v249 offset:4608
    v_mfma_f32_16x16x32_bf16 v[40:43], a[84:87], v[212:215], v[40:43]
    s_addk_i32 s58, 31744
    v_mfma_f32_16x16x32_bf16 v[56:59], a[84:87], v[216:219], v[56:59]
    buffer_load_dwordx4 v254, s[16:19], s58 offen offset:3072 lds
    v_mfma_f32_16x16x32_bf16 v[72:75], a[84:87], v[220:223], v[72:75]
    v_mfma_f32_16x16x32_bf16 v[88:91], a[84:87], v[224:227], v[88:91]
    v_mfma_f32_16x16x32_bf16 v[104:107], a[84:87], v[228:231], v[104:107]
    s_add_u32 m0, s62, 4096
    s_add_u32 s58, s58, 35840
    s_waitcnt lgkmcnt(2)
    v_mfma_f32_16x16x32_bf16 v[12:15], a[88:91], v[204:207], v[12:15]
    buffer_load_dwordx4 v254, s[16:19], s58 offen offset:0 lds
    v_mfma_f32_16x16x32_bf16 v[28:31], a[88:91], v[208:211], v[28:31]
    ds_read_b64_tr_b16 a[96:97], v249 offset:4104
    ds_read_b64_tr_b16 a[98:99], v249 offset:4616
    v_mfma_f32_16x16x32_bf16 v[44:47], a[88:91], v[212:215], v[44:47]
    s_addk_i32 s58, 31744
    v_mfma_f32_16x16x32_bf16 v[60:63], a[88:91], v[216:219], v[60:63]
    buffer_load_dwordx4 v254, s[16:19], s58 offen offset:1024 lds
    v_mfma_f32_16x16x32_bf16 v[76:79], a[88:91], v[220:223], v[76:79]
    v_mfma_f32_16x16x32_bf16 v[92:95], a[88:91], v[224:227], v[92:95]
    v_mfma_f32_16x16x32_bf16 v[108:111], a[88:91], v[228:231], v[108:111]
    s_addk_i32 s58, 31744
    s_waitcnt lgkmcnt(2)
    v_mfma_f32_16x16x32_bf16 v[16:19], a[92:95], v[204:207], v[16:19]
    buffer_load_dwordx4 v254, s[16:19], s58 offen offset:2048 lds
    v_mfma_f32_16x16x32_bf16 v[32:35], a[92:95], v[208:211], v[32:35]
    v_mfma_f32_16x16x32_bf16 v[48:51], a[92:95], v[212:215], v[48:51]
    s_addk_i32 s58, 31744
    v_mfma_f32_16x16x32_bf16 v[64:67], a[92:95], v[216:219], v[64:67]
    buffer_load_dwordx4 v254, s[16:19], s58 offen offset:3072 lds
    v_mfma_f32_16x16x32_bf16 v[80:83], a[92:95], v[220:223], v[80:83]
    s_add_u32 s62, s62, 8192
    s_cmp_eq_u32 s62, s64
    s_cselect_b32 s62, s63, s62
    v_mfma_f32_16x16x32_bf16 v[96:99], a[92:95], v[224:227], v[96:99]
    v_mfma_f32_16x16x32_bf16 v[112:115], a[92:95], v[228:231], v[112:115]
    s_mul_i32 s52, s41, 24576
    s_add_u32 s52, s52, 131072
    s_waitcnt lgkmcnt(0)
    v_mfma_f32_16x16x32_bf16 v[20:23], a[96:99], v[204:207], v[20:23]
    v_add_u32 v1, s52, v4
    s_lshl_b32 s52, s41, 13
    v_mfma_f32_16x16x32_bf16 v[36:39], a[96:99], v[208:211], v[36:39]
    s_add_u32 s52, s52, 90112
    v_add_u32 v3, s52, v4
    v_mfma_f32_16x16x32_bf16 v[52:55], a[96:99], v[212:215], v[52:55]
    v_mfma_f32_16x16x32_bf16 v[68:71], a[96:99], v[216:219], v[68:71]
    v_mfma_f32_16x16x32_bf16 v[84:87], a[96:99], v[220:223], v[84:87]
    v_mfma_f32_16x16x32_bf16 v[100:103], a[96:99], v[224:227], v[100:103]
    v_mfma_f32_16x16x32_bf16 v[116:119], a[96:99], v[228:231], v[116:119]
    v_bfe_u32 v251, v0, 2, 2
    v_lshl_add_u32 v2, v7, 3, v251
    v_lshlrev_b32 v2, 8, v2
    v_and_b32 v7, 3, v0
    v_lshl_add_u32 v2, v7, 4, v2
    v_lshl_add_u32 v2, v251, 6, v2
    v_add_u32 v248, s63, v2
    v_xor_b32 v249, 64, v248
    v_xor_b32 v250, 128, v248
    v_xor_b32 v251, 192, v248
    v_subrev_u32 v255, 16384, v255
    s_sub_u32 s96, s96, 2048
    v_xor_b32 v252, 64, v253
    s_mov_b32 s61, s63
    s_mov_b32 s65, 32768
    s_mov_b32 s66, 0
    s_mov_b32 s67, 16384
    s_mov_b32 m0, s62
    s_xor_b32 s58, s60, 1
    s_lshl_b32 s58, s58, 18
    buffer_load_dwordx4 v254, s[16:19], s58 offen offset:0 lds
    .p2align 3
    v_pk_mul_f32 v[8:9], v[8:9], s[50:51]
    v_pk_mul_f32 v[10:11], v[10:11], s[50:51]
    v_pk_mul_f32 v[12:13], v[12:13], s[50:51]
    v_pk_mul_f32 v[14:15], v[14:15], s[50:51]
    v_cvt_pk_bf16_f32 v8, v8, v9
    v_cvt_pk_bf16_f32 v9, v10, v11
    v_cvt_pk_bf16_f32 v10, v12, v13
    v_cvt_pk_bf16_f32 v11, v14, v15
    ds_write_b128 v1, v[8:11] offset:0
    v_pk_mul_f32 v[16:17], v[16:17], s[50:51]
    v_pk_mul_f32 v[18:19], v[18:19], s[50:51]
    v_pk_mul_f32 v[20:21], v[20:21], s[50:51]
    v_pk_mul_f32 v[22:23], v[22:23], s[50:51]
    v_cvt_pk_bf16_f32 v16, v16, v17
    s_addk_i32 s58, 31744
    buffer_load_dwordx4 v254, s[16:19], s58 offen offset:1024 lds
    v_cvt_pk_bf16_f32 v17, v18, v19
    v_cvt_pk_bf16_f32 v18, v20, v21
    v_cvt_pk_bf16_f32 v19, v22, v23
    ds_write_b128 v1, v[16:19] offset:1024
    v_pk_mul_f32 v[24:25], v[24:25], s[50:51]
    v_pk_mul_f32 v[26:27], v[26:27], s[50:51]
    v_pk_mul_f32 v[28:29], v[28:29], s[50:51]
    v_pk_mul_f32 v[30:31], v[30:31], s[50:51]
    v_cvt_pk_bf16_f32 v24, v24, v25
    v_cvt_pk_bf16_f32 v25, v26, v27
    v_cvt_pk_bf16_f32 v26, v28, v29
    v_cvt_pk_bf16_f32 v27, v30, v31
    ds_write_b128 v1, v[24:27] offset:2048
    v_pk_mul_f32 v[32:33], v[32:33], s[50:51]
    v_pk_mul_f32 v[34:35], v[34:35], s[50:51]
    v_pk_mul_f32 v[36:37], v[36:37], s[50:51]
    s_addk_i32 s58, 31744
    buffer_load_dwordx4 v254, s[16:19], s58 offen offset:2048 lds
    v_pk_mul_f32 v[38:39], v[38:39], s[50:51]
    v_cvt_pk_bf16_f32 v32, v32, v33
    v_cvt_pk_bf16_f32 v33, v34, v35
    v_cvt_pk_bf16_f32 v34, v36, v37
    v_cvt_pk_bf16_f32 v35, v38, v39
    ds_write_b128 v1, v[32:35] offset:3072
    v_pk_mul_f32 v[40:41], v[40:41], s[50:51]
    v_pk_mul_f32 v[42:43], v[42:43], s[50:51]
    v_pk_mul_f32 v[44:45], v[44:45], s[50:51]
    v_pk_mul_f32 v[46:47], v[46:47], s[50:51]
    v_cvt_pk_bf16_f32 v40, v40, v41
    v_cvt_pk_bf16_f32 v41, v42, v43
    v_cvt_pk_bf16_f32 v42, v44, v45
    v_cvt_pk_bf16_f32 v43, v46, v47
    ds_write_b128 v1, v[40:43] offset:4096
    v_pk_mul_f32 v[48:49], v[48:49], s[50:51]
    s_addk_i32 s58, 31744
    buffer_load_dwordx4 v254, s[16:19], s58 offen offset:3072 lds
    v_pk_mul_f32 v[50:51], v[50:51], s[50:51]
    v_pk_mul_f32 v[52:53], v[52:53], s[50:51]
    v_pk_mul_f32 v[54:55], v[54:55], s[50:51]
    v_cvt_pk_bf16_f32 v48, v48, v49
    v_cvt_pk_bf16_f32 v49, v50, v51
    v_cvt_pk_bf16_f32 v50, v52, v53
    v_cvt_pk_bf16_f32 v51, v54, v55
    ds_write_b128 v1, v[48:51] offset:5120
    v_pk_mul_f32 v[56:57], v[56:57], s[50:51]
    v_pk_mul_f32 v[58:59], v[58:59], s[50:51]
    v_pk_mul_f32 v[60:61], v[60:61], s[50:51]
    v_pk_mul_f32 v[62:63], v[62:63], s[50:51]
    v_cvt_pk_bf16_f32 v56, v56, v57
    v_cvt_pk_bf16_f32 v57, v58, v59
    v_cvt_pk_bf16_f32 v58, v60, v61
    v_cvt_pk_bf16_f32 v59, v62, v63
    s_add_u32 m0, s62, 4096
    s_add_u32 s58, s58, 35840
    buffer_load_dwordx4 v254, s[16:19], s58 offen offset:0 lds
    ds_write_b128 v1, v[56:59] offset:6144
    v_pk_mul_f32 v[64:65], v[64:65], s[50:51]
    v_pk_mul_f32 v[66:67], v[66:67], s[50:51]
    v_pk_mul_f32 v[68:69], v[68:69], s[50:51]
    v_pk_mul_f32 v[70:71], v[70:71], s[50:51]
    v_cvt_pk_bf16_f32 v64, v64, v65
    v_cvt_pk_bf16_f32 v65, v66, v67
    v_cvt_pk_bf16_f32 v66, v68, v69
    v_cvt_pk_bf16_f32 v67, v70, v71
    ds_write_b128 v1, v[64:67] offset:7168
    v_pk_mul_f32 v[72:73], v[72:73], s[50:51]
    v_pk_mul_f32 v[74:75], v[74:75], s[50:51]
    v_pk_mul_f32 v[76:77], v[76:77], s[50:51]
    v_pk_mul_f32 v[78:79], v[78:79], s[50:51]
    v_cvt_pk_bf16_f32 v72, v72, v73
    v_cvt_pk_bf16_f32 v73, v74, v75
    s_addk_i32 s58, 31744
    buffer_load_dwordx4 v254, s[16:19], s58 offen offset:1024 lds
    v_cvt_pk_bf16_f32 v74, v76, v77
    v_cvt_pk_bf16_f32 v75, v78, v79
    ds_write_b128 v3, v[72:75] offset:8192
    v_pk_mul_f32 v[80:81], v[80:81], s[50:51]
    v_pk_mul_f32 v[82:83], v[82:83], s[50:51]
    v_pk_mul_f32 v[84:85], v[84:85], s[50:51]
    v_pk_mul_f32 v[86:87], v[86:87], s[50:51]
    v_cvt_pk_bf16_f32 v80, v80, v81
    v_cvt_pk_bf16_f32 v81, v82, v83
    v_cvt_pk_bf16_f32 v82, v84, v85
    v_cvt_pk_bf16_f32 v83, v86, v87
    ds_write_b128 v3, v[80:83] offset:9216
    v_pk_mul_f32 v[88:89], v[88:89], s[50:51]
    v_pk_mul_f32 v[90:91], v[90:91], s[50:51]
    v_pk_mul_f32 v[92:93], v[92:93], s[50:51]
    v_pk_mul_f32 v[94:95], v[94:95], s[50:51]
    s_addk_i32 s58, 31744
    buffer_load_dwordx4 v254, s[16:19], s58 offen offset:2048 lds
    v_cvt_pk_bf16_f32 v88, v88, v89
    v_cvt_pk_bf16_f32 v89, v90, v91
    v_cvt_pk_bf16_f32 v90, v92, v93
    v_cvt_pk_bf16_f32 v91, v94, v95
    ds_write_b128 v3, v[88:91] offset:10240
    v_pk_mul_f32 v[96:97], v[96:97], s[50:51]
    v_pk_mul_f32 v[98:99], v[98:99], s[50:51]
    v_pk_mul_f32 v[100:101], v[100:101], s[50:51]
    v_pk_mul_f32 v[102:103], v[102:103], s[50:51]
    v_cvt_pk_bf16_f32 v96, v96, v97
    v_cvt_pk_bf16_f32 v97, v98, v99
    v_cvt_pk_bf16_f32 v98, v100, v101
    v_cvt_pk_bf16_f32 v99, v102, v103
    ds_write_b128 v3, v[96:99] offset:11264
    v_pk_mul_f32 v[104:105], v[104:105], s[50:51]
    v_pk_mul_f32 v[106:107], v[106:107], s[50:51]
    s_addk_i32 s58, 31744
    buffer_load_dwordx4 v254, s[16:19], s58 offen offset:3072 lds
    s_add_u32 s62, s62, 8192
    s_cmp_eq_u32 s62, s64
    s_cselect_b32 s62, s63, s62
    v_pk_mul_f32 v[108:109], v[108:109], s[50:51]
    v_pk_mul_f32 v[110:111], v[110:111], s[50:51]
    v_cvt_pk_bf16_f32 v104, v104, v105
    v_cvt_pk_bf16_f32 v105, v106, v107
    v_cvt_pk_bf16_f32 v106, v108, v109
    v_cvt_pk_bf16_f32 v107, v110, v111
    ds_write_b128 v3, v[104:107] offset:12288
    v_pk_mul_f32 v[112:113], v[112:113], s[50:51]
    v_pk_mul_f32 v[114:115], v[114:115], s[50:51]
    v_pk_mul_f32 v[116:117], v[116:117], s[50:51]
    v_pk_mul_f32 v[118:119], v[118:119], s[50:51]
    v_cvt_pk_bf16_f32 v112, v112, v113
    v_cvt_pk_bf16_f32 v113, v114, v115
    v_cvt_pk_bf16_f32 v114, v116, v117
    v_cvt_pk_bf16_f32 v115, v118, v119
    ds_write_b128 v3, v[112:115] offset:13312
    s_waitcnt lgkmcnt(0)
    s_waitcnt vmcnt(20)
    s_barrier
    v_mfma_f32_32x32x16_bf16 v[8:23], v[232:235], v[232:235], 0
    v_mfma_f32_32x32x16_bf16 v[24:39], v[232:235], v[232:235], 0
    v_mfma_f32_32x32x16_bf16 v[40:55], v[232:235], v[232:235], 0
    v_mfma_f32_32x32x16_bf16 v[56:71], v[232:235], v[232:235], 0
    v_mfma_f32_32x32x16_bf16 v[72:87], v[232:235], v[232:235], 0
    v_mfma_f32_32x32x16_bf16 v[88:103], v[232:235], v[232:235], 0
    v_mfma_f32_32x32x16_bf16 v[104:119], v[232:235], v[232:235], 0
    s_barrier
    ds_read_b128 v[176:179], v252 offset:0
    ds_read_b128 v[180:183], v252 offset:2048
    ds_read_b128 v[184:187], v252 offset:4096
    ds_read_b128 v[188:191], v252 offset:6144
    ds_read_b128 v[192:195], v252 offset:8192
    ds_read_b128 v[196:199], v252 offset:10240
    ds_read_b128 v[200:203], v252 offset:12288
    v_subrev_u32 v252, 16384, v252
    s_waitcnt vmcnt(8)
    ds_read_b64_tr_b16 a[84:85], v248 offset:0
    ds_read_b64_tr_b16 a[86:87], v248 offset:1024
    ds_read_b64_tr_b16 a[88:89], v248 offset:8
    ds_read_b64_tr_b16 a[90:91], v248 offset:1032
    s_mov_b32 s59, 0
L_a2e:
    s_mov_b32 m0, s62
    s_lshl1_add_u32 s58, s59, 2
    s_xor_b32 s58, s58, s60
    s_lshl_b32 s58, s58, 18
    buffer_load_dwordx4 v254, s[16:19], s58 offen offset:0 lds
    s_waitcnt lgkmcnt(2)
    v_mfma_f32_16x16x32_bf16 v[8:11], a[84:87], v[176:179], v[8:11]
    ds_read_b64_tr_b16 a[92:93], v249 offset:0
    ds_read_b64_tr_b16 a[94:95], v249 offset:1024
    v_mfma_f32_16x16x32_bf16 v[24:27], a[84:87], v[180:183], v[24:27]
    s_mov_b32 m0, s62
    s_addk_i32 s58, 31744
    buffer_load_dwordx4 v254, s[16:19], s58 offen offset:1024 lds
    v_mfma_f32_16x16x32_bf16 v[40:43], a[84:87], v[184:187], v[40:43]
    ds_read_b128 v[204:207], v253 offset:0
    v_mfma_f32_16x16x32_bf16 v[56:59], a[84:87], v[188:191], v[56:59]
    s_mov_b32 m0, s62
    s_addk_i32 s58, 31744
    buffer_load_dwordx4 v254, s[16:19], s58 offen offset:2048 lds
    v_mfma_f32_16x16x32_bf16 v[72:75], a[84:87], v[192:195], v[72:75]
    v_mfma_f32_16x16x32_bf16 v[88:91], a[84:87], v[196:199], v[88:91]
    s_mov_b32 m0, s62
    s_addk_i32 s58, 31744
    buffer_load_dwordx4 v254, s[16:19], s58 offen offset:3072 lds
    v_mfma_f32_16x16x32_bf16 v[104:107], a[84:87], v[200:203], v[104:107]
    ds_read_b128 v[208:211], v253 offset:2048
    s_waitcnt lgkmcnt(4)
    v_mfma_f32_16x16x32_bf16 v[12:15], a[88:91], v[176:179], v[12:15]
    ds_read_b64_tr_b16 a[96:97], v249 offset:8
    ds_read_b64_tr_b16 a[98:99], v249 offset:1032
    s_add_u32 m0, s62, 4096
    s_add_u32 s58, s58, 35840
    buffer_load_dwordx4 v254, s[16:19], s58 offen offset:0 lds
    v_mfma_f32_16x16x32_bf16 v[28:31], a[88:91], v[180:183], v[28:31]
    v_mfma_f32_16x16x32_bf16 v[44:47], a[88:91], v[184:187], v[44:47]
    s_add_u32 m0, s62, 4096
    s_addk_i32 s58, 31744
    buffer_load_dwordx4 v254, s[16:19], s58 offen offset:1024 lds
    v_mfma_f32_16x16x32_bf16 v[60:63], a[88:91], v[188:191], v[60:63]
    ds_read_b128 v[212:215], v253 offset:4096
    v_mfma_f32_16x16x32_bf16 v[76:79], a[88:91], v[192:195], v[76:79]
    s_add_u32 m0, s48, 24576
    s_lshl1_add_u32 s56, s59, 1
    s_lshl_b32 s56, s56, 13
    s_xor_b32 s56, s56, s46
    s_waitcnt vmcnt(23)
    buffer_load_dwordx4 v5, s[12:15], s56 offen offset:0 nt lds
    v_mfma_f32_16x16x32_bf16 v[92:95], a[88:91], v[196:199], v[92:95]
    v_mfma_f32_16x16x32_bf16 v[108:111], a[88:91], v[200:203], v[108:111]
    s_waitcnt vmcnt(23)
    buffer_load_dwordx4 v6, s[12:15], s56 offen offset:1024 nt lds
    s_waitcnt lgkmcnt(5)
    v_mfma_f32_16x16x32_bf16 v[16:19], a[92:95], v[176:179], v[16:19]
    ds_read_b64_tr_b16 a[84:85], v250 offset:0
    ds_read_b64_tr_b16 a[86:87], v250 offset:1024
    ds_read_b128 v[216:219], v253 offset:6144
    v_mfma_f32_16x16x32_bf16 v[32:35], a[92:95], v[180:183], v[32:35]
    s_waitcnt vmcnt(23)
    buffer_load_dwordx4 v5, s[12:15], s56 offen offset:2048 nt lds
    v_mfma_f32_16x16x32_bf16 v[48:51], a[92:95], v[184:187], v[48:51]
    v_mfma_f32_16x16x32_bf16 v[64:67], a[92:95], v[188:191], v[64:67]
    s_waitcnt vmcnt(23)
    buffer_load_dwordx4 v6, s[12:15], s56 offen offset:3072 nt lds
    v_mfma_f32_16x16x32_bf16 v[80:83], a[92:95], v[192:195], v[80:83]
    ds_read_b128 v[220:223], v253 offset:8192
    v_mfma_f32_16x16x32_bf16 v[96:99], a[92:95], v[196:199], v[96:99]
    s_add_u32 m0, s49, 24576
    s_xor_b32 s56, s56, 0x1000
    s_waitcnt vmcnt(23)
    buffer_load_dwordx4 v5, s[12:15], s56 offen offset:0 nt lds
    v_mfma_f32_16x16x32_bf16 v[112:115], a[92:95], v[200:203], v[112:115]
    s_waitcnt lgkmcnt(5)
    v_mfma_f32_16x16x32_bf16 v[20:23], a[96:99], v[176:179], v[20:23]
    ds_read_b64_tr_b16 a[88:89], v250 offset:8
    ds_read_b64_tr_b16 a[90:91], v250 offset:1032
    s_waitcnt vmcnt(18)
    buffer_load_dwordx4 v6, s[12:15], s56 offen offset:1024 nt lds
    v_mfma_f32_16x16x32_bf16 v[36:39], a[96:99], v[180:183], v[36:39]
    ds_read_b128 v[224:227], v253 offset:10240
    v_mfma_f32_16x16x32_bf16 v[52:55], a[96:99], v[184:187], v[52:55]
    s_waitcnt vmcnt(18)
    buffer_load_dwordx4 v5, s[12:15], s56 offen offset:2048 nt lds
    v_mfma_f32_16x16x32_bf16 v[68:71], a[96:99], v[188:191], v[68:71]
    v_mfma_f32_16x16x32_bf16 v[84:87], a[96:99], v[192:195], v[84:87]
    s_waitcnt vmcnt(18)
    buffer_load_dwordx4 v6, s[12:15], s56 offen offset:3072 nt lds
    v_mfma_f32_16x16x32_bf16 v[100:103], a[96:99], v[196:199], v[100:103]
    ds_read_b128 v[228:231], v253 offset:12288
    v_mfma_f32_16x16x32_bf16 v[116:119], a[96:99], v[200:203], v[116:119]
    s_barrier
    s_add_u32 m0, s62, 4096
    s_addk_i32 s58, 31744
    buffer_load_dwordx4 v254, s[16:19], s58 offen offset:2048 lds
    s_waitcnt lgkmcnt(6)
    v_mfma_f32_16x16x32_bf16 v[120:123], a[84:87], v[176:179], v[120:123]
    ds_read_b64_tr_b16 a[92:93], v251 offset:0
    ds_read_b64_tr_b16 a[94:95], v251 offset:1024
    v_mfma_f32_16x16x32_bf16 v[128:131], a[84:87], v[180:183], v[128:131]
    s_add_u32 m0, s62, 4096
    s_addk_i32 s58, 31744
    buffer_load_dwordx4 v254, s[16:19], s58 offen offset:3072 lds
    s_add_u32 s62, s62, 8192
    s_cmp_eq_u32 s62, s64
    s_cselect_b32 s62, s63, s62
    v_mfma_f32_16x16x32_bf16 v[136:139], a[84:87], v[184:187], v[136:139]
    v_mfma_f32_16x16x32_bf16 v[144:147], a[84:87], v[188:191], v[144:147]
    s_add_u32 m0, s96, s65
    s_add_u32 s52, s59, 2
    s_xor_b32 s57, s45, s52
    s_lshl_b32 s57, s57, 7
    s_cmp_lt_u32 s52, 8
    s_cselect_b32 s57, s57, 2146435072
    buffer_load_dwordx4 v255, s[28:31], s57 offen lds
    v_mfma_f32_16x16x32_bf16 v[152:155], a[84:87], v[192:195], v[152:155]
    v_mfma_f32_16x16x32_bf16 v[160:163], a[84:87], v[196:199], v[160:163]
    s_addk_i32 m0, 2048
    s_add_u32 s57, s57, 16384
    buffer_load_dwordx4 v255, s[28:31], s57 offen lds
    v_mfma_f32_16x16x32_bf16 v[168:171], a[84:87], v[200:203], v[168:171]
    s_waitcnt lgkmcnt(4)
    v_mfma_f32_16x16x32_bf16 v[124:127], a[88:91], v[176:179], v[124:127]
    ds_read_b64_tr_b16 a[96:97], v251 offset:8
    ds_read_b64_tr_b16 a[98:99], v251 offset:1032
    s_addk_i32 m0, 2048
    s_add_u32 s57, s57, 16384
    buffer_load_dwordx4 v255, s[28:31], s57 offen lds
    v_mfma_f32_16x16x32_bf16 v[132:135], a[88:91], v[180:183], v[132:135]
    s_mov_b32 s53, s61
    s_addk_i32 s61, 8192
    s_cmp_eq_u32 s61, s64
    s_cselect_b32 s61, s63, s61
    s_sub_u32 s53, s61, s53
    v_add_u32 v248, s53, v248
    v_add_u32 v249, s53, v249
    v_add_u32 v250, s53, v250
    v_add_u32 v251, s53, v251
    v_mfma_f32_16x16x32_bf16 v[140:143], a[88:91], v[184:187], v[140:143]
    s_addk_i32 m0, 2048
    s_add_u32 s57, s57, 16384
    buffer_load_dwordx4 v255, s[28:31], s57 offen lds
    v_mfma_f32_16x16x32_bf16 v[148:151], a[88:91], v[188:191], v[148:151]
    v_mfma_f32_16x16x32_bf16 v[156:159], a[88:91], v[192:195], v[156:159]
    s_add_u32 m0, s48, 0
    s_lshl1_add_u32 s56, s59, 2
    s_lshl_b32 s56, s56, 13
    s_xor_b32 s56, s56, s46
    s_waitcnt vmcnt(24)
    buffer_load_dwordx4 v5, s[8:11], s56 offen offset:0 nt lds
    v_mfma_f32_16x16x32_bf16 v[164:167], a[88:91], v[196:199], v[164:167]
    v_mfma_f32_16x16x32_bf16 v[172:175], a[88:91], v[200:203], v[172:175]
    s_waitcnt vmcnt(24)
    buffer_load_dwordx4 v6, s[8:11], s56 offen offset:1024 nt lds
    s_waitcnt lgkmcnt(2)
    v_mfma_f32_16x16x32_bf16 a[0:3], a[92:95], v[176:179], a[0:3]
    s_waitcnt vmcnt(22)
    ds_read_b64_tr_b16 a[84:85], v248 offset:0
    ds_read_b64_tr_b16 a[86:87], v248 offset:1024
    v_mfma_f32_16x16x32_bf16 a[8:11], a[92:95], v[180:183], a[8:11]
    buffer_load_dwordx4 v5, s[8:11], s56 offen offset:2048 nt lds
    v_mfma_f32_16x16x32_bf16 a[16:19], a[92:95], v[184:187], a[16:19]
    s_mov_b32 s53, s67
    s_addk_i32 s67, -16384
    s_cmp_lt_i32 s67, 0
    s_cselect_b32 s67, 32768, s67
    s_sub_u32 s53, s67, s53
    v_add_u32 v253, s53, v253
    v_mfma_f32_16x16x32_bf16 a[24:27], a[92:95], v[188:191], a[24:27]
    buffer_load_dwordx4 v6, s[8:11], s56 offen offset:3072 nt lds
    v_mfma_f32_16x16x32_bf16 a[32:35], a[92:95], v[192:195], a[32:35]
    v_mfma_f32_16x16x32_bf16 a[40:43], a[92:95], v[196:199], a[40:43]
    s_add_u32 m0, s49, 0
    s_xor_b32 s56, s56, 0x1000
    buffer_load_dwordx4 v5, s[8:11], s56 offen offset:0 nt lds
    v_mfma_f32_16x16x32_bf16 a[48:51], a[92:95], v[200:203], a[48:51]
    s_waitcnt lgkmcnt(2)
    v_mfma_f32_16x16x32_bf16 a[4:7], a[96:99], v[176:179], a[4:7]
    ds_read_b64_tr_b16 a[88:89], v248 offset:8
    ds_read_b64_tr_b16 a[90:91], v248 offset:1032
    s_waitcnt vmcnt(18)
    buffer_load_dwordx4 v6, s[8:11], s56 offen offset:1024 nt lds
    v_mfma_f32_16x16x32_bf16 a[12:15], a[96:99], v[180:183], a[12:15]
    v_mfma_f32_16x16x32_bf16 a[20:23], a[96:99], v[184:187], a[20:23]
    s_waitcnt vmcnt(18)
    buffer_load_dwordx4 v5, s[8:11], s56 offen offset:2048 nt lds
    v_mfma_f32_16x16x32_bf16 a[28:31], a[96:99], v[188:191], a[28:31]
    v_mfma_f32_16x16x32_bf16 a[36:39], a[96:99], v[192:195], a[36:39]
    s_waitcnt vmcnt(18)
    buffer_load_dwordx4 v6, s[8:11], s56 offen offset:3072 nt lds
    v_mfma_f32_16x16x32_bf16 a[44:47], a[96:99], v[196:199], a[44:47]
    v_mfma_f32_16x16x32_bf16 a[52:55], a[96:99], v[200:203], a[52:55]
    s_barrier
    s_add_u32 m0, s96, s65
    s_addk_i32 m0, 8192
    s_add_u32 s57, s57, 16384
    buffer_load_dwordx4 v255, s[28:31], s57 offen lds
    s_waitcnt lgkmcnt(2)
    v_mfma_f32_16x16x32_bf16 v[8:11], a[84:87], v[204:207], v[8:11]
    ds_read_b64_tr_b16 a[92:93], v249 offset:0
    ds_read_b64_tr_b16 a[94:95], v249 offset:1024
    v_mfma_f32_16x16x32_bf16 v[24:27], a[84:87], v[208:211], v[24:27]
    s_addk_i32 m0, 2048
    s_add_u32 s57, s57, 16384
    buffer_load_dwordx4 v255, s[28:31], s57 offen lds
    v_mfma_f32_16x16x32_bf16 v[40:43], a[84:87], v[212:215], v[40:43]
    ds_read_b128 v[176:179], v252 offset:0
    v_mfma_f32_16x16x32_bf16 v[56:59], a[84:87], v[216:219], v[56:59]
    s_addk_i32 m0, 2048
    s_add_u32 s57, s57, 16384
    buffer_load_dwordx4 v255, s[28:31], s57 offen lds
    s_addk_i32 s65, -16384
    s_cmp_lt_i32 s65, 0
    s_cselect_b32 s65, 32768, s65
    v_mfma_f32_16x16x32_bf16 v[72:75], a[84:87], v[220:223], v[72:75]
    v_mfma_f32_16x16x32_bf16 v[88:91], a[84:87], v[224:227], v[88:91]
    s_mov_b32 m0, s62
    s_lshl1_add_u32 s58, s59, 3
    s_xor_b32 s58, s58, s60
    s_lshl_b32 s58, s58, 18
    buffer_load_dwordx4 v254, s[16:19], s58 offen offset:0 lds
    v_mfma_f32_16x16x32_bf16 v[104:107], a[84:87], v[228:231], v[104:107]
    ds_read_b128 v[180:183], v252 offset:2048
    s_waitcnt lgkmcnt(4)
    v_mfma_f32_16x16x32_bf16 v[12:15], a[88:91], v[204:207], v[12:15]
    ds_read_b64_tr_b16 a[96:97], v249 offset:8
    ds_read_b64_tr_b16 a[98:99], v249 offset:1032
    s_mov_b32 m0, s62
    s_addk_i32 s58, 31744
    buffer_load_dwordx4 v254, s[16:19], s58 offen offset:1024 lds
    v_mfma_f32_16x16x32_bf16 v[28:31], a[88:91], v[208:211], v[28:31]
    v_mfma_f32_16x16x32_bf16 v[44:47], a[88:91], v[212:215], v[44:47]
    s_mov_b32 m0, s62
    s_addk_i32 s58, 31744
    buffer_load_dwordx4 v254, s[16:19], s58 offen offset:2048 lds
    v_mfma_f32_16x16x32_bf16 v[60:63], a[88:91], v[216:219], v[60:63]
    ds_read_b128 v[184:187], v252 offset:4096
    v_mfma_f32_16x16x32_bf16 v[76:79], a[88:91], v[220:223], v[76:79]
    s_add_u32 m0, s48, 8192
    s_lshl1_add_u32 s56, s59, 2
    s_lshl_b32 s56, s56, 13
    s_xor_b32 s56, s56, s46
    s_waitcnt vmcnt(24)
    buffer_load_dwordx4 v5, s[12:15], s56 offen offset:0 nt lds
    v_mfma_f32_16x16x32_bf16 v[92:95], a[88:91], v[224:227], v[92:95]
    v_mfma_f32_16x16x32_bf16 v[108:111], a[88:91], v[228:231], v[108:111]
    s_waitcnt vmcnt(24)
    buffer_load_dwordx4 v6, s[12:15], s56 offen offset:1024 nt lds
    s_waitcnt lgkmcnt(5)
    v_mfma_f32_16x16x32_bf16 v[16:19], a[92:95], v[204:207], v[16:19]
    ds_read_b64_tr_b16 a[84:85], v250 offset:0
    ds_read_b64_tr_b16 a[86:87], v250 offset:1024
    ds_read_b128 v[188:191], v252 offset:6144
    v_mfma_f32_16x16x32_bf16 v[32:35], a[92:95], v[208:211], v[32:35]
    s_waitcnt vmcnt(24)
    buffer_load_dwordx4 v5, s[12:15], s56 offen offset:2048 nt lds
    v_mfma_f32_16x16x32_bf16 v[48:51], a[92:95], v[212:215], v[48:51]
    v_mfma_f32_16x16x32_bf16 v[64:67], a[92:95], v[216:219], v[64:67]
    s_waitcnt vmcnt(24)
    buffer_load_dwordx4 v6, s[12:15], s56 offen offset:3072 nt lds
    v_mfma_f32_16x16x32_bf16 v[80:83], a[92:95], v[220:223], v[80:83]
    ds_read_b128 v[192:195], v252 offset:8192
    v_mfma_f32_16x16x32_bf16 v[96:99], a[92:95], v[224:227], v[96:99]
    s_add_u32 m0, s49, 8192
    s_xor_b32 s56, s56, 0x1000
    s_waitcnt vmcnt(24)
    buffer_load_dwordx4 v5, s[12:15], s56 offen offset:0 nt lds
    v_mfma_f32_16x16x32_bf16 v[112:115], a[92:95], v[228:231], v[112:115]
    s_waitcnt lgkmcnt(5)
    v_mfma_f32_16x16x32_bf16 v[20:23], a[96:99], v[204:207], v[20:23]
    ds_read_b64_tr_b16 a[88:89], v250 offset:8
    ds_read_b64_tr_b16 a[90:91], v250 offset:1032
    s_waitcnt vmcnt(18)
    buffer_load_dwordx4 v6, s[12:15], s56 offen offset:1024 nt lds
    v_mfma_f32_16x16x32_bf16 v[36:39], a[96:99], v[208:211], v[36:39]
    ds_read_b128 v[196:199], v252 offset:10240
    v_mfma_f32_16x16x32_bf16 v[52:55], a[96:99], v[212:215], v[52:55]
    s_waitcnt vmcnt(18)
    buffer_load_dwordx4 v5, s[12:15], s56 offen offset:2048 nt lds
    v_mfma_f32_16x16x32_bf16 v[68:71], a[96:99], v[216:219], v[68:71]
    v_mfma_f32_16x16x32_bf16 v[84:87], a[96:99], v[220:223], v[84:87]
    s_waitcnt vmcnt(18)
    buffer_load_dwordx4 v6, s[12:15], s56 offen offset:3072 nt lds
    v_mfma_f32_16x16x32_bf16 v[100:103], a[96:99], v[224:227], v[100:103]
    ds_read_b128 v[200:203], v252 offset:12288
    v_mfma_f32_16x16x32_bf16 v[116:119], a[96:99], v[228:231], v[116:119]
    s_barrier
    s_mov_b32 m0, s62
    s_addk_i32 s58, 31744
    buffer_load_dwordx4 v254, s[16:19], s58 offen offset:3072 lds
    s_waitcnt lgkmcnt(6)
    v_mfma_f32_16x16x32_bf16 v[120:123], a[84:87], v[204:207], v[120:123]
    ds_read_b64_tr_b16 a[92:93], v251 offset:0
    ds_read_b64_tr_b16 a[94:95], v251 offset:1024
    v_mfma_f32_16x16x32_bf16 v[128:131], a[84:87], v[208:211], v[128:131]
    s_add_u32 m0, s62, 4096
    s_add_u32 s58, s58, 35840
    buffer_load_dwordx4 v254, s[16:19], s58 offen offset:0 lds
    v_mfma_f32_16x16x32_bf16 v[136:139], a[84:87], v[212:215], v[136:139]
    v_mfma_f32_16x16x32_bf16 v[144:147], a[84:87], v[216:219], v[144:147]
    s_add_u32 m0, s62, 4096
    s_addk_i32 s58, 31744
    buffer_load_dwordx4 v254, s[16:19], s58 offen offset:1024 lds
    v_mfma_f32_16x16x32_bf16 v[152:155], a[84:87], v[220:223], v[152:155]
    v_mfma_f32_16x16x32_bf16 v[160:163], a[84:87], v[224:227], v[160:163]
    s_add_u32 m0, s62, 4096
    s_addk_i32 s58, 31744
    buffer_load_dwordx4 v254, s[16:19], s58 offen offset:2048 lds
    v_mfma_f32_16x16x32_bf16 v[168:171], a[84:87], v[228:231], v[168:171]
    s_waitcnt lgkmcnt(4)
    v_mfma_f32_16x16x32_bf16 v[124:127], a[88:91], v[204:207], v[124:127]
    ds_read_b64_tr_b16 a[96:97], v251 offset:8
    ds_read_b64_tr_b16 a[98:99], v251 offset:1032
    s_add_u32 m0, s62, 4096
    s_addk_i32 s58, 31744
    buffer_load_dwordx4 v254, s[16:19], s58 offen offset:3072 lds
    s_add_u32 s62, s62, 8192
    s_cmp_eq_u32 s62, s64
    s_cselect_b32 s62, s63, s62
    v_mfma_f32_16x16x32_bf16 v[132:135], a[88:91], v[208:211], v[132:135]
    s_mov_b32 s53, s61
    s_addk_i32 s61, 8192
    s_cmp_eq_u32 s61, s64
    s_cselect_b32 s61, s63, s61
    s_sub_u32 s53, s61, s53
    v_add_u32 v248, s53, v248
    v_add_u32 v249, s53, v249
    v_add_u32 v250, s53, v250
    v_add_u32 v251, s53, v251
    v_mfma_f32_16x16x32_bf16 v[140:143], a[88:91], v[212:215], v[140:143]
    s_add_u32 m0, s48, 16384
    s_lshl1_add_u32 s56, s59, 3
    s_lshl_b32 s56, s56, 13
    s_xor_b32 s56, s56, s46
    s_waitcnt vmcnt(23)
    buffer_load_dwordx4 v5, s[8:11], s56 offen offset:0 nt lds
    v_mfma_f32_16x16x32_bf16 v[148:151], a[88:91], v[216:219], v[148:151]
    v_mfma_f32_16x16x32_bf16 v[156:159], a[88:91], v[220:223], v[156:159]
    s_waitcnt vmcnt(23)
    buffer_load_dwordx4 v6, s[8:11], s56 offen offset:1024 nt lds
    v_mfma_f32_16x16x32_bf16 v[164:167], a[88:91], v[224:227], v[164:167]
    v_mfma_f32_16x16x32_bf16 v[172:175], a[88:91], v[228:231], v[172:175]
    s_waitcnt lgkmcnt(2)
    v_mfma_f32_16x16x32_bf16 a[0:3], a[92:95], v[204:207], a[0:3]
    ds_read_b64_tr_b16 a[84:85], v248 offset:0
    ds_read_b64_tr_b16 a[86:87], v248 offset:1024
    s_waitcnt vmcnt(23)
    buffer_load_dwordx4 v5, s[8:11], s56 offen offset:2048 nt lds
    v_mfma_f32_16x16x32_bf16 a[8:11], a[92:95], v[208:211], a[8:11]
    v_mfma_f32_16x16x32_bf16 a[16:19], a[92:95], v[212:215], a[16:19]
    s_mov_b32 s53, s66
    s_addk_i32 s66, -16384
    s_cmp_lt_i32 s66, 0
    s_cselect_b32 s66, 32768, s66
    s_sub_u32 s53, s66, s53
    v_add_u32 v252, s53, v252
    s_waitcnt vmcnt(23)
    buffer_load_dwordx4 v6, s[8:11], s56 offen offset:3072 nt lds
    v_mfma_f32_16x16x32_bf16 a[24:27], a[92:95], v[216:219], a[24:27]
    v_mfma_f32_16x16x32_bf16 a[32:35], a[92:95], v[220:223], a[32:35]
    s_add_u32 m0, s49, 16384
    s_xor_b32 s56, s56, 0x1000
    s_waitcnt vmcnt(23)
    buffer_load_dwordx4 v5, s[8:11], s56 offen offset:0 nt lds
    v_mfma_f32_16x16x32_bf16 a[40:43], a[92:95], v[224:227], a[40:43]
    v_mfma_f32_16x16x32_bf16 a[48:51], a[92:95], v[228:231], a[48:51]
    s_waitcnt vmcnt(17)
    buffer_load_dwordx4 v6, s[8:11], s56 offen offset:1024 nt lds
    s_waitcnt lgkmcnt(2)
    v_mfma_f32_16x16x32_bf16 a[4:7], a[96:99], v[204:207], a[4:7]
    ds_read_b64_tr_b16 a[88:89], v248 offset:8
    ds_read_b64_tr_b16 a[90:91], v248 offset:1032
    v_mfma_f32_16x16x32_bf16 a[12:15], a[96:99], v[208:211], a[12:15]
    s_waitcnt vmcnt(17)
    buffer_load_dwordx4 v5, s[8:11], s56 offen offset:2048 nt lds
    v_mfma_f32_16x16x32_bf16 a[20:23], a[96:99], v[212:215], a[20:23]
    v_mfma_f32_16x16x32_bf16 a[28:31], a[96:99], v[216:219], a[28:31]
    s_waitcnt vmcnt(17)
    buffer_load_dwordx4 v6, s[8:11], s56 offen offset:3072 nt lds
    v_mfma_f32_16x16x32_bf16 a[36:39], a[96:99], v[220:223], a[36:39]
    v_mfma_f32_16x16x32_bf16 a[44:47], a[96:99], v[224:227], a[44:47]
    v_mfma_f32_16x16x32_bf16 a[52:55], a[96:99], v[228:231], a[52:55]
    s_barrier
    s_add_u32 s59, s59, 1
    s_cmp_lt_u32 s59, 2
    s_cbranch_scc1 L_a2e
L_a2:
    s_mov_b32 m0, s62
    s_lshl1_add_u32 s58, s59, 2
    s_xor_b32 s58, s58, s60
    s_lshl_b32 s58, s58, 18
    buffer_load_dwordx4 v254, s[16:19], s58 offen offset:0 lds
    s_waitcnt lgkmcnt(2)
    v_mfma_f32_16x16x32_bf16 v[8:11], a[84:87], v[176:179], v[8:11]
    ds_read_b64_tr_b16 a[92:93], v249 offset:0
    ds_read_b64_tr_b16 a[94:95], v249 offset:1024
    v_mfma_f32_16x16x32_bf16 v[24:27], a[84:87], v[180:183], v[24:27]
    s_mov_b32 m0, s62
    s_addk_i32 s58, 31744
    buffer_load_dwordx4 v254, s[16:19], s58 offen offset:1024 lds
    v_mfma_f32_16x16x32_bf16 v[40:43], a[84:87], v[184:187], v[40:43]
    ds_read_b128 v[204:207], v253 offset:0
    v_mfma_f32_16x16x32_bf16 v[56:59], a[84:87], v[188:191], v[56:59]
    s_mov_b32 m0, s62
    s_addk_i32 s58, 31744
    buffer_load_dwordx4 v254, s[16:19], s58 offen offset:2048 lds
    v_mfma_f32_16x16x32_bf16 v[72:75], a[84:87], v[192:195], v[72:75]
    v_mfma_f32_16x16x32_bf16 v[88:91], a[84:87], v[196:199], v[88:91]
    s_mov_b32 m0, s62
    s_addk_i32 s58, 31744
    buffer_load_dwordx4 v254, s[16:19], s58 offen offset:3072 lds
    v_mfma_f32_16x16x32_bf16 v[104:107], a[84:87], v[200:203], v[104:107]
    ds_read_b128 v[208:211], v253 offset:2048
    s_waitcnt lgkmcnt(4)
    v_mfma_f32_16x16x32_bf16 v[12:15], a[88:91], v[176:179], v[12:15]
    ds_read_b64_tr_b16 a[96:97], v249 offset:8
    ds_read_b64_tr_b16 a[98:99], v249 offset:1032
    s_add_u32 m0, s62, 4096
    s_add_u32 s58, s58, 35840
    buffer_load_dwordx4 v254, s[16:19], s58 offen offset:0 lds
    v_mfma_f32_16x16x32_bf16 v[28:31], a[88:91], v[180:183], v[28:31]
    v_mfma_f32_16x16x32_bf16 v[44:47], a[88:91], v[184:187], v[44:47]
    s_add_u32 m0, s62, 4096
    s_addk_i32 s58, 31744
    buffer_load_dwordx4 v254, s[16:19], s58 offen offset:1024 lds
    v_mfma_f32_16x16x32_bf16 v[60:63], a[88:91], v[188:191], v[60:63]
    ds_read_b128 v[212:215], v253 offset:4096
    v_mfma_f32_16x16x32_bf16 v[76:79], a[88:91], v[192:195], v[76:79]
    s_add_u32 m0, s48, 24576
    s_lshl1_add_u32 s56, s59, 1
    s_lshl_b32 s56, s56, 13
    s_xor_b32 s56, s56, s46
    s_waitcnt vmcnt(19)
    buffer_load_dwordx4 v5, s[12:15], s56 offen offset:0 nt lds
    v_mfma_f32_16x16x32_bf16 v[92:95], a[88:91], v[196:199], v[92:95]
    v_mfma_f32_16x16x32_bf16 v[108:111], a[88:91], v[200:203], v[108:111]
    s_waitcnt vmcnt(14)
    buffer_load_dwordx4 v6, s[12:15], s56 offen offset:1024 nt lds
    s_waitcnt lgkmcnt(5)
    v_mfma_f32_16x16x32_bf16 v[16:19], a[92:95], v[176:179], v[16:19]
    ds_read_b64_tr_b16 a[84:85], v250 offset:0
    ds_read_b64_tr_b16 a[86:87], v250 offset:1024
    ds_read_b128 v[216:219], v253 offset:6144
    v_mfma_f32_16x16x32_bf16 v[32:35], a[92:95], v[180:183], v[32:35]
    s_waitcnt vmcnt(14)
    buffer_load_dwordx4 v5, s[12:15], s56 offen offset:2048 nt lds
    v_mfma_f32_16x16x32_bf16 v[48:51], a[92:95], v[184:187], v[48:51]
    v_mfma_f32_16x16x32_bf16 v[64:67], a[92:95], v[188:191], v[64:67]
    s_waitcnt vmcnt(14)
    buffer_load_dwordx4 v6, s[12:15], s56 offen offset:3072 nt lds
    v_mfma_f32_16x16x32_bf16 v[80:83], a[92:95], v[192:195], v[80:83]
    ds_read_b128 v[220:223], v253 offset:8192
    v_mfma_f32_16x16x32_bf16 v[96:99], a[92:95], v[196:199], v[96:99]
    s_add_u32 m0, s49, 24576
    s_xor_b32 s56, s56, 0x1000
    s_waitcnt vmcnt(14)
    buffer_load_dwordx4 v5, s[12:15], s56 offen offset:0 nt lds
    v_mfma_f32_16x16x32_bf16 v[112:115], a[92:95], v[200:203], v[112:115]
    s_waitcnt lgkmcnt(5)
    v_mfma_f32_16x16x32_bf16 v[20:23], a[96:99], v[176:179], v[20:23]
    ds_read_b64_tr_b16 a[88:89], v250 offset:8
    ds_read_b64_tr_b16 a[90:91], v250 offset:1032
    s_waitcnt vmcnt(14)
    buffer_load_dwordx4 v6, s[12:15], s56 offen offset:1024 nt lds
    v_mfma_f32_16x16x32_bf16 v[36:39], a[96:99], v[180:183], v[36:39]
    ds_read_b128 v[224:227], v253 offset:10240
    v_mfma_f32_16x16x32_bf16 v[52:55], a[96:99], v[184:187], v[52:55]
    s_waitcnt vmcnt(14)
    buffer_load_dwordx4 v5, s[12:15], s56 offen offset:2048 nt lds
    v_mfma_f32_16x16x32_bf16 v[68:71], a[96:99], v[188:191], v[68:71]
    v_mfma_f32_16x16x32_bf16 v[84:87], a[96:99], v[192:195], v[84:87]
    s_waitcnt vmcnt(14)
    buffer_load_dwordx4 v6, s[12:15], s56 offen offset:3072 nt lds
    v_mfma_f32_16x16x32_bf16 v[100:103], a[96:99], v[196:199], v[100:103]
    ds_read_b128 v[228:231], v253 offset:12288
    v_mfma_f32_16x16x32_bf16 v[116:119], a[96:99], v[200:203], v[116:119]
    s_barrier
    s_add_u32 m0, s62, 4096
    s_addk_i32 s58, 31744
    buffer_load_dwordx4 v254, s[16:19], s58 offen offset:2048 lds
    s_waitcnt lgkmcnt(6)
    v_mfma_f32_16x16x32_bf16 v[120:123], a[84:87], v[176:179], v[120:123]
    ds_read_b64_tr_b16 a[92:93], v251 offset:0
    ds_read_b64_tr_b16 a[94:95], v251 offset:1024
    v_mfma_f32_16x16x32_bf16 v[128:131], a[84:87], v[180:183], v[128:131]
    s_add_u32 m0, s62, 4096
    s_addk_i32 s58, 31744
    buffer_load_dwordx4 v254, s[16:19], s58 offen offset:3072 lds
    s_add_u32 s62, s62, 8192
    s_cmp_eq_u32 s62, s64
    s_cselect_b32 s62, s63, s62
    v_mfma_f32_16x16x32_bf16 v[136:139], a[84:87], v[184:187], v[136:139]
    v_mfma_f32_16x16x32_bf16 v[144:147], a[84:87], v[188:191], v[144:147]
    s_add_u32 m0, s96, s65
    s_add_u32 s52, s59, 2
    s_xor_b32 s57, s45, s52
    s_lshl_b32 s57, s57, 7
    s_cmp_lt_u32 s52, 8
    s_cselect_b32 s57, s57, 2146435072
    buffer_load_dwordx4 v255, s[28:31], s57 offen lds
    v_mfma_f32_16x16x32_bf16 v[152:155], a[84:87], v[192:195], v[152:155]
    v_mfma_f32_16x16x32_bf16 v[160:163], a[84:87], v[196:199], v[160:163]
    s_addk_i32 m0, 2048
    s_add_u32 s57, s57, 16384
    buffer_load_dwordx4 v255, s[28:31], s57 offen lds
    v_mfma_f32_16x16x32_bf16 v[168:171], a[84:87], v[200:203], v[168:171]
    s_waitcnt lgkmcnt(4)
    v_mfma_f32_16x16x32_bf16 v[124:127], a[88:91], v[176:179], v[124:127]
    ds_read_b64_tr_b16 a[96:97], v251 offset:8
    ds_read_b64_tr_b16 a[98:99], v251 offset:1032
    s_addk_i32 m0, 2048
    s_add_u32 s57, s57, 16384
    buffer_load_dwordx4 v255, s[28:31], s57 offen lds
    v_mfma_f32_16x16x32_bf16 v[132:135], a[88:91], v[180:183], v[132:135]
    s_mov_b32 s53, s61
    s_addk_i32 s61, 8192
    s_cmp_eq_u32 s61, s64
    s_cselect_b32 s61, s63, s61
    s_sub_u32 s53, s61, s53
    v_add_u32 v248, s53, v248
    v_add_u32 v249, s53, v249
    v_add_u32 v250, s53, v250
    v_add_u32 v251, s53, v251
    v_mfma_f32_16x16x32_bf16 v[140:143], a[88:91], v[184:187], v[140:143]
    s_addk_i32 m0, 2048
    s_add_u32 s57, s57, 16384
    buffer_load_dwordx4 v255, s[28:31], s57 offen lds
    v_mfma_f32_16x16x32_bf16 v[148:151], a[88:91], v[188:191], v[148:151]
    v_mfma_f32_16x16x32_bf16 v[156:159], a[88:91], v[192:195], v[156:159]
    s_add_u32 m0, s48, 0
    s_lshl1_add_u32 s56, s59, 2
    s_lshl_b32 s56, s56, 13
    s_xor_b32 s56, s56, s46
    s_waitcnt vmcnt(20)
    buffer_load_dwordx4 v5, s[8:11], s56 offen offset:0 nt lds
    v_mfma_f32_16x16x32_bf16 v[164:167], a[88:91], v[196:199], v[164:167]
    v_mfma_f32_16x16x32_bf16 v[172:175], a[88:91], v[200:203], v[172:175]
    s_waitcnt vmcnt(14)
    buffer_load_dwordx4 v6, s[8:11], s56 offen offset:1024 nt lds
    s_waitcnt lgkmcnt(2)
    v_mfma_f32_16x16x32_bf16 a[0:3], a[92:95], v[176:179], a[0:3]
    ds_read_b64_tr_b16 a[84:85], v248 offset:0
    ds_read_b64_tr_b16 a[86:87], v248 offset:1024
    v_mfma_f32_16x16x32_bf16 a[8:11], a[92:95], v[180:183], a[8:11]
    s_waitcnt vmcnt(14)
    buffer_load_dwordx4 v5, s[8:11], s56 offen offset:2048 nt lds
    v_mfma_f32_16x16x32_bf16 a[16:19], a[92:95], v[184:187], a[16:19]
    s_mov_b32 s53, s67
    s_addk_i32 s67, -16384
    s_cmp_lt_i32 s67, 0
    s_cselect_b32 s67, 32768, s67
    s_sub_u32 s53, s67, s53
    v_add_u32 v253, s53, v253
    v_mfma_f32_16x16x32_bf16 a[24:27], a[92:95], v[188:191], a[24:27]
    s_waitcnt vmcnt(14)
    buffer_load_dwordx4 v6, s[8:11], s56 offen offset:3072 nt lds
    v_mfma_f32_16x16x32_bf16 a[32:35], a[92:95], v[192:195], a[32:35]
    v_mfma_f32_16x16x32_bf16 a[40:43], a[92:95], v[196:199], a[40:43]
    s_add_u32 m0, s49, 0
    s_xor_b32 s56, s56, 0x1000
    s_waitcnt vmcnt(14)
    buffer_load_dwordx4 v5, s[8:11], s56 offen offset:0 nt lds
    v_mfma_f32_16x16x32_bf16 a[48:51], a[92:95], v[200:203], a[48:51]
    s_waitcnt lgkmcnt(2)
    v_mfma_f32_16x16x32_bf16 a[4:7], a[96:99], v[176:179], a[4:7]
    ds_read_b64_tr_b16 a[88:89], v248 offset:8
    ds_read_b64_tr_b16 a[90:91], v248 offset:1032
    s_waitcnt vmcnt(14)
    buffer_load_dwordx4 v6, s[8:11], s56 offen offset:1024 nt lds
    v_mfma_f32_16x16x32_bf16 a[12:15], a[96:99], v[180:183], a[12:15]
    v_mfma_f32_16x16x32_bf16 a[20:23], a[96:99], v[184:187], a[20:23]
    s_waitcnt vmcnt(14)
    buffer_load_dwordx4 v5, s[8:11], s56 offen offset:2048 nt lds
    v_mfma_f32_16x16x32_bf16 a[28:31], a[96:99], v[188:191], a[28:31]
    v_mfma_f32_16x16x32_bf16 a[36:39], a[96:99], v[192:195], a[36:39]
    s_waitcnt vmcnt(14)
    buffer_load_dwordx4 v6, s[8:11], s56 offen offset:3072 nt lds
    v_mfma_f32_16x16x32_bf16 a[44:47], a[96:99], v[196:199], a[44:47]
    v_mfma_f32_16x16x32_bf16 a[52:55], a[96:99], v[200:203], a[52:55]
    s_barrier
    s_add_u32 m0, s96, s65
    s_addk_i32 m0, 8192
    s_add_u32 s57, s57, 16384
    buffer_load_dwordx4 v255, s[28:31], s57 offen lds
    s_waitcnt lgkmcnt(2)
    v_mfma_f32_16x16x32_bf16 v[8:11], a[84:87], v[204:207], v[8:11]
    ds_read_b64_tr_b16 a[92:93], v249 offset:0
    ds_read_b64_tr_b16 a[94:95], v249 offset:1024
    v_mfma_f32_16x16x32_bf16 v[24:27], a[84:87], v[208:211], v[24:27]
    s_addk_i32 m0, 2048
    s_add_u32 s57, s57, 16384
    buffer_load_dwordx4 v255, s[28:31], s57 offen lds
    v_mfma_f32_16x16x32_bf16 v[40:43], a[84:87], v[212:215], v[40:43]
    ds_read_b128 v[176:179], v252 offset:0
    v_mfma_f32_16x16x32_bf16 v[56:59], a[84:87], v[216:219], v[56:59]
    s_addk_i32 m0, 2048
    s_add_u32 s57, s57, 16384
    buffer_load_dwordx4 v255, s[28:31], s57 offen lds
    s_addk_i32 s65, -16384
    s_cmp_lt_i32 s65, 0
    s_cselect_b32 s65, 32768, s65
    v_mfma_f32_16x16x32_bf16 v[72:75], a[84:87], v[220:223], v[72:75]
    v_mfma_f32_16x16x32_bf16 v[88:91], a[84:87], v[224:227], v[88:91]
    s_mov_b32 m0, s62
    s_lshl1_add_u32 s58, s59, 3
    s_xor_b32 s58, s58, s60
    s_lshl_b32 s58, s58, 18
    buffer_load_dwordx4 v254, s[16:19], s58 offen offset:0 lds
    v_mfma_f32_16x16x32_bf16 v[104:107], a[84:87], v[228:231], v[104:107]
    ds_read_b128 v[180:183], v252 offset:2048
    s_waitcnt lgkmcnt(4)
    v_mfma_f32_16x16x32_bf16 v[12:15], a[88:91], v[204:207], v[12:15]
    ds_read_b64_tr_b16 a[96:97], v249 offset:8
    ds_read_b64_tr_b16 a[98:99], v249 offset:1032
    s_mov_b32 m0, s62
    s_addk_i32 s58, 31744
    buffer_load_dwordx4 v254, s[16:19], s58 offen offset:1024 lds
    v_mfma_f32_16x16x32_bf16 v[28:31], a[88:91], v[208:211], v[28:31]
    v_mfma_f32_16x16x32_bf16 v[44:47], a[88:91], v[212:215], v[44:47]
    s_mov_b32 m0, s62
    s_addk_i32 s58, 31744
    buffer_load_dwordx4 v254, s[16:19], s58 offen offset:2048 lds
    v_mfma_f32_16x16x32_bf16 v[60:63], a[88:91], v[216:219], v[60:63]
    ds_read_b128 v[184:187], v252 offset:4096
    v_mfma_f32_16x16x32_bf16 v[76:79], a[88:91], v[220:223], v[76:79]
    s_add_u32 m0, s48, 8192
    s_lshl1_add_u32 s56, s59, 2
    s_lshl_b32 s56, s56, 13
    s_xor_b32 s56, s56, s46
    s_waitcnt vmcnt(20)
    buffer_load_dwordx4 v5, s[12:15], s56 offen offset:0 nt lds
    v_mfma_f32_16x16x32_bf16 v[92:95], a[88:91], v[224:227], v[92:95]
    v_mfma_f32_16x16x32_bf16 v[108:111], a[88:91], v[228:231], v[108:111]
    s_waitcnt vmcnt(14)
    buffer_load_dwordx4 v6, s[12:15], s56 offen offset:1024 nt lds
    s_waitcnt lgkmcnt(5)
    v_mfma_f32_16x16x32_bf16 v[16:19], a[92:95], v[204:207], v[16:19]
    ds_read_b64_tr_b16 a[84:85], v250 offset:0
    ds_read_b64_tr_b16 a[86:87], v250 offset:1024
    ds_read_b128 v[188:191], v252 offset:6144
    v_mfma_f32_16x16x32_bf16 v[32:35], a[92:95], v[208:211], v[32:35]
    s_waitcnt vmcnt(14)
    buffer_load_dwordx4 v5, s[12:15], s56 offen offset:2048 nt lds
    v_mfma_f32_16x16x32_bf16 v[48:51], a[92:95], v[212:215], v[48:51]
    v_mfma_f32_16x16x32_bf16 v[64:67], a[92:95], v[216:219], v[64:67]
    s_waitcnt vmcnt(14)
    buffer_load_dwordx4 v6, s[12:15], s56 offen offset:3072 nt lds
    v_mfma_f32_16x16x32_bf16 v[80:83], a[92:95], v[220:223], v[80:83]
    ds_read_b128 v[192:195], v252 offset:8192
    v_mfma_f32_16x16x32_bf16 v[96:99], a[92:95], v[224:227], v[96:99]
    s_add_u32 m0, s49, 8192
    s_xor_b32 s56, s56, 0x1000
    s_waitcnt vmcnt(14)
    buffer_load_dwordx4 v5, s[12:15], s56 offen offset:0 nt lds
    v_mfma_f32_16x16x32_bf16 v[112:115], a[92:95], v[228:231], v[112:115]
    s_waitcnt lgkmcnt(5)
    v_mfma_f32_16x16x32_bf16 v[20:23], a[96:99], v[204:207], v[20:23]
    ds_read_b64_tr_b16 a[88:89], v250 offset:8
    ds_read_b64_tr_b16 a[90:91], v250 offset:1032
    s_waitcnt vmcnt(14)
    buffer_load_dwordx4 v6, s[12:15], s56 offen offset:1024 nt lds
    v_mfma_f32_16x16x32_bf16 v[36:39], a[96:99], v[208:211], v[36:39]
    ds_read_b128 v[196:199], v252 offset:10240
    v_mfma_f32_16x16x32_bf16 v[52:55], a[96:99], v[212:215], v[52:55]
    s_waitcnt vmcnt(14)
    buffer_load_dwordx4 v5, s[12:15], s56 offen offset:2048 nt lds
    v_mfma_f32_16x16x32_bf16 v[68:71], a[96:99], v[216:219], v[68:71]
    v_mfma_f32_16x16x32_bf16 v[84:87], a[96:99], v[220:223], v[84:87]
    s_waitcnt vmcnt(14)
    buffer_load_dwordx4 v6, s[12:15], s56 offen offset:3072 nt lds
    v_mfma_f32_16x16x32_bf16 v[100:103], a[96:99], v[224:227], v[100:103]
    ds_read_b128 v[200:203], v252 offset:12288
    v_mfma_f32_16x16x32_bf16 v[116:119], a[96:99], v[228:231], v[116:119]
    s_barrier
    s_mov_b32 m0, s62
    s_addk_i32 s58, 31744
    buffer_load_dwordx4 v254, s[16:19], s58 offen offset:3072 lds
    s_waitcnt lgkmcnt(6)
    v_mfma_f32_16x16x32_bf16 v[120:123], a[84:87], v[204:207], v[120:123]
    ds_read_b64_tr_b16 a[92:93], v251 offset:0
    ds_read_b64_tr_b16 a[94:95], v251 offset:1024
    v_mfma_f32_16x16x32_bf16 v[128:131], a[84:87], v[208:211], v[128:131]
    s_add_u32 m0, s62, 4096
    s_add_u32 s58, s58, 35840
    buffer_load_dwordx4 v254, s[16:19], s58 offen offset:0 lds
    v_mfma_f32_16x16x32_bf16 v[136:139], a[84:87], v[212:215], v[136:139]
    v_mfma_f32_16x16x32_bf16 v[144:147], a[84:87], v[216:219], v[144:147]
    s_add_u32 m0, s62, 4096
    s_addk_i32 s58, 31744
    buffer_load_dwordx4 v254, s[16:19], s58 offen offset:1024 lds
    v_mfma_f32_16x16x32_bf16 v[152:155], a[84:87], v[220:223], v[152:155]
    v_mfma_f32_16x16x32_bf16 v[160:163], a[84:87], v[224:227], v[160:163]
    s_add_u32 m0, s62, 4096
    s_addk_i32 s58, 31744
    buffer_load_dwordx4 v254, s[16:19], s58 offen offset:2048 lds
    v_mfma_f32_16x16x32_bf16 v[168:171], a[84:87], v[228:231], v[168:171]
    s_waitcnt lgkmcnt(4)
    v_mfma_f32_16x16x32_bf16 v[124:127], a[88:91], v[204:207], v[124:127]
    ds_read_b64_tr_b16 a[96:97], v251 offset:8
    ds_read_b64_tr_b16 a[98:99], v251 offset:1032
    s_add_u32 m0, s62, 4096
    s_addk_i32 s58, 31744
    buffer_load_dwordx4 v254, s[16:19], s58 offen offset:3072 lds
    s_add_u32 s62, s62, 8192
    s_cmp_eq_u32 s62, s64
    s_cselect_b32 s62, s63, s62
    v_mfma_f32_16x16x32_bf16 v[132:135], a[88:91], v[208:211], v[132:135]
    s_mov_b32 s53, s61
    s_addk_i32 s61, 8192
    s_cmp_eq_u32 s61, s64
    s_cselect_b32 s61, s63, s61
    s_sub_u32 s53, s61, s53
    v_add_u32 v248, s53, v248
    v_add_u32 v249, s53, v249
    v_add_u32 v250, s53, v250
    v_add_u32 v251, s53, v251
    v_mfma_f32_16x16x32_bf16 v[140:143], a[88:91], v[212:215], v[140:143]
    s_add_u32 m0, s48, 16384
    s_lshl1_add_u32 s56, s59, 3
    s_lshl_b32 s56, s56, 13
    s_xor_b32 s56, s56, s46
    s_waitcnt vmcnt(19)
    buffer_load_dwordx4 v5, s[8:11], s56 offen offset:0 nt lds
    v_mfma_f32_16x16x32_bf16 v[148:151], a[88:91], v[216:219], v[148:151]
    v_mfma_f32_16x16x32_bf16 v[156:159], a[88:91], v[220:223], v[156:159]
    s_waitcnt vmcnt(13)
    buffer_load_dwordx4 v6, s[8:11], s56 offen offset:1024 nt lds
    v_mfma_f32_16x16x32_bf16 v[164:167], a[88:91], v[224:227], v[164:167]
    v_mfma_f32_16x16x32_bf16 v[172:175], a[88:91], v[228:231], v[172:175]
    s_waitcnt lgkmcnt(2)
    v_mfma_f32_16x16x32_bf16 a[0:3], a[92:95], v[204:207], a[0:3]
    ds_read_b64_tr_b16 a[84:85], v248 offset:0
    ds_read_b64_tr_b16 a[86:87], v248 offset:1024
    s_waitcnt vmcnt(13)
    buffer_load_dwordx4 v5, s[8:11], s56 offen offset:2048 nt lds
    v_mfma_f32_16x16x32_bf16 a[8:11], a[92:95], v[208:211], a[8:11]
    v_mfma_f32_16x16x32_bf16 a[16:19], a[92:95], v[212:215], a[16:19]
    s_mov_b32 s53, s66
    s_addk_i32 s66, -16384
    s_cmp_lt_i32 s66, 0
    s_cselect_b32 s66, 32768, s66
    s_sub_u32 s53, s66, s53
    v_add_u32 v252, s53, v252
    s_waitcnt vmcnt(13)
    buffer_load_dwordx4 v6, s[8:11], s56 offen offset:3072 nt lds
    v_mfma_f32_16x16x32_bf16 a[24:27], a[92:95], v[216:219], a[24:27]
    v_mfma_f32_16x16x32_bf16 a[32:35], a[92:95], v[220:223], a[32:35]
    s_add_u32 m0, s49, 16384
    s_xor_b32 s56, s56, 0x1000
    s_waitcnt vmcnt(13)
    buffer_load_dwordx4 v5, s[8:11], s56 offen offset:0 nt lds
    v_mfma_f32_16x16x32_bf16 a[40:43], a[92:95], v[224:227], a[40:43]
    v_mfma_f32_16x16x32_bf16 a[48:51], a[92:95], v[228:231], a[48:51]
    s_waitcnt vmcnt(13)
    buffer_load_dwordx4 v6, s[8:11], s56 offen offset:1024 nt lds
    s_waitcnt lgkmcnt(2)
    v_mfma_f32_16x16x32_bf16 a[4:7], a[96:99], v[204:207], a[4:7]
    ds_read_b64_tr_b16 a[88:89], v248 offset:8
    ds_read_b64_tr_b16 a[90:91], v248 offset:1032
    v_mfma_f32_16x16x32_bf16 a[12:15], a[96:99], v[208:211], a[12:15]
    s_waitcnt vmcnt(13)
    buffer_load_dwordx4 v5, s[8:11], s56 offen offset:2048 nt lds
    v_mfma_f32_16x16x32_bf16 a[20:23], a[96:99], v[212:215], a[20:23]
    v_mfma_f32_16x16x32_bf16 a[28:31], a[96:99], v[216:219], a[28:31]
    s_waitcnt vmcnt(13)
    buffer_load_dwordx4 v6, s[8:11], s56 offen offset:3072 nt lds
    v_mfma_f32_16x16x32_bf16 a[36:39], a[96:99], v[220:223], a[36:39]
    v_mfma_f32_16x16x32_bf16 a[44:47], a[96:99], v[224:227], a[44:47]
    v_mfma_f32_16x16x32_bf16 a[52:55], a[96:99], v[228:231], a[52:55]
    s_barrier
    s_add_u32 s59, s59, 1
    s_cmp_lt_u32 s59, 7
    s_cbranch_scc1 L_a2
    s_add_u32 m0, s48, 24576
    s_xor_b32 s56, s46, 122880
    s_waitcnt vmcnt(13)
    buffer_load_dwordx4 v5, s[12:15], s56 offen offset:0 nt lds
    ds_read_b64_tr_b16 a[92:93], v249 offset:0
    ds_read_b64_tr_b16 a[94:95], v249 offset:1024
    ds_read_b64_tr_b16 a[96:97], v249 offset:8
    ds_read_b64_tr_b16 a[98:99], v249 offset:1032
    ds_read_b64_tr_b16 a[100:101], v250 offset:0
    ds_read_b64_tr_b16 a[102:103], v250 offset:1024
    ds_read_b64_tr_b16 a[104:105], v250 offset:8
    ds_read_b64_tr_b16 a[106:107], v250 offset:1032
    ds_read_b64_tr_b16 a[108:109], v251 offset:0
    ds_read_b64_tr_b16 a[110:111], v251 offset:1024
    ds_read_b64_tr_b16 a[112:113], v251 offset:8
    s_waitcnt lgkmcnt(14)
    ds_read_b64_tr_b16 a[114:115], v251 offset:1032
    s_waitcnt lgkmcnt(14)
    ds_read_b128 v[204:207], v253 offset:0
    s_waitcnt lgkmcnt(14)
    ds_read_b128 v[208:211], v253 offset:2048
    s_waitcnt vmcnt(8)
    buffer_load_dwordx4 v6, s[12:15], s56 offen offset:1024 nt lds
    s_waitcnt lgkmcnt(14)
    ds_read_b128 v[212:215], v253 offset:4096
    s_waitcnt lgkmcnt(14)
    ds_read_b128 v[216:219], v253 offset:6144
    s_waitcnt lgkmcnt(14)
    ds_read_b128 v[220:223], v253 offset:8192
    s_waitcnt lgkmcnt(14)
    ds_read_b128 v[224:227], v253 offset:10240
    s_waitcnt lgkmcnt(14)
    ds_read_b128 v[228:231], v253 offset:12288
    s_waitcnt lgkmcnt(0)
    v_mfma_f32_16x16x32_bf16 v[8:11], a[84:87], v[176:179], v[8:11]
    v_mfma_f32_16x16x32_bf16 v[12:15], a[88:91], v[176:179], v[12:15]
    s_waitcnt vmcnt(8)
    buffer_load_dwordx4 v5, s[12:15], s56 offen offset:2048 nt lds
    v_mfma_f32_16x16x32_bf16 v[16:19], a[92:95], v[176:179], v[16:19]
    v_mfma_f32_16x16x32_bf16 v[20:23], a[96:99], v[176:179], v[20:23]
    v_mfma_f32_16x16x32_bf16 v[120:123], a[100:103], v[176:179], v[120:123]
    v_mfma_f32_16x16x32_bf16 v[124:127], a[104:107], v[176:179], v[124:127]
    v_mfma_f32_16x16x32_bf16 a[0:3], a[108:111], v[176:179], a[0:3]
    v_mfma_f32_16x16x32_bf16 a[4:7], a[112:115], v[176:179], a[4:7]
    v_mfma_f32_16x16x32_bf16 v[24:27], a[84:87], v[180:183], v[24:27]
    v_mfma_f32_16x16x32_bf16 v[28:31], a[88:91], v[180:183], v[28:31]
    s_waitcnt vmcnt(8)
    buffer_load_dwordx4 v6, s[12:15], s56 offen offset:3072 nt lds
    v_mfma_f32_16x16x32_bf16 v[32:35], a[92:95], v[180:183], v[32:35]
    v_mfma_f32_16x16x32_bf16 v[36:39], a[96:99], v[180:183], v[36:39]
    v_mfma_f32_16x16x32_bf16 v[128:131], a[100:103], v[180:183], v[128:131]
    v_mfma_f32_16x16x32_bf16 v[132:135], a[104:107], v[180:183], v[132:135]
    v_mfma_f32_16x16x32_bf16 a[8:11], a[108:111], v[180:183], a[8:11]
    v_mfma_f32_16x16x32_bf16 a[12:15], a[112:115], v[180:183], a[12:15]
    v_mfma_f32_16x16x32_bf16 v[40:43], a[84:87], v[184:187], v[40:43]
    v_mfma_f32_16x16x32_bf16 v[44:47], a[88:91], v[184:187], v[44:47]
    v_mfma_f32_16x16x32_bf16 v[48:51], a[92:95], v[184:187], v[48:51]
    s_add_u32 m0, s49, 24576
    s_xor_b32 s56, s56, 0x1000
    s_waitcnt vmcnt(8)
    buffer_load_dwordx4 v5, s[12:15], s56 offen offset:0 nt lds
    v_mfma_f32_16x16x32_bf16 v[52:55], a[96:99], v[184:187], v[52:55]
    v_mfma_f32_16x16x32_bf16 v[136:139], a[100:103], v[184:187], v[136:139]
    v_mfma_f32_16x16x32_bf16 v[140:143], a[104:107], v[184:187], v[140:143]
    v_mfma_f32_16x16x32_bf16 a[16:19], a[108:111], v[184:187], a[16:19]
    v_mfma_f32_16x16x32_bf16 a[20:23], a[112:115], v[184:187], a[20:23]
    v_mfma_f32_16x16x32_bf16 v[56:59], a[84:87], v[188:191], v[56:59]
    v_mfma_f32_16x16x32_bf16 v[60:63], a[88:91], v[188:191], v[60:63]
    v_mfma_f32_16x16x32_bf16 v[64:67], a[92:95], v[188:191], v[64:67]
    s_waitcnt vmcnt(8)
    buffer_load_dwordx4 v6, s[12:15], s56 offen offset:1024 nt lds
    v_mfma_f32_16x16x32_bf16 v[68:71], a[96:99], v[188:191], v[68:71]
    v_mfma_f32_16x16x32_bf16 v[144:147], a[100:103], v[188:191], v[144:147]
    v_mfma_f32_16x16x32_bf16 v[148:151], a[104:107], v[188:191], v[148:151]
    v_mfma_f32_16x16x32_bf16 a[24:27], a[108:111], v[188:191], a[24:27]
    v_mfma_f32_16x16x32_bf16 a[28:31], a[112:115], v[188:191], a[28:31]
    v_mfma_f32_16x16x32_bf16 v[72:75], a[84:87], v[192:195], v[72:75]
    v_mfma_f32_16x16x32_bf16 v[76:79], a[88:91], v[192:195], v[76:79]
    v_mfma_f32_16x16x32_bf16 v[80:83], a[92:95], v[192:195], v[80:83]
    s_waitcnt vmcnt(8)
    buffer_load_dwordx4 v5, s[12:15], s56 offen offset:2048 nt lds
    v_mfma_f32_16x16x32_bf16 v[84:87], a[96:99], v[192:195], v[84:87]
    s_mov_b32 s53, s61
    s_addk_i32 s61, 8192
    s_cmp_eq_u32 s61, s64
    s_cselect_b32 s61, s63, s61
    s_sub_u32 s53, s61, s53
    v_add_u32 v248, s53, v248
    v_add_u32 v249, s53, v249
    v_add_u32 v250, s53, v250
    v_add_u32 v251, s53, v251
    ds_read_b64_tr_b16 a[116:117], v248 offset:0
    ds_read_b64_tr_b16 a[118:119], v248 offset:1024
    ds_read_b64_tr_b16 a[120:121], v248 offset:8
    ds_read_b64_tr_b16 a[122:123], v248 offset:1032
    ds_read_b64_tr_b16 a[124:125], v249 offset:0
    ds_read_b64_tr_b16 a[126:127], v249 offset:1024
    ds_read_b64_tr_b16 a[128:129], v249 offset:8
    ds_read_b64_tr_b16 a[130:131], v249 offset:1032
    ds_read_b64_tr_b16 a[132:133], v250 offset:0
    ds_read_b64_tr_b16 a[134:135], v250 offset:1024
    s_waitcnt vmcnt(8)
    buffer_load_dwordx4 v6, s[12:15], s56 offen offset:3072 nt lds
    ds_read_b64_tr_b16 a[136:137], v250 offset:8
    ds_read_b64_tr_b16 a[138:139], v250 offset:1032
    ds_read_b64_tr_b16 a[140:141], v251 offset:0
    ds_read_b64_tr_b16 a[142:143], v251 offset:1024
    ds_read_b64_tr_b16 a[56:57], v251 offset:8
    s_waitcnt lgkmcnt(14)
    ds_read_b64_tr_b16 a[58:59], v251 offset:1032
    v_mfma_f32_16x16x32_bf16 v[152:155], a[100:103], v[192:195], v[152:155]
    v_mfma_f32_16x16x32_bf16 v[156:159], a[104:107], v[192:195], v[156:159]
    v_mfma_f32_16x16x32_bf16 a[32:35], a[108:111], v[192:195], a[32:35]
    v_mfma_f32_16x16x32_bf16 a[36:39], a[112:115], v[192:195], a[36:39]
    s_waitcnt lgkmcnt(0)
    v_mfma_f32_16x16x32_bf16 v[8:11], a[116:119], v[204:207], v[8:11]
    s_barrier
    s_add_u32 m0, s48, 0
    s_xor_b32 s56, s47, 0
    s_waitcnt vmcnt(8)
    buffer_load_dwordx4 v5, s[8:11], s56 offen offset:0 nt lds
    v_mfma_f32_16x16x32_bf16 v[12:15], a[120:123], v[204:207], v[12:15]
    v_mfma_f32_16x16x32_bf16 v[16:19], a[124:127], v[204:207], v[16:19]
    v_mfma_f32_16x16x32_bf16 v[20:23], a[128:131], v[204:207], v[20:23]
    v_mfma_f32_16x16x32_bf16 v[120:123], a[132:135], v[204:207], v[120:123]
    v_mfma_f32_16x16x32_bf16 v[124:127], a[136:139], v[204:207], v[124:127]
    v_mfma_f32_16x16x32_bf16 a[0:3], a[140:143], v[204:207], a[0:3]
    v_mfma_f32_16x16x32_bf16 a[4:7], a[56:59], v[204:207], a[4:7]
    v_mfma_f32_16x16x32_bf16 v[24:27], a[116:119], v[208:211], v[24:27]
    v_mfma_f32_16x16x32_bf16 v[28:31], a[120:123], v[208:211], v[28:31]
    v_mfma_f32_16x16x32_bf16 v[32:35], a[124:127], v[208:211], v[32:35]
    v_mfma_f32_16x16x32_bf16 v[36:39], a[128:131], v[208:211], v[36:39]
    s_waitcnt vmcnt(8)
    buffer_load_dwordx4 v6, s[8:11], s56 offen offset:1024 nt lds
    v_mfma_f32_16x16x32_bf16 v[128:131], a[132:135], v[208:211], v[128:131]
    v_mfma_f32_16x16x32_bf16 v[132:135], a[136:139], v[208:211], v[132:135]
    v_mfma_f32_16x16x32_bf16 a[8:11], a[140:143], v[208:211], a[8:11]
    v_mfma_f32_16x16x32_bf16 a[12:15], a[56:59], v[208:211], a[12:15]
    v_accvgpr_read_b32 v176, a0
    v_accvgpr_read_b32 v177, a1
    v_accvgpr_read_b32 v178, a2
    v_accvgpr_read_b32 v179, a3
    v_accvgpr_read_b32 v180, a4
    v_accvgpr_read_b32 v181, a5
    v_accvgpr_read_b32 v182, a6
    s_waitcnt vmcnt(8)
    buffer_load_dwordx4 v5, s[8:11], s56 offen offset:2048 nt lds
    v_accvgpr_read_b32 v183, a7
    v_pk_mul_f32 v[8:9], v[8:9], s[50:51]
    v_pk_mul_f32 v[10:11], v[10:11], s[50:51]
    v_pk_mul_f32 v[12:13], v[12:13], s[50:51]
    v_pk_mul_f32 v[14:15], v[14:15], s[50:51]
    v_pk_mul_f32 v[16:17], v[16:17], s[50:51]
    v_pk_mul_f32 v[18:19], v[18:19], s[50:51]
    v_pk_mul_f32 v[20:21], v[20:21], s[50:51]
    v_pk_mul_f32 v[22:23], v[22:23], s[50:51]
    v_pk_mul_f32 v[120:121], v[120:121], s[50:51]
    v_pk_mul_f32 v[122:123], v[122:123], s[50:51]
    s_waitcnt vmcnt(8)
    buffer_load_dwordx4 v6, s[8:11], s56 offen offset:3072 nt lds
    v_pk_mul_f32 v[124:125], v[124:125], s[50:51]
    v_pk_mul_f32 v[126:127], v[126:127], s[50:51]
    v_pk_mul_f32 v[176:177], v[176:177], s[50:51]
    v_pk_mul_f32 v[178:179], v[178:179], s[50:51]
    v_pk_mul_f32 v[180:181], v[180:181], s[50:51]
    v_pk_mul_f32 v[182:183], v[182:183], s[50:51]
    v_mfma_f32_16x16x32_bf16 v[88:91], a[84:87], v[196:199], v[88:91]
    v_cvt_pk_bf16_f32 v8, v8, v9
    v_cvt_pk_bf16_f32 v9, v10, v11
    v_mfma_f32_16x16x32_bf16 v[92:95], a[88:91], v[196:199], v[92:95]
    v_cvt_pk_bf16_f32 v10, v12, v13
    v_cvt_pk_bf16_f32 v11, v14, v15
    v_mfma_f32_16x16x32_bf16 v[96:99], a[92:95], v[196:199], v[96:99]
    v_accvgpr_write_b32 a144, v8
    v_accvgpr_write_b32 a145, v9
    v_mfma_f32_16x16x32_bf16 v[100:103], a[96:99], v[196:199], v[100:103]
    v_accvgpr_write_b32 a146, v10
    v_accvgpr_write_b32 a147, v11
    v_mfma_f32_16x16x32_bf16 v[160:163], a[100:103], v[196:199], v[160:163]
    v_cvt_pk_bf16_f32 v16, v16, v17
    v_cvt_pk_bf16_f32 v17, v18, v19
    v_mfma_f32_16x16x32_bf16 v[164:167], a[104:107], v[196:199], v[164:167]
    v_cvt_pk_bf16_f32 v18, v20, v21
    v_cvt_pk_bf16_f32 v19, v22, v23
    s_add_u32 m0, s49, 0
    s_xor_b32 s56, s56, 0x1000
    s_waitcnt vmcnt(8)
    buffer_load_dwordx4 v5, s[8:11], s56 offen offset:0 nt lds
    v_mfma_f32_16x16x32_bf16 a[40:43], a[108:111], v[196:199], a[40:43]
    v_accvgpr_write_b32 a148, v16
    v_accvgpr_write_b32 a149, v17
    v_mfma_f32_16x16x32_bf16 a[44:47], a[112:115], v[196:199], a[44:47]
    v_accvgpr_write_b32 a150, v18
    v_accvgpr_write_b32 a151, v19
    v_mfma_f32_16x16x32_bf16 v[40:43], a[116:119], v[212:215], v[40:43]
    v_cvt_pk_bf16_f32 v120, v120, v121
    v_cvt_pk_bf16_f32 v121, v122, v123
    v_mfma_f32_16x16x32_bf16 v[44:47], a[120:123], v[212:215], v[44:47]
    v_cvt_pk_bf16_f32 v122, v124, v125
    v_cvt_pk_bf16_f32 v123, v126, v127
    v_mfma_f32_16x16x32_bf16 v[48:51], a[124:127], v[212:215], v[48:51]
    v_accvgpr_write_b32 a152, v120
    v_accvgpr_write_b32 a153, v121
    v_mfma_f32_16x16x32_bf16 v[52:55], a[128:131], v[212:215], v[52:55]
    v_accvgpr_write_b32 a154, v122
    v_accvgpr_write_b32 a155, v123
    v_mfma_f32_16x16x32_bf16 v[136:139], a[132:135], v[212:215], v[136:139]
    v_cvt_pk_bf16_f32 v176, v176, v177
    v_cvt_pk_bf16_f32 v177, v178, v179
    v_mfma_f32_16x16x32_bf16 v[140:143], a[136:139], v[212:215], v[140:143]
    v_cvt_pk_bf16_f32 v178, v180, v181
    v_cvt_pk_bf16_f32 v179, v182, v183
    v_mfma_f32_16x16x32_bf16 a[16:19], a[140:143], v[212:215], a[16:19]
    v_accvgpr_write_b32 a156, v176
    v_accvgpr_write_b32 a157, v177
    v_mfma_f32_16x16x32_bf16 a[20:23], a[56:59], v[212:215], a[20:23]
    v_accvgpr_write_b32 a158, v178
    v_accvgpr_write_b32 a159, v179
    v_accvgpr_read_b32 v184, a8
    s_waitcnt vmcnt(8)
    buffer_load_dwordx4 v6, s[8:11], s56 offen offset:1024 nt lds
    v_accvgpr_read_b32 v185, a9
    v_accvgpr_read_b32 v186, a10
    v_accvgpr_read_b32 v187, a11
    v_accvgpr_read_b32 v188, a12
    v_accvgpr_read_b32 v189, a13
    v_accvgpr_read_b32 v190, a14
    v_accvgpr_read_b32 v191, a15
    v_pk_mul_f32 v[24:25], v[24:25], s[50:51]
    v_pk_mul_f32 v[26:27], v[26:27], s[50:51]
    v_pk_mul_f32 v[28:29], v[28:29], s[50:51]
    v_pk_mul_f32 v[30:31], v[30:31], s[50:51]
    s_waitcnt vmcnt(8)
    buffer_load_dwordx4 v5, s[8:11], s56 offen offset:2048 nt lds
    v_pk_mul_f32 v[32:33], v[32:33], s[50:51]
    v_pk_mul_f32 v[34:35], v[34:35], s[50:51]
    v_pk_mul_f32 v[36:37], v[36:37], s[50:51]
    v_pk_mul_f32 v[38:39], v[38:39], s[50:51]
    v_pk_mul_f32 v[128:129], v[128:129], s[50:51]
    v_pk_mul_f32 v[130:131], v[130:131], s[50:51]
    v_pk_mul_f32 v[132:133], v[132:133], s[50:51]
    v_pk_mul_f32 v[134:135], v[134:135], s[50:51]
    v_pk_mul_f32 v[184:185], v[184:185], s[50:51]
    v_pk_mul_f32 v[186:187], v[186:187], s[50:51]
    v_pk_mul_f32 v[188:189], v[188:189], s[50:51]
    s_waitcnt vmcnt(8)
    buffer_load_dwordx4 v6, s[8:11], s56 offen offset:3072 nt lds
    v_pk_mul_f32 v[190:191], v[190:191], s[50:51]
    v_mfma_f32_16x16x32_bf16 v[104:107], a[84:87], v[200:203], v[104:107]
    v_cvt_pk_bf16_f32 v24, v24, v25
    v_cvt_pk_bf16_f32 v25, v26, v27
    v_mfma_f32_16x16x32_bf16 v[108:111], a[88:91], v[200:203], v[108:111]
    v_cvt_pk_bf16_f32 v26, v28, v29
    v_cvt_pk_bf16_f32 v27, v30, v31
    v_mfma_f32_16x16x32_bf16 v[112:115], a[92:95], v[200:203], v[112:115]
    v_accvgpr_write_b32 a160, v24
    v_accvgpr_write_b32 a161, v25
    v_mfma_f32_16x16x32_bf16 v[116:119], a[96:99], v[200:203], v[116:119]
    v_accvgpr_write_b32 a162, v26
    v_accvgpr_write_b32 a163, v27
    v_mfma_f32_16x16x32_bf16 v[168:171], a[100:103], v[200:203], v[168:171]
    v_cvt_pk_bf16_f32 v32, v32, v33
    v_cvt_pk_bf16_f32 v33, v34, v35
    v_mfma_f32_16x16x32_bf16 v[172:175], a[104:107], v[200:203], v[172:175]
    v_cvt_pk_bf16_f32 v34, v36, v37
    v_cvt_pk_bf16_f32 v35, v38, v39
    v_mfma_f32_16x16x32_bf16 a[48:51], a[108:111], v[200:203], a[48:51]
    v_accvgpr_write_b32 a164, v32
    v_accvgpr_write_b32 a165, v33
    v_mfma_f32_16x16x32_bf16 a[52:55], a[112:115], v[200:203], a[52:55]
    v_accvgpr_write_b32 a166, v34
    v_accvgpr_write_b32 a167, v35
    v_mfma_f32_16x16x32_bf16 v[56:59], a[116:119], v[216:219], v[56:59]
    v_cvt_pk_bf16_f32 v128, v128, v129
    v_cvt_pk_bf16_f32 v129, v130, v131
    v_mfma_f32_16x16x32_bf16 v[60:63], a[120:123], v[216:219], v[60:63]
    v_cvt_pk_bf16_f32 v130, v132, v133
    v_cvt_pk_bf16_f32 v131, v134, v135
    v_mfma_f32_16x16x32_bf16 v[64:67], a[124:127], v[216:219], v[64:67]
    v_accvgpr_write_b32 a168, v128
    v_accvgpr_write_b32 a169, v129
    s_barrier
    s_add_u32 m0, s48, 8192
    s_xor_b32 s56, s47, 0
    s_waitcnt vmcnt(8)
    buffer_load_dwordx4 v5, s[12:15], s56 offen offset:0 nt lds
    s_load_dword s54, s[36:37], s55
    v_mfma_f32_16x16x32_bf16 v[68:71], a[128:131], v[216:219], v[68:71]
    v_accvgpr_write_b32 a170, v130
    v_accvgpr_write_b32 a171, v131
    v_mfma_f32_16x16x32_bf16 v[144:147], a[132:135], v[216:219], v[144:147]
    v_cvt_pk_bf16_f32 v184, v184, v185
    v_cvt_pk_bf16_f32 v185, v186, v187
    v_mfma_f32_16x16x32_bf16 v[148:151], a[136:139], v[216:219], v[148:151]
    v_cvt_pk_bf16_f32 v186, v188, v189
    v_cvt_pk_bf16_f32 v187, v190, v191
    v_mfma_f32_16x16x32_bf16 a[24:27], a[140:143], v[216:219], a[24:27]
    v_accvgpr_write_b32 a172, v184
    v_accvgpr_write_b32 a173, v185
    v_mfma_f32_16x16x32_bf16 a[28:31], a[56:59], v[216:219], a[28:31]
    v_accvgpr_write_b32 a174, v186
    v_accvgpr_write_b32 a175, v187
    v_mfma_f32_32x32x16_bf16 v[8:23], v[232:235], v[232:235], 0
    v_accvgpr_read_b32 v176, a16
    v_accvgpr_read_b32 v177, a17
    v_accvgpr_read_b32 v178, a18
    v_accvgpr_read_b32 v179, a19
    v_accvgpr_read_b32 v180, a20
    v_accvgpr_read_b32 v181, a21
    s_waitcnt vmcnt(8)
    buffer_load_dwordx4 v6, s[12:15], s56 offen offset:1024 nt lds
    v_accvgpr_read_b32 v182, a22
    v_accvgpr_read_b32 v183, a23
    v_pk_mul_f32 v[40:41], v[40:41], s[50:51]
    v_pk_mul_f32 v[42:43], v[42:43], s[50:51]
    v_pk_mul_f32 v[44:45], v[44:45], s[50:51]
    v_pk_mul_f32 v[46:47], v[46:47], s[50:51]
    v_pk_mul_f32 v[48:49], v[48:49], s[50:51]
    v_pk_mul_f32 v[50:51], v[50:51], s[50:51]
    v_pk_mul_f32 v[52:53], v[52:53], s[50:51]
    v_pk_mul_f32 v[54:55], v[54:55], s[50:51]
    v_pk_mul_f32 v[136:137], v[136:137], s[50:51]
    v_pk_mul_f32 v[138:139], v[138:139], s[50:51]
    v_pk_mul_f32 v[140:141], v[140:141], s[50:51]
    v_pk_mul_f32 v[142:143], v[142:143], s[50:51]
    s_waitcnt vmcnt(8)
    buffer_load_dwordx4 v5, s[12:15], s56 offen offset:2048 nt lds
    v_pk_mul_f32 v[176:177], v[176:177], s[50:51]
    v_pk_mul_f32 v[178:179], v[178:179], s[50:51]
    v_pk_mul_f32 v[180:181], v[180:181], s[50:51]
    v_pk_mul_f32 v[182:183], v[182:183], s[50:51]
    v_mfma_f32_16x16x32_bf16 v[72:75], a[116:119], v[220:223], v[72:75]
    v_cvt_pk_bf16_f32 v40, v40, v41
    v_cvt_pk_bf16_f32 v41, v42, v43
    v_mfma_f32_16x16x32_bf16 v[76:79], a[120:123], v[220:223], v[76:79]
    v_cvt_pk_bf16_f32 v42, v44, v45
    v_cvt_pk_bf16_f32 v43, v46, v47
    v_mfma_f32_16x16x32_bf16 v[80:83], a[124:127], v[220:223], v[80:83]
    v_accvgpr_write_b32 a176, v40
    v_accvgpr_write_b32 a177, v41
    v_mfma_f32_16x16x32_bf16 v[84:87], a[128:131], v[220:223], v[84:87]
    v_accvgpr_write_b32 a178, v42
    v_accvgpr_write_b32 a179, v43
    v_mfma_f32_16x16x32_bf16 v[152:155], a[132:135], v[220:223], v[152:155]
    v_cvt_pk_bf16_f32 v48, v48, v49
    v_cvt_pk_bf16_f32 v49, v50, v51
    v_mfma_f32_16x16x32_bf16 v[156:159], a[136:139], v[220:223], v[156:159]
    v_cvt_pk_bf16_f32 v50, v52, v53
    v_cvt_pk_bf16_f32 v51, v54, v55
    v_mfma_f32_16x16x32_bf16 a[32:35], a[140:143], v[220:223], a[32:35]
    v_accvgpr_write_b32 a180, v48
    v_accvgpr_write_b32 a181, v49
    v_mfma_f32_16x16x32_bf16 a[36:39], a[56:59], v[220:223], a[36:39]
    v_accvgpr_write_b32 a182, v50
    v_accvgpr_write_b32 a183, v51
    v_mfma_f32_32x32x16_bf16 v[24:39], v[232:235], v[232:235], 0
    v_cvt_pk_bf16_f32 v136, v136, v137
    v_cvt_pk_bf16_f32 v137, v138, v139
    v_cvt_pk_bf16_f32 v138, v140, v141
    v_cvt_pk_bf16_f32 v139, v142, v143
    v_accvgpr_write_b32 a184, v136
    v_accvgpr_write_b32 a185, v137
    v_mfma_f32_32x32x16_bf16 v[120:135], v[232:235], v[232:235], 0
    v_accvgpr_write_b32 a186, v138
    v_accvgpr_write_b32 a187, v139
    v_cvt_pk_bf16_f32 v176, v176, v177
    v_cvt_pk_bf16_f32 v177, v178, v179
    v_cvt_pk_bf16_f32 v178, v180, v181
    v_cvt_pk_bf16_f32 v179, v182, v183
    s_waitcnt vmcnt(8)
    buffer_load_dwordx4 v6, s[12:15], s56 offen offset:3072 nt lds
    v_mfma_f32_32x32x16_bf16 a[0:15], v[232:235], v[232:235], 0
    v_accvgpr_write_b32 a188, v176
    v_accvgpr_write_b32 a189, v177
    v_accvgpr_write_b32 a190, v178
    v_accvgpr_write_b32 a191, v179
    v_accvgpr_read_b32 v184, a24
    v_accvgpr_read_b32 v185, a25
    v_accvgpr_read_b32 v186, a26
    v_accvgpr_read_b32 v187, a27
    v_accvgpr_read_b32 v188, a28
    v_accvgpr_read_b32 v189, a29
    v_accvgpr_read_b32 v190, a30
    v_accvgpr_read_b32 v191, a31
    v_pk_mul_f32 v[56:57], v[56:57], s[50:51]
    v_pk_mul_f32 v[58:59], v[58:59], s[50:51]
    v_pk_mul_f32 v[60:61], v[60:61], s[50:51]
    v_pk_mul_f32 v[62:63], v[62:63], s[50:51]
    v_pk_mul_f32 v[64:65], v[64:65], s[50:51]
    s_add_u32 m0, s49, 8192
    s_xor_b32 s56, s56, 0x1000
    s_waitcnt vmcnt(8)
    buffer_load_dwordx4 v5, s[12:15], s56 offen offset:0 nt lds
    v_pk_mul_f32 v[66:67], v[66:67], s[50:51]
    v_pk_mul_f32 v[68:69], v[68:69], s[50:51]
    v_pk_mul_f32 v[70:71], v[70:71], s[50:51]
    v_pk_mul_f32 v[144:145], v[144:145], s[50:51]
    v_pk_mul_f32 v[146:147], v[146:147], s[50:51]
    v_pk_mul_f32 v[148:149], v[148:149], s[50:51]
    v_pk_mul_f32 v[150:151], v[150:151], s[50:51]
    v_pk_mul_f32 v[184:185], v[184:185], s[50:51]
    v_pk_mul_f32 v[186:187], v[186:187], s[50:51]
    v_pk_mul_f32 v[188:189], v[188:189], s[50:51]
    v_pk_mul_f32 v[190:191], v[190:191], s[50:51]
    v_mfma_f32_16x16x32_bf16 v[88:91], a[116:119], v[224:227], v[88:91]
    v_cvt_pk_bf16_f32 v56, v56, v57
    v_cvt_pk_bf16_f32 v57, v58, v59
    v_mfma_f32_16x16x32_bf16 v[92:95], a[120:123], v[224:227], v[92:95]
    v_cvt_pk_bf16_f32 v58, v60, v61
    v_cvt_pk_bf16_f32 v59, v62, v63
    s_waitcnt vmcnt(8)
    buffer_load_dwordx4 v6, s[12:15], s56 offen offset:1024 nt lds
    v_mfma_f32_16x16x32_bf16 v[96:99], a[124:127], v[224:227], v[96:99]
    v_accvgpr_write_b32 a192, v56
    v_accvgpr_write_b32 a193, v57
    v_mfma_f32_16x16x32_bf16 v[100:103], a[128:131], v[224:227], v[100:103]
    v_accvgpr_write_b32 a194, v58
    v_accvgpr_write_b32 a195, v59
    v_mfma_f32_16x16x32_bf16 v[160:163], a[132:135], v[224:227], v[160:163]
    v_cvt_pk_bf16_f32 v64, v64, v65
    v_cvt_pk_bf16_f32 v65, v66, v67
    v_mfma_f32_16x16x32_bf16 v[164:167], a[136:139], v[224:227], v[164:167]
    v_cvt_pk_bf16_f32 v66, v68, v69
    v_cvt_pk_bf16_f32 v67, v70, v71
    v_mfma_f32_16x16x32_bf16 a[40:43], a[140:143], v[224:227], a[40:43]
    v_accvgpr_write_b32 a196, v64
    v_accvgpr_write_b32 a197, v65
    v_mfma_f32_16x16x32_bf16 a[44:47], a[56:59], v[224:227], a[44:47]
    v_accvgpr_write_b32 a198, v66
    v_accvgpr_write_b32 a199, v67
    v_mfma_f32_32x32x16_bf16 v[40:55], v[232:235], v[232:235], 0
    v_cvt_pk_bf16_f32 v144, v144, v145
    v_cvt_pk_bf16_f32 v145, v146, v147
    v_cvt_pk_bf16_f32 v146, v148, v149
    v_cvt_pk_bf16_f32 v147, v150, v151
    v_accvgpr_write_b32 a200, v144
    v_accvgpr_write_b32 a201, v145
    v_accvgpr_write_b32 a202, v146
    v_accvgpr_write_b32 a203, v147
    v_cvt_pk_bf16_f32 v184, v184, v185
    v_cvt_pk_bf16_f32 v185, v186, v187
    v_cvt_pk_bf16_f32 v186, v188, v189
    v_cvt_pk_bf16_f32 v187, v190, v191
    v_accvgpr_write_b32 a204, v184
    s_waitcnt vmcnt(8)
    buffer_load_dwordx4 v5, s[12:15], s56 offen offset:2048 nt lds
    v_accvgpr_write_b32 a205, v185
    v_accvgpr_write_b32 a206, v186
    v_accvgpr_write_b32 a207, v187
    v_accvgpr_read_b32 v176, a32
    v_accvgpr_read_b32 v177, a33
    v_accvgpr_read_b32 v178, a34
    v_accvgpr_read_b32 v179, a35
    v_accvgpr_read_b32 v180, a36
    v_accvgpr_read_b32 v181, a37
    v_accvgpr_read_b32 v182, a38
    v_accvgpr_read_b32 v183, a39
    v_pk_mul_f32 v[72:73], v[72:73], s[50:51]
    v_pk_mul_f32 v[74:75], v[74:75], s[50:51]
    v_pk_mul_f32 v[76:77], v[76:77], s[50:51]
    s_waitcnt vmcnt(8)
    buffer_load_dwordx4 v6, s[12:15], s56 offen offset:3072 nt lds
    v_pk_mul_f32 v[78:79], v[78:79], s[50:51]
    v_pk_mul_f32 v[80:81], v[80:81], s[50:51]
    v_pk_mul_f32 v[82:83], v[82:83], s[50:51]
    v_pk_mul_f32 v[84:85], v[84:85], s[50:51]
    v_pk_mul_f32 v[86:87], v[86:87], s[50:51]
    v_pk_mul_f32 v[152:153], v[152:153], s[50:51]
    v_pk_mul_f32 v[154:155], v[154:155], s[50:51]
    v_pk_mul_f32 v[156:157], v[156:157], s[50:51]
    v_pk_mul_f32 v[158:159], v[158:159], s[50:51]
    v_pk_mul_f32 v[176:177], v[176:177], s[50:51]
    v_pk_mul_f32 v[178:179], v[178:179], s[50:51]
    v_pk_mul_f32 v[180:181], v[180:181], s[50:51]
    v_pk_mul_f32 v[182:183], v[182:183], s[50:51]
    v_mfma_f32_16x16x32_bf16 v[104:107], a[116:119], v[228:231], v[104:107]
    v_cvt_pk_bf16_f32 v72, v72, v73
    v_cvt_pk_bf16_f32 v73, v74, v75
    s_barrier
    s_add_u32 m0, s48, 16384
    s_xor_b32 s56, s47, 8192
    s_waitcnt vmcnt(8)
    buffer_load_dwordx4 v5, s[8:11], s56 offen offset:0 nt lds
    v_mfma_f32_16x16x32_bf16 v[108:111], a[120:123], v[228:231], v[108:111]
    v_cvt_pk_bf16_f32 v74, v76, v77
    v_cvt_pk_bf16_f32 v75, v78, v79
    v_mfma_f32_16x16x32_bf16 v[112:115], a[124:127], v[228:231], v[112:115]
    v_accvgpr_write_b32 a208, v72
    v_accvgpr_write_b32 a209, v73
    v_mfma_f32_16x16x32_bf16 v[116:119], a[128:131], v[228:231], v[116:119]
    v_accvgpr_write_b32 a210, v74
    v_accvgpr_write_b32 a211, v75
    v_mfma_f32_16x16x32_bf16 v[168:171], a[132:135], v[228:231], v[168:171]
    v_cvt_pk_bf16_f32 v80, v80, v81
    v_cvt_pk_bf16_f32 v81, v82, v83
    v_mfma_f32_16x16x32_bf16 v[172:175], a[136:139], v[228:231], v[172:175]
    v_cvt_pk_bf16_f32 v82, v84, v85
    v_cvt_pk_bf16_f32 v83, v86, v87
    v_mfma_f32_16x16x32_bf16 a[48:51], a[140:143], v[228:231], a[48:51]
    v_accvgpr_write_b32 a212, v80
    v_accvgpr_write_b32 a213, v81
    v_mfma_f32_16x16x32_bf16 a[52:55], a[56:59], v[228:231], a[52:55]
    v_accvgpr_write_b32 a214, v82
    v_accvgpr_write_b32 a215, v83
    v_mfma_f32_32x32x16_bf16 v[56:71], v[232:235], v[232:235], 0
    v_cvt_pk_bf16_f32 v152, v152, v153
    v_cvt_pk_bf16_f32 v153, v154, v155
    v_cvt_pk_bf16_f32 v154, v156, v157
    v_cvt_pk_bf16_f32 v155, v158, v159
    v_accvgpr_write_b32 a216, v152
    v_accvgpr_write_b32 a217, v153
    v_mfma_f32_32x32x16_bf16 v[136:151], v[232:235], v[232:235], 0
    v_accvgpr_write_b32 a218, v154
    v_accvgpr_write_b32 a219, v155
    v_cvt_pk_bf16_f32 v176, v176, v177
    v_cvt_pk_bf16_f32 v177, v178, v179
    v_cvt_pk_bf16_f32 v178, v180, v181
    v_cvt_pk_bf16_f32 v179, v182, v183
    v_mfma_f32_32x32x16_bf16 a[16:31], v[232:235], v[232:235], 0
    v_accvgpr_write_b32 a220, v176
    v_accvgpr_write_b32 a221, v177
    v_accvgpr_write_b32 a222, v178
    v_accvgpr_write_b32 a223, v179
    v_accvgpr_read_b32 v184, a40
    v_accvgpr_read_b32 v185, a41
    v_accvgpr_read_b32 v186, a42
    s_waitcnt vmcnt(8)
    buffer_load_dwordx4 v6, s[8:11], s56 offen offset:1024 nt lds
    v_accvgpr_read_b32 v187, a43
    v_accvgpr_read_b32 v188, a44
    v_accvgpr_read_b32 v189, a45
    v_accvgpr_read_b32 v190, a46
    v_accvgpr_read_b32 v191, a47
    v_pk_mul_f32 v[88:89], v[88:89], s[50:51]
    v_pk_mul_f32 v[90:91], v[90:91], s[50:51]
    v_pk_mul_f32 v[92:93], v[92:93], s[50:51]
    v_pk_mul_f32 v[94:95], v[94:95], s[50:51]
    v_pk_mul_f32 v[96:97], v[96:97], s[50:51]
    v_pk_mul_f32 v[98:99], v[98:99], s[50:51]
    v_pk_mul_f32 v[100:101], v[100:101], s[50:51]
    v_pk_mul_f32 v[102:103], v[102:103], s[50:51]
    v_pk_mul_f32 v[160:161], v[160:161], s[50:51]
    s_waitcnt vmcnt(8)
    buffer_load_dwordx4 v5, s[8:11], s56 offen offset:2048 nt lds
    v_pk_mul_f32 v[162:163], v[162:163], s[50:51]
    v_pk_mul_f32 v[164:165], v[164:165], s[50:51]
    v_pk_mul_f32 v[166:167], v[166:167], s[50:51]
    v_pk_mul_f32 v[184:185], v[184:185], s[50:51]
    v_pk_mul_f32 v[186:187], v[186:187], s[50:51]
    v_pk_mul_f32 v[188:189], v[188:189], s[50:51]
    v_pk_mul_f32 v[190:191], v[190:191], s[50:51]
    v_mfma_f32_32x32x16_bf16 v[72:87], v[232:235], v[232:235], 0
    v_cvt_pk_bf16_f32 v88, v88, v89
    v_cvt_pk_bf16_f32 v89, v90, v91
    v_cvt_pk_bf16_f32 v90, v92, v93
    v_cvt_pk_bf16_f32 v91, v94, v95
    v_accvgpr_write_b32 a224, v88
    v_accvgpr_write_b32 a225, v89
    v_accvgpr_write_b32 a226, v90
    v_accvgpr_write_b32 a227, v91
    v_cvt_pk_bf16_f32 v96, v96, v97
    v_cvt_pk_bf16_f32 v97, v98, v99
    v_cvt_pk_bf16_f32 v98, v100, v101
    v_cvt_pk_bf16_f32 v99, v102, v103
    s_waitcnt vmcnt(8)
    buffer_load_dwordx4 v6, s[8:11], s56 offen offset:3072 nt lds
    v_accvgpr_write_b32 a228, v96
    v_accvgpr_write_b32 a229, v97
    v_accvgpr_write_b32 a230, v98
    v_accvgpr_write_b32 a231, v99
    v_cvt_pk_bf16_f32 v160, v160, v161
    v_cvt_pk_bf16_f32 v161, v162, v163
    v_cvt_pk_bf16_f32 v162, v164, v165
    v_cvt_pk_bf16_f32 v163, v166, v167
    v_accvgpr_write_b32 a232, v160
    v_accvgpr_write_b32 a233, v161
    v_accvgpr_write_b32 a234, v162
    v_accvgpr_write_b32 a235, v163
    v_cvt_pk_bf16_f32 v184, v184, v185
    v_cvt_pk_bf16_f32 v185, v186, v187
    s_add_u32 m0, s49, 16384
    s_xor_b32 s56, s56, 0x1000
    s_waitcnt vmcnt(8)
    buffer_load_dwordx4 v5, s[8:11], s56 offen offset:0 nt lds
    v_cvt_pk_bf16_f32 v186, v188, v189
    v_cvt_pk_bf16_f32 v187, v190, v191
    v_accvgpr_write_b32 a236, v184
    v_accvgpr_write_b32 a237, v185
    v_accvgpr_write_b32 a238, v186
    v_accvgpr_write_b32 a239, v187
    v_accvgpr_read_b32 v176, a48
    v_accvgpr_read_b32 v177, a49
    v_accvgpr_read_b32 v178, a50
    v_accvgpr_read_b32 v179, a51
    v_accvgpr_read_b32 v180, a52
    v_accvgpr_read_b32 v181, a53
    v_accvgpr_read_b32 v182, a54
    s_waitcnt vmcnt(8)
    buffer_load_dwordx4 v6, s[8:11], s56 offen offset:1024 nt lds
    v_accvgpr_read_b32 v183, a55
    v_pk_mul_f32 v[104:105], v[104:105], s[50:51]
    v_pk_mul_f32 v[106:107], v[106:107], s[50:51]
    v_pk_mul_f32 v[108:109], v[108:109], s[50:51]
    v_pk_mul_f32 v[110:111], v[110:111], s[50:51]
    v_pk_mul_f32 v[112:113], v[112:113], s[50:51]
    v_pk_mul_f32 v[114:115], v[114:115], s[50:51]
    v_pk_mul_f32 v[116:117], v[116:117], s[50:51]
    v_pk_mul_f32 v[118:119], v[118:119], s[50:51]
    v_pk_mul_f32 v[168:169], v[168:169], s[50:51]
    v_pk_mul_f32 v[170:171], v[170:171], s[50:51]
    v_pk_mul_f32 v[172:173], v[172:173], s[50:51]
    v_pk_mul_f32 v[174:175], v[174:175], s[50:51]
    v_pk_mul_f32 v[176:177], v[176:177], s[50:51]
    s_waitcnt vmcnt(8)
    buffer_load_dwordx4 v5, s[8:11], s56 offen offset:2048 nt lds
    v_pk_mul_f32 v[178:179], v[178:179], s[50:51]
    v_pk_mul_f32 v[180:181], v[180:181], s[50:51]
    v_pk_mul_f32 v[182:183], v[182:183], s[50:51]
    v_mfma_f32_32x32x16_bf16 v[88:103], v[232:235], v[232:235], 0
    v_cvt_pk_bf16_f32 v104, v104, v105
    v_cvt_pk_bf16_f32 v105, v106, v107
    v_cvt_pk_bf16_f32 v106, v108, v109
    v_cvt_pk_bf16_f32 v107, v110, v111
    v_accvgpr_write_b32 a240, v104
    v_accvgpr_write_b32 a241, v105
    v_mfma_f32_32x32x16_bf16 v[152:167], v[232:235], v[232:235], 0
    v_accvgpr_write_b32 a242, v106
    v_accvgpr_write_b32 a243, v107
    v_cvt_pk_bf16_f32 v112, v112, v113
    v_cvt_pk_bf16_f32 v113, v114, v115
    v_cvt_pk_bf16_f32 v114, v116, v117
    v_cvt_pk_bf16_f32 v115, v118, v119
    v_mfma_f32_32x32x16_bf16 a[32:47], v[232:235], v[232:235], 0
    v_accvgpr_write_b32 a244, v112
    v_accvgpr_write_b32 a245, v113
    v_accvgpr_write_b32 a246, v114
    v_accvgpr_write_b32 a247, v115
    v_cvt_pk_bf16_f32 v168, v168, v169
    v_cvt_pk_bf16_f32 v169, v170, v171
    v_cvt_pk_bf16_f32 v170, v172, v173
    v_cvt_pk_bf16_f32 v171, v174, v175
    v_accvgpr_write_b32 a248, v168
    v_accvgpr_write_b32 a249, v169
    v_accvgpr_write_b32 a250, v170
    v_accvgpr_write_b32 a251, v171
    v_cvt_pk_bf16_f32 v176, v176, v177
    v_cvt_pk_bf16_f32 v177, v178, v179
    s_waitcnt vmcnt(8)
    buffer_load_dwordx4 v6, s[8:11], s56 offen offset:3072 nt lds
    v_cvt_pk_bf16_f32 v178, v180, v181
    v_cvt_pk_bf16_f32 v179, v182, v183
    v_accvgpr_write_b32 a252, v176
    v_accvgpr_write_b32 a253, v177
    v_accvgpr_write_b32 a254, v178
    v_accvgpr_write_b32 a255, v179
    v_mfma_f32_32x32x16_bf16 v[104:119], v[232:235], v[232:235], 0
    v_mfma_f32_32x32x16_bf16 v[168:183], v[232:235], v[232:235], 0
    v_mfma_f32_32x32x16_bf16 a[48:63], v[232:235], v[232:235], 0
    v_mov_b32 v232, 0x3f803f80
    v_mov_b32 v233, 0x3f803f80
    v_mov_b32 v234, 0x3f803f80
    v_mov_b32 v235, 0x3f803f80
    s_waitcnt lgkmcnt(0)
    s_cmp_eq_u32 s54, 1
    s_cbranch_scc1 L_chk_ok
    s_mov_b32 s60, 0
    v_mov_b32 v255, 0
L_chk:
    buffer_load_dword v254, v255, s[36:39], s55 offen sc1
    s_waitcnt vmcnt(0)
    v_cmp_ne_u32 vcc, 1, v254
    s_cbranch_vccz L_chk_ok
    s_add_u32 s60, s60, 1
    s_cmp_gt_u32 s60, 0x40000
    s_cbranch_scc1 L_chk_ok
    s_sleep 8
    s_branch L_chk
L_chk_ok:
    s_barrier
    ds_read_b128 a[88:91], v236 offset:0
    ds_read_b128 a[92:95], v236 offset:4096
    ds_read_b128 a[96:99], v237 offset:0
    ds_read_b128 a[100:103], v237 offset:4096
    ds_read_b128 a[104:107], v238 offset:0
    ds_read_b128 a[108:111], v238 offset:4096
    ds_read_b128 a[112:115], v239 offset:0
    ds_read_b128 a[84:87], v239 offset:4096
    s_mov_b32 s59, 0
    s_branch L_att
L_y2:
    s_mul_i32 s52, s41, 28672
    s_xor_b32 s53, s42, 1
    s_lshl_b32 s53, s53, 16
    s_add_u32 s52, s52, s53
    v_add_u32 v207, s52, v4
    v_lshrrev_b32 v198, 1, v4
    s_mul_i32 s52, s41, 28672
    s_add_u32 s52, s52, 65536
    v_add_u32 v208, s52, v4
    v_add_u32 v209, s52, v198
    .p2align 3
    v_accvgpr_read_b32 v176, a0
    v_accvgpr_read_b32 v177, a1
    v_accvgpr_read_b32 v178, a2
    v_accvgpr_read_b32 v179, a3
    v_accvgpr_read_b32 v180, a4
    v_accvgpr_read_b32 v181, a5
    v_accvgpr_read_b32 v182, a6
    v_accvgpr_read_b32 v183, a7
    v_pk_mul_f32 v[8:9], v[8:9], v[224:225] op_sel:[0,0] op_sel_hi:[1,0]
    v_pk_mul_f32 v[10:11], v[10:11], v[224:225] op_sel:[0,0] op_sel_hi:[1,0]
    v_pk_mul_f32 v[12:13], v[12:13], v[224:225] op_sel:[0,0] op_sel_hi:[1,0]
    v_pk_mul_f32 v[14:15], v[14:15], v[224:225] op_sel:[0,0] op_sel_hi:[1,0]
    v_cvt_pk_bf16_f32 v8, v8, v9
    v_cvt_pk_bf16_f32 v9, v10, v11
    v_cvt_pk_bf16_f32 v10, v12, v13
    v_cvt_pk_bf16_f32 v11, v14, v15
    ds_write_b128 v207, v[8:11] offset:0
    v_pk_mul_f32 v[16:17], v[16:17], v[224:225] op_sel:[0,0] op_sel_hi:[1,0]
    v_pk_mul_f32 v[18:19], v[18:19], v[224:225] op_sel:[0,0] op_sel_hi:[1,0]
    v_pk_mul_f32 v[20:21], v[20:21], v[224:225] op_sel:[0,0] op_sel_hi:[1,0]
    v_pk_mul_f32 v[22:23], v[22:23], v[224:225] op_sel:[0,0] op_sel_hi:[1,0]
    v_cvt_pk_bf16_f32 v16, v16, v17
    v_cvt_pk_bf16_f32 v17, v18, v19
    v_cvt_pk_bf16_f32 v18, v20, v21
    v_cvt_pk_bf16_f32 v19, v22, v23
    ds_write_b128 v207, v[16:19] offset:7168
    v_pk_mul_f32 v[120:121], v[120:121], v[224:225] op_sel:[0,0] op_sel_hi:[1,0]
    v_pk_mul_f32 v[122:123], v[122:123], v[224:225] op_sel:[0,0] op_sel_hi:[1,0]
    v_pk_mul_f32 v[124:125], v[124:125], v[224:225] op_sel:[0,0] op_sel_hi:[1,0]
    v_pk_mul_f32 v[126:127], v[126:127], v[224:225] op_sel:[0,0] op_sel_hi:[1,0]
    v_cvt_pk_bf16_f32 v120, v120, v121
    v_cvt_pk_bf16_f32 v121, v122, v123
    v_cvt_pk_bf16_f32 v122, v124, v125
    v_cvt_pk_bf16_f32 v123, v126, v127
    ds_write_b128 v207, v[120:123] offset:14336
    v_pk_mul_f32 v[176:177], v[176:177], v[224:225] op_sel:[0,0] op_sel_hi:[1,0]
    v_pk_mul_f32 v[178:179], v[178:179], v[224:225] op_sel:[0,0] op_sel_hi:[1,0]
    v_pk_mul_f32 v[180:181], v[180:181], v[224:225] op_sel:[0,0] op_sel_hi:[1,0]
    v_pk_mul_f32 v[182:183], v[182:183], v[224:225] op_sel:[0,0] op_sel_hi:[1,0]
    v_cvt_pk_bf16_f32 v176, v176, v177
    v_cvt_pk_bf16_f32 v177, v178, v179
    v_cvt_pk_bf16_f32 v178, v180, v181
    v_cvt_pk_bf16_f32 v179, v182, v183
    ds_write_b128 v207, v[176:179] offset:21504
    ds_read_b128 v[8:11], v208 offset:0
    ds_read_b128 v[12:15], v208 offset:1024
    ds_read_b128 v[16:19], v208 offset:2048
    ds_read_b64 v[20:21], v209 offset:3072
    .p2align 3
    v_accvgpr_read_b32 v184, a8
    v_accvgpr_read_b32 v185, a9
    v_accvgpr_read_b32 v186, a10
    v_accvgpr_read_b32 v187, a11
    v_accvgpr_read_b32 v188, a12
    v_accvgpr_read_b32 v189, a13
    v_accvgpr_read_b32 v190, a14
    v_accvgpr_read_b32 v191, a15
    v_pk_mul_f32 v[24:25], v[24:25], v[224:225] op_sel:[0,1] op_sel_hi:[1,1]
    v_pk_mul_f32 v[26:27], v[26:27], v[224:225] op_sel:[0,1] op_sel_hi:[1,1]
    v_pk_mul_f32 v[28:29], v[28:29], v[224:225] op_sel:[0,1] op_sel_hi:[1,1]
    v_pk_mul_f32 v[30:31], v[30:31], v[224:225] op_sel:[0,1] op_sel_hi:[1,1]
    v_cvt_pk_bf16_f32 v24, v24, v25
    v_cvt_pk_bf16_f32 v25, v26, v27
    v_cvt_pk_bf16_f32 v26, v28, v29
    v_cvt_pk_bf16_f32 v27, v30, v31
    ds_write_b128 v207, v[24:27] offset:1024
    v_pk_mul_f32 v[32:33], v[32:33], v[224:225] op_sel:[0,1] op_sel_hi:[1,1]
    v_pk_mul_f32 v[34:35], v[34:35], v[224:225] op_sel:[0,1] op_sel_hi:[1,1]
    v_pk_mul_f32 v[36:37], v[36:37], v[224:225] op_sel:[0,1] op_sel_hi:[1,1]
    v_pk_mul_f32 v[38:39], v[38:39], v[224:225] op_sel:[0,1] op_sel_hi:[1,1]
    v_cvt_pk_bf16_f32 v32, v32, v33
    v_cvt_pk_bf16_f32 v33, v34, v35
    v_cvt_pk_bf16_f32 v34, v36, v37
    v_cvt_pk_bf16_f32 v35, v38, v39
    ds_write_b128 v207, v[32:35] offset:8192
    v_pk_mul_f32 v[128:129], v[128:129], v[224:225] op_sel:[0,1] op_sel_hi:[1,1]
    v_pk_mul_f32 v[130:131], v[130:131], v[224:225] op_sel:[0,1] op_sel_hi:[1,1]
    v_pk_mul_f32 v[132:133], v[132:133], v[224:225] op_sel:[0,1] op_sel_hi:[1,1]
    v_pk_mul_f32 v[134:135], v[134:135], v[224:225] op_sel:[0,1] op_sel_hi:[1,1]
    v_cvt_pk_bf16_f32 v128, v128, v129
    v_cvt_pk_bf16_f32 v129, v130, v131
    v_cvt_pk_bf16_f32 v130, v132, v133
    v_cvt_pk_bf16_f32 v131, v134, v135
    ds_write_b128 v207, v[128:131] offset:15360
    v_pk_mul_f32 v[184:185], v[184:185], v[224:225] op_sel:[0,1] op_sel_hi:[1,1]
    v_pk_mul_f32 v[186:187], v[186:187], v[224:225] op_sel:[0,1] op_sel_hi:[1,1]
    v_pk_mul_f32 v[188:189], v[188:189], v[224:225] op_sel:[0,1] op_sel_hi:[1,1]
    v_pk_mul_f32 v[190:191], v[190:191], v[224:225] op_sel:[0,1] op_sel_hi:[1,1]
    v_cvt_pk_bf16_f32 v184, v184, v185
    v_cvt_pk_bf16_f32 v185, v186, v187
    v_cvt_pk_bf16_f32 v186, v188, v189
    v_cvt_pk_bf16_f32 v187, v190, v191
    ds_write_b128 v207, v[184:187] offset:22528
    ds_read_b128 v[22:25], v208 offset:3584
    ds_read_b128 v[26:29], v208 offset:4608
    ds_read_b128 v[30:33], v208 offset:5632
    s_waitcnt lgkmcnt(14)
    ds_read_b64 v[34:35], v209 offset:6656
    s_waitcnt lgkmcnt(12)
    .p2align 3
    v_accvgpr_read_b32 v176, a16
    v_accvgpr_read_b32 v177, a17
    v_accvgpr_read_b32 v178, a18
    v_accvgpr_read_b32 v179, a19
    v_accvgpr_read_b32 v180, a20
    v_accvgpr_read_b32 v181, a21
    v_accvgpr_read_b32 v182, a22
    v_accvgpr_read_b32 v183, a23
    v_pk_mul_f32 v[40:41], v[40:41], v[226:227] op_sel:[0,0] op_sel_hi:[1,0]
    v_pk_mul_f32 v[42:43], v[42:43], v[226:227] op_sel:[0,0] op_sel_hi:[1,0]
    v_pk_mul_f32 v[44:45], v[44:45], v[226:227] op_sel:[0,0] op_sel_hi:[1,0]
    v_pk_mul_f32 v[46:47], v[46:47], v[226:227] op_sel:[0,0] op_sel_hi:[1,0]
    v_cvt_pk_bf16_f32 v40, v40, v41
    v_cvt_pk_bf16_f32 v41, v42, v43
    v_cvt_pk_bf16_f32 v42, v44, v45
    v_cvt_pk_bf16_f32 v43, v46, v47
    ds_write_b128 v207, v[40:43] offset:2048
    v_pk_mul_f32 v[48:49], v[48:49], v[226:227] op_sel:[0,0] op_sel_hi:[1,0]
    v_pk_mul_f32 v[50:51], v[50:51], v[226:227] op_sel:[0,0] op_sel_hi:[1,0]
    v_pk_mul_f32 v[52:53], v[52:53], v[226:227] op_sel:[0,0] op_sel_hi:[1,0]
    v_pk_mul_f32 v[54:55], v[54:55], v[226:227] op_sel:[0,0] op_sel_hi:[1,0]
    v_cvt_pk_bf16_f32 v48, v48, v49
    v_cvt_pk_bf16_f32 v49, v50, v51
    v_cvt_pk_bf16_f32 v50, v52, v53
    v_cvt_pk_bf16_f32 v51, v54, v55
    ds_write_b128 v207, v[48:51] offset:9216
    v_pk_mul_f32 v[136:137], v[136:137], v[226:227] op_sel:[0,0] op_sel_hi:[1,0]
    v_pk_mul_f32 v[138:139], v[138:139], v[226:227] op_sel:[0,0] op_sel_hi:[1,0]
    v_pk_mul_f32 v[140:141], v[140:141], v[226:227] op_sel:[0,0] op_sel_hi:[1,0]
    v_pk_mul_f32 v[142:143], v[142:143], v[226:227] op_sel:[0,0] op_sel_hi:[1,0]
    v_cvt_pk_bf16_f32 v136, v136, v137
    v_cvt_pk_bf16_f32 v137, v138, v139
    v_cvt_pk_bf16_f32 v138, v140, v141
    v_cvt_pk_bf16_f32 v139, v142, v143
    ds_write_b128 v207, v[136:139] offset:16384
    v_pk_mul_f32 v[176:177], v[176:177], v[226:227] op_sel:[0,0] op_sel_hi:[1,0]
    v_pk_mul_f32 v[178:179], v[178:179], v[226:227] op_sel:[0,0] op_sel_hi:[1,0]
    v_pk_mul_f32 v[180:181], v[180:181], v[226:227] op_sel:[0,0] op_sel_hi:[1,0]
    v_pk_mul_f32 v[182:183], v[182:183], v[226:227] op_sel:[0,0] op_sel_hi:[1,0]
    v_cvt_pk_bf16_f32 v176, v176, v177
    v_cvt_pk_bf16_f32 v177, v178, v179
    v_cvt_pk_bf16_f32 v178, v180, v181
    v_cvt_pk_bf16_f32 v179, v182, v183
    s_waitcnt lgkmcnt(14)
    ds_write_b128 v207, v[176:179] offset:23552
    s_waitcnt lgkmcnt(14)
    ds_read_b128 v[36:39], v208 offset:7168
    s_waitcnt lgkmcnt(14)
    ds_read_b128 v[40:43], v208 offset:8192
    s_waitcnt lgkmcnt(14)
    ds_read_b128 v[44:47], v208 offset:9216
    s_waitcnt lgkmcnt(14)
    ds_read_b64 v[48:49], v209 offset:10240
    s_waitcnt lgkmcnt(12)
    .p2align 3
    v_accvgpr_read_b32 v184, a24
    v_accvgpr_read_b32 v185, a25
    v_accvgpr_read_b32 v186, a26
    v_accvgpr_read_b32 v187, a27
    v_accvgpr_read_b32 v188, a28
    v_accvgpr_read_b32 v189, a29
    v_accvgpr_read_b32 v190, a30
    v_accvgpr_read_b32 v191, a31
    v_pk_mul_f32 v[56:57], v[56:57], v[226:227] op_sel:[0,1] op_sel_hi:[1,1]
    v_pk_mul_f32 v[58:59], v[58:59], v[226:227] op_sel:[0,1] op_sel_hi:[1,1]
    v_pk_mul_f32 v[60:61], v[60:61], v[226:227] op_sel:[0,1] op_sel_hi:[1,1]
    v_pk_mul_f32 v[62:63], v[62:63], v[226:227] op_sel:[0,1] op_sel_hi:[1,1]
    v_cvt_pk_bf16_f32 v56, v56, v57
    v_cvt_pk_bf16_f32 v57, v58, v59
    v_cvt_pk_bf16_f32 v58, v60, v61
    v_cvt_pk_bf16_f32 v59, v62, v63
    ds_write_b128 v207, v[56:59] offset:3072
    v_pk_mul_f32 v[64:65], v[64:65], v[226:227] op_sel:[0,1] op_sel_hi:[1,1]
    v_pk_mul_f32 v[66:67], v[66:67], v[226:227] op_sel:[0,1] op_sel_hi:[1,1]
    v_pk_mul_f32 v[68:69], v[68:69], v[226:227] op_sel:[0,1] op_sel_hi:[1,1]
    v_pk_mul_f32 v[70:71], v[70:71], v[226:227] op_sel:[0,1] op_sel_hi:[1,1]
    v_cvt_pk_bf16_f32 v64, v64, v65
    v_cvt_pk_bf16_f32 v65, v66, v67
    v_cvt_pk_bf16_f32 v66, v68, v69
    v_cvt_pk_bf16_f32 v67, v70, v71
    ds_write_b128 v207, v[64:67] offset:10240
    v_pk_mul_f32 v[144:145], v[144:145], v[226:227] op_sel:[0,1] op_sel_hi:[1,1]
    v_pk_mul_f32 v[146:147], v[146:147], v[226:227] op_sel:[0,1] op_sel_hi:[1,1]
    v_pk_mul_f32 v[148:149], v[148:149], v[226:227] op_sel:[0,1] op_sel_hi:[1,1]
    v_pk_mul_f32 v[150:151], v[150:151], v[226:227] op_sel:[0,1] op_sel_hi:[1,1]
    v_cvt_pk_bf16_f32 v144, v144, v145
    v_cvt_pk_bf16_f32 v145, v146, v147
    v_cvt_pk_bf16_f32 v146, v148, v149
    v_cvt_pk_bf16_f32 v147, v150, v151
    ds_write_b128 v207, v[144:147] offset:17408
    v_pk_mul_f32 v[184:185], v[184:185], v[226:227] op_sel:[0,1] op_sel_hi:[1,1]
    v_pk_mul_f32 v[186:187], v[186:187], v[226:227] op_sel:[0,1] op_sel_hi:[1,1]
    v_pk_mul_f32 v[188:189], v[188:189], v[226:227] op_sel:[0,1] op_sel_hi:[1,1]
    v_pk_mul_f32 v[190:191], v[190:191], v[226:227] op_sel:[0,1] op_sel_hi:[1,1]
    v_cvt_pk_bf16_f32 v184, v184, v185
    v_cvt_pk_bf16_f32 v185, v186, v187
    v_cvt_pk_bf16_f32 v186, v188, v189
    v_cvt_pk_bf16_f32 v187, v190, v191
    s_waitcnt lgkmcnt(14)
    ds_write_b128 v207, v[184:187] offset:24576
    s_waitcnt lgkmcnt(14)
    ds_read_b128 v[50:53], v208 offset:10752
    s_waitcnt lgkmcnt(14)
    ds_read_b128 v[54:57], v208 offset:11776
    s_waitcnt lgkmcnt(14)
    ds_read_b128 v[58:61], v208 offset:12800
    s_waitcnt lgkmcnt(14)
    ds_read_b64 v[62:63], v209 offset:13824
    s_waitcnt lgkmcnt(12)
    .p2align 3
    v_accvgpr_read_b32 v176, a32
    v_accvgpr_read_b32 v177, a33
    v_accvgpr_read_b32 v178, a34
    v_accvgpr_read_b32 v179, a35
    v_accvgpr_read_b32 v180, a36
    v_accvgpr_read_b32 v181, a37
    v_accvgpr_read_b32 v182, a38
    v_accvgpr_read_b32 v183, a39
    v_pk_mul_f32 v[72:73], v[72:73], v[228:229] op_sel:[0,0] op_sel_hi:[1,0]
    v_pk_mul_f32 v[74:75], v[74:75], v[228:229] op_sel:[0,0] op_sel_hi:[1,0]
    v_pk_mul_f32 v[76:77], v[76:77], v[228:229] op_sel:[0,0] op_sel_hi:[1,0]
    v_pk_mul_f32 v[78:79], v[78:79], v[228:229] op_sel:[0,0] op_sel_hi:[1,0]
    v_cvt_pk_bf16_f32 v72, v72, v73
    v_cvt_pk_bf16_f32 v73, v74, v75
    v_cvt_pk_bf16_f32 v74, v76, v77
    v_cvt_pk_bf16_f32 v75, v78, v79
    ds_write_b128 v207, v[72:75] offset:4096
    v_pk_mul_f32 v[80:81], v[80:81], v[228:229] op_sel:[0,0] op_sel_hi:[1,0]
    v_pk_mul_f32 v[82:83], v[82:83], v[228:229] op_sel:[0,0] op_sel_hi:[1,0]
    v_pk_mul_f32 v[84:85], v[84:85], v[228:229] op_sel:[0,0] op_sel_hi:[1,0]
    v_pk_mul_f32 v[86:87], v[86:87], v[228:229] op_sel:[0,0] op_sel_hi:[1,0]
    v_cvt_pk_bf16_f32 v80, v80, v81
    v_cvt_pk_bf16_f32 v81, v82, v83
    v_cvt_pk_bf16_f32 v82, v84, v85
    v_cvt_pk_bf16_f32 v83, v86, v87
    ds_write_b128 v207, v[80:83] offset:11264
    v_pk_mul_f32 v[152:153], v[152:153], v[228:229] op_sel:[0,0] op_sel_hi:[1,0]
    v_pk_mul_f32 v[154:155], v[154:155], v[228:229] op_sel:[0,0] op_sel_hi:[1,0]
    v_pk_mul_f32 v[156:157], v[156:157], v[228:229] op_sel:[0,0] op_sel_hi:[1,0]
    v_pk_mul_f32 v[158:159], v[158:159], v[228:229] op_sel:[0,0] op_sel_hi:[1,0]
    v_cvt_pk_bf16_f32 v152, v152, v153
    v_cvt_pk_bf16_f32 v153, v154, v155
    v_cvt_pk_bf16_f32 v154, v156, v157
    v_cvt_pk_bf16_f32 v155, v158, v159
    ds_write_b128 v207, v[152:155] offset:18432
    v_pk_mul_f32 v[176:177], v[176:177], v[228:229] op_sel:[0,0] op_sel_hi:[1,0]
    v_pk_mul_f32 v[178:179], v[178:179], v[228:229] op_sel:[0,0] op_sel_hi:[1,0]
    v_pk_mul_f32 v[180:181], v[180:181], v[228:229] op_sel:[0,0] op_sel_hi:[1,0]
    v_pk_mul_f32 v[182:183], v[182:183], v[228:229] op_sel:[0,0] op_sel_hi:[1,0]
    v_cvt_pk_bf16_f32 v176, v176, v177
    v_cvt_pk_bf16_f32 v177, v178, v179
    v_cvt_pk_bf16_f32 v178, v180, v181
    v_cvt_pk_bf16_f32 v179, v182, v183
    s_waitcnt lgkmcnt(14)
    ds_write_b128 v207, v[176:179] offset:25600
    s_waitcnt lgkmcnt(14)
    ds_read_b128 v[64:67], v208 offset:14336
    s_waitcnt lgkmcnt(14)
    ds_read_b128 v[68:71], v208 offset:15360
    s_waitcnt lgkmcnt(14)
    ds_read_b128 v[72:75], v208 offset:16384
    s_waitcnt lgkmcnt(14)
    ds_read_b64 v[76:77], v209 offset:17408
    s_waitcnt lgkmcnt(12)
    .p2align 3
    v_accvgpr_read_b32 v184, a40
    v_accvgpr_read_b32 v185, a41
    v_accvgpr_read_b32 v186, a42
    v_accvgpr_read_b32 v187, a43
    v_accvgpr_read_b32 v188, a44
    v_accvgpr_read_b32 v189, a45
    v_accvgpr_read_b32 v190, a46
    v_accvgpr_read_b32 v191, a47
    v_pk_mul_f32 v[88:89], v[88:89], v[228:229] op_sel:[0,1] op_sel_hi:[1,1]
    v_pk_mul_f32 v[90:91], v[90:91], v[228:229] op_sel:[0,1] op_sel_hi:[1,1]
    v_pk_mul_f32 v[92:93], v[92:93], v[228:229] op_sel:[0,1] op_sel_hi:[1,1]
    v_pk_mul_f32 v[94:95], v[94:95], v[228:229] op_sel:[0,1] op_sel_hi:[1,1]
    v_cvt_pk_bf16_f32 v88, v88, v89
    v_cvt_pk_bf16_f32 v89, v90, v91
    v_cvt_pk_bf16_f32 v90, v92, v93
    v_cvt_pk_bf16_f32 v91, v94, v95
    ds_write_b128 v207, v[88:91] offset:5120
    v_pk_mul_f32 v[96:97], v[96:97], v[228:229] op_sel:[0,1] op_sel_hi:[1,1]
    v_pk_mul_f32 v[98:99], v[98:99], v[228:229] op_sel:[0,1] op_sel_hi:[1,1]
    v_pk_mul_f32 v[100:101], v[100:101], v[228:229] op_sel:[0,1] op_sel_hi:[1,1]
    v_pk_mul_f32 v[102:103], v[102:103], v[228:229] op_sel:[0,1] op_sel_hi:[1,1]
    v_cvt_pk_bf16_f32 v96, v96, v97
    v_cvt_pk_bf16_f32 v97, v98, v99
    v_cvt_pk_bf16_f32 v98, v100, v101
    v_cvt_pk_bf16_f32 v99, v102, v103
    ds_write_b128 v207, v[96:99] offset:12288
    v_pk_mul_f32 v[160:161], v[160:161], v[228:229] op_sel:[0,1] op_sel_hi:[1,1]
    v_pk_mul_f32 v[162:163], v[162:163], v[228:229] op_sel:[0,1] op_sel_hi:[1,1]
    v_pk_mul_f32 v[164:165], v[164:165], v[228:229] op_sel:[0,1] op_sel_hi:[1,1]
    v_pk_mul_f32 v[166:167], v[166:167], v[228:229] op_sel:[0,1] op_sel_hi:[1,1]
    v_cvt_pk_bf16_f32 v160, v160, v161
    v_cvt_pk_bf16_f32 v161, v162, v163
    v_cvt_pk_bf16_f32 v162, v164, v165
    v_cvt_pk_bf16_f32 v163, v166, v167
    ds_write_b128 v207, v[160:163] offset:19456
    v_pk_mul_f32 v[184:185], v[184:185], v[228:229] op_sel:[0,1] op_sel_hi:[1,1]
    v_pk_mul_f32 v[186:187], v[186:187], v[228:229] op_sel:[0,1] op_sel_hi:[1,1]
    v_pk_mul_f32 v[188:189], v[188:189], v[228:229] op_sel:[0,1] op_sel_hi:[1,1]
    v_pk_mul_f32 v[190:191], v[190:191], v[228:229] op_sel:[0,1] op_sel_hi:[1,1]
    v_cvt_pk_bf16_f32 v184, v184, v185
    v_cvt_pk_bf16_f32 v185, v186, v187
    v_cvt_pk_bf16_f32 v186, v188, v189
    v_cvt_pk_bf16_f32 v187, v190, v191
    s_waitcnt lgkmcnt(14)
    ds_write_b128 v207, v[184:187] offset:26624
    s_waitcnt lgkmcnt(14)
    ds_read_b128 v[78:81], v208 offset:17920
    s_waitcnt lgkmcnt(14)
    ds_read_b128 v[82:85], v208 offset:18944
    s_waitcnt lgkmcnt(14)
    ds_read_b128 v[86:89], v208 offset:19968
    s_waitcnt lgkmcnt(14)
    ds_read_b64 v[90:91], v209 offset:20992
    s_waitcnt lgkmcnt(12)
    .p2align 3
    v_accvgpr_read_b32 v176, a48
    v_accvgpr_read_b32 v177, a49
    v_accvgpr_read_b32 v178, a50
    v_accvgpr_read_b32 v179, a51
    v_accvgpr_read_b32 v180, a52
    v_accvgpr_read_b32 v181, a53
    v_accvgpr_read_b32 v182, a54
    v_accvgpr_read_b32 v183, a55
    v_pk_mul_f32 v[104:105], v[104:105], v[230:231] op_sel:[0,0] op_sel_hi:[1,0]
    v_pk_mul_f32 v[106:107], v[106:107], v[230:231] op_sel:[0,0] op_sel_hi:[1,0]
    v_pk_mul_f32 v[108:109], v[108:109], v[230:231] op_sel:[0,0] op_sel_hi:[1,0]
    v_pk_mul_f32 v[110:111], v[110:111], v[230:231] op_sel:[0,0] op_sel_hi:[1,0]
    v_cvt_pk_bf16_f32 v104, v104, v105
    v_cvt_pk_bf16_f32 v105, v106, v107
    v_cvt_pk_bf16_f32 v106, v108, v109
    v_cvt_pk_bf16_f32 v107, v110, v111
    ds_write_b128 v207, v[104:107] offset:6144
    v_pk_mul_f32 v[112:113], v[112:113], v[230:231] op_sel:[0,0] op_sel_hi:[1,0]
    v_pk_mul_f32 v[114:115], v[114:115], v[230:231] op_sel:[0,0] op_sel_hi:[1,0]
    v_pk_mul_f32 v[116:117], v[116:117], v[230:231] op_sel:[0,0] op_sel_hi:[1,0]
    v_pk_mul_f32 v[118:119], v[118:119], v[230:231] op_sel:[0,0] op_sel_hi:[1,0]
    v_cvt_pk_bf16_f32 v112, v112, v113
    v_cvt_pk_bf16_f32 v113, v114, v115
    v_cvt_pk_bf16_f32 v114, v116, v117
    v_cvt_pk_bf16_f32 v115, v118, v119
    ds_write_b128 v207, v[112:115] offset:13312
    v_pk_mul_f32 v[168:169], v[168:169], v[230:231] op_sel:[0,0] op_sel_hi:[1,0]
    v_pk_mul_f32 v[170:171], v[170:171], v[230:231] op_sel:[0,0] op_sel_hi:[1,0]
    v_pk_mul_f32 v[172:173], v[172:173], v[230:231] op_sel:[0,0] op_sel_hi:[1,0]
    v_pk_mul_f32 v[174:175], v[174:175], v[230:231] op_sel:[0,0] op_sel_hi:[1,0]
    v_cvt_pk_bf16_f32 v168, v168, v169
    v_cvt_pk_bf16_f32 v169, v170, v171
    v_cvt_pk_bf16_f32 v170, v172, v173
    v_cvt_pk_bf16_f32 v171, v174, v175
    ds_write_b128 v207, v[168:171] offset:20480
    v_pk_mul_f32 v[176:177], v[176:177], v[230:231] op_sel:[0,0] op_sel_hi:[1,0]
    v_pk_mul_f32 v[178:179], v[178:179], v[230:231] op_sel:[0,0] op_sel_hi:[1,0]
    v_pk_mul_f32 v[180:181], v[180:181], v[230:231] op_sel:[0,0] op_sel_hi:[1,0]
    v_pk_mul_f32 v[182:183], v[182:183], v[230:231] op_sel:[0,0] op_sel_hi:[1,0]
    v_cvt_pk_bf16_f32 v176, v176, v177
    v_cvt_pk_bf16_f32 v177, v178, v179
    v_cvt_pk_bf16_f32 v178, v180, v181
    v_cvt_pk_bf16_f32 v179, v182, v183
    s_waitcnt lgkmcnt(14)
    ds_write_b128 v207, v[176:179] offset:27648
    v_lshrrev_b32 v1, 2, v0
    v_bfe_u32 v2, v1, 1, 2
    v_xor_b32 v2, s43, v2
    v_lshlrev_b32 v2, 5, v2
    v_and_b32 v3, 3, v0
    v_lshl_add_u32 v2, v3, 3, v2
    v_lshl_add_u32 v192, v1, 7, v2
    v_add_u32 v193, 0x10000, v192
    v_add_u32 v194, 0x20000, v192
    v_and_b32 v2, 1, v3
    v_lshlrev_b32 v2, 4, v2
    s_movk_i32 s52, 0x3f80
    v_lshlrev_b32 v2, v2, s52
    v_cmp_gt_u32 vcc, 2, v3
    v_lshrrev_b32 v1, 4, v0
    v_lshlrev_b32 v3, 1, v1
    v_cndmask_b32 v204, 0, v2, vcc
    v_xor_b32 v205, v204, v2
    v_and_b32 v2, 7, v0
    v_xor_b32 v3, v3, v2
    v_lshrrev_b32 v2, 3, v0
    v_lshlrev_b32 v2, 10, v2
    v_lshl_add_u32 v197, v3, 4, v2
    s_lshl2_add_u32 s52, s41, s42
    s_lshl_b32 s52, s52, 15
    v_add_u32 v197, s52, v197
    s_lshl_b32 s65, s40, 12
    s_barrier
    s_waitcnt lgkmcnt(14)
    ds_read_b128 v[92:95], v208 offset:21504
    s_waitcnt lgkmcnt(14)
    ds_read_b128 v[96:99], v208 offset:22528
    s_waitcnt lgkmcnt(14)
    ds_read_b128 v[100:103], v208 offset:23552
    s_waitcnt lgkmcnt(14)
    ds_read_b64 v[104:105], v209 offset:24576
    s_waitcnt lgkmcnt(14)
    ds_read_b128 v[106:109], v208 offset:25088
    s_waitcnt lgkmcnt(14)
    ds_read_b128 v[110:113], v208 offset:26112
    s_waitcnt lgkmcnt(14)
    ds_read_b128 v[114:117], v208 offset:27136
    s_waitcnt lgkmcnt(14)
    ds_read_b64 v[118:119], v209 offset:28160
L_tail:
    s_waitcnt lgkmcnt(0)
    s_barrier
    ds_read_b64_tr_b16 a[224:225], v192 offset:57344
    ds_read_b64_tr_b16 a[226:227], v192 offset:59392
    ds_read_b128 a[0:3], v4 offset:0
    ds_read_b128 a[4:7], v4 offset:1024
    ds_read_b128 a[8:11], v4 offset:2048
    ds_read_b128 a[12:15], v4 offset:3072
    ds_read_b128 a[16:19], v4 offset:4096
    ds_read_b128 a[20:23], v4 offset:5120
    ds_read_b128 a[24:27], v4 offset:6144
    ds_read_b64_tr_b16 a[228:229], v192 offset:61440
    ds_read_b64_tr_b16 a[230:231], v192 offset:63488
    ds_read_b128 a[28:31], v4 offset:28672
    ds_read_b128 a[32:35], v4 offset:29696
    ds_read_b128 a[36:39], v4 offset:30720
    ds_read_b128 a[40:43], v4 offset:31744
    v_mfma_f32_4x4x4_16b_bf16 v[120:123], v[204:205], v[8:9], 0
    v_mfma_f32_4x4x4_16b_bf16 v[124:127], v[204:205], v[10:11], 0
    v_mfma_f32_4x4x4_16b_bf16 v[128:131], v[204:205], v[12:13], 0
    v_mfma_f32_4x4x4_16b_bf16 v[132:135], v[204:205], v[14:15], 0
    v_mfma_f32_4x4x4_16b_bf16 v[136:139], v[204:205], v[16:17], 0
    v_mfma_f32_4x4x4_16b_bf16 v[140:143], v[204:205], v[18:19], 0
    v_mfma_f32_4x4x4_16b_bf16 v[144:147], v[204:205], v[20:21], 0
    s_waitcnt lgkmcnt(9)
    v_mfma_f32_16x16x32_bf16 v[120:123], a[224:227], a[0:3], v[120:123]
    ds_read_b64_tr_b16 a[232:233], v194 offset:8192
    ds_read_b64_tr_b16 a[234:235], v194 offset:10240
    v_mfma_f32_16x16x32_bf16 v[124:127], a[224:227], a[4:7], v[124:127]
    ds_read_b128 a[44:47], v4 offset:32768
    ds_read_b128 a[48:51], v4 offset:33792
    v_mfma_f32_16x16x32_bf16 v[128:131], a[224:227], a[8:11], v[128:131]
    s_add_u32 m0, s65, 65536
    s_add_u32 s58, s44, 2
    s_and_b32 s58, s58, 7
    v_mfma_f32_16x16x32_bf16 v[132:135], a[224:227], a[12:15], v[132:135]
    s_lshl_b32 s58, s58, 7
    s_add_u32 s58, s58, 262144
    s_waitcnt lgkmcnt(10)
    v_mfma_f32_16x16x32_bf16 v[136:139], a[224:227], a[16:19], v[136:139]
    buffer_load_dwordx4 v197, s[20:23], s58 offen offset:0 lds
    v_mfma_f32_16x16x32_bf16 v[140:143], a[224:227], a[20:23], v[140:143]
    ds_read_b128 a[52:55], v4 offset:34816
    ds_read_b128 a[56:59], v4 offset:7168
    v_mfma_f32_16x16x32_bf16 v[144:147], a[224:227], a[24:27], v[144:147]
    ds_read_b128 a[60:63], v4 offset:8192
    s_waitcnt lgkmcnt(7)
    v_mfma_f32_16x16x32_bf16 v[120:123], a[228:231], a[28:31], v[120:123]
    ds_read_b128 a[64:67], v4 offset:9216
    s_addk_i32 s58, 7168
    v_mfma_f32_16x16x32_bf16 v[124:127], a[228:231], a[32:35], v[124:127]
    buffer_load_dwordx4 v197, s[20:23], s58 offen offset:1024 lds
    v_mfma_f32_16x16x32_bf16 v[128:131], a[228:231], a[36:39], v[128:131]
    ds_read_b128 a[68:71], v4 offset:10240
    ds_read_b64_tr_b16 a[236:237], v194 offset:12288
    v_mfma_f32_16x16x32_bf16 v[132:135], a[228:231], a[40:43], v[132:135]
    ds_read_b64_tr_b16 a[238:239], v194 offset:14336
    s_waitcnt lgkmcnt(6)
    v_mfma_f32_16x16x32_bf16 v[136:139], a[228:231], a[44:47], v[136:139]
    ds_read_b128 a[72:75], v4 offset:11264
    s_addk_i32 s58, 7168
    v_mfma_f32_16x16x32_bf16 v[140:143], a[228:231], a[48:51], v[140:143]
    buffer_load_dwordx4 v197, s[20:23], s58 offen offset:2048 lds
    v_mfma_f32_16x16x32_bf16 v[144:147], a[228:231], a[52:55], v[144:147]
    ds_read_b128 a[76:79], v4 offset:12288
    s_waitcnt lgkmcnt(4)
    v_mfma_f32_16x16x32_bf16 v[120:123], a[232:235], a[56:59], v[120:123]
    ds_read_b128 a[80:83], v4 offset:13312
    ds_read_b128 a[84:87], v4 offset:35840
    v_mfma_f32_16x16x32_bf16 v[124:127], a[232:235], a[60:63], v[124:127]
    ds_read_b128 a[88:91], v4 offset:36864
    s_addk_i32 s58, 7168
    buffer_load_dwordx4 v197, s[20:23], s58 offen offset:3072 lds
    v_mfma_f32_16x16x32_bf16 v[128:131], a[232:235], a[64:67], v[128:131]
    ds_read_b128 a[92:95], v4 offset:37888
    ds_read_b128 a[96:99], v4 offset:38912
    v_mfma_f32_16x16x32_bf16 v[132:135], a[232:235], a[68:71], v[132:135]
    s_waitcnt vmcnt(4)
    s_barrier
    s_waitcnt lgkmcnt(4)
    v_mfma_f32_16x16x32_bf16 v[136:139], a[232:235], a[72:75], v[136:139]
    ds_read_b64_tr_b16 a[240:241], v194 offset:16384
    ds_read_b64_tr_b16 a[242:243], v194 offset:18432
    v_mfma_f32_16x16x32_bf16 v[140:143], a[232:235], a[76:79], v[140:143]
    ds_read_b128 a[100:103], v4 offset:39936
    ds_read_b128 a[104:107], v4 offset:40960
    v_mfma_f32_16x16x32_bf16 v[144:147], a[232:235], a[80:83], v[144:147]
    s_add_u32 m0, s65, 81920
    s_add_u32 s58, s44, 2
    s_and_b32 s58, s58, 7
    s_lshl_b32 s58, s58, 7
    s_add_u32 s58, s58, 327680
    buffer_load_dwordx4 v197, s[20:23], s58 offen offset:0 lds
    s_waitcnt lgkmcnt(4)
    v_mfma_f32_16x16x32_bf16 v[120:123], a[236:239], a[84:87], v[120:123]
    ds_read_b128 a[108:111], v4 offset:41984
    ds_read_b128 a[112:115], v4 offset:14336
    v_mfma_f32_16x16x32_bf16 v[124:127], a[236:239], a[88:91], v[124:127]
    ds_read_b128 a[116:119], v4 offset:15360
    ds_read_b128 a[120:123], v4 offset:16384
    v_mfma_f32_16x16x32_bf16 v[128:131], a[236:239], a[92:95], v[128:131]
    s_addk_i32 s58, 7168
    buffer_load_dwordx4 v197, s[20:23], s58 offen offset:1024 lds
    v_mfma_f32_16x16x32_bf16 v[132:135], a[236:239], a[96:99], v[132:135]
    ds_read_b128 a[124:127], v4 offset:17408
    s_waitcnt lgkmcnt(4)
    v_mfma_f32_16x16x32_bf16 v[136:139], a[236:239], a[100:103], v[136:139]
    ds_read_b64_tr_b16 a[244:245], v194 offset:20480
    ds_read_b64_tr_b16 a[246:247], v194 offset:22528
    v_mfma_f32_16x16x32_bf16 v[140:143], a[236:239], a[104:107], v[140:143]
    ds_read_b128 a[128:131], v4 offset:18432
    s_addk_i32 s58, 7168
    buffer_load_dwordx4 v197, s[20:23], s58 offen offset:2048 lds
    v_mfma_f32_16x16x32_bf16 v[144:147], a[236:239], a[108:111], v[144:147]
    ds_read_b128 a[132:135], v4 offset:19456
    s_waitcnt lgkmcnt(4)
    v_mfma_f32_16x16x32_bf16 v[120:123], a[240:243], a[112:115], v[120:123]
    ds_read_b128 a[136:139], v4 offset:20480
    ds_read_b128 a[140:143], v4 offset:43008
    v_mfma_f32_16x16x32_bf16 v[124:127], a[240:243], a[116:119], v[124:127]
    ds_read_b128 a[144:147], v4 offset:44032
    s_addk_i32 s58, 7168
    buffer_load_dwordx4 v197, s[20:23], s58 offen offset:3072 lds
    v_mfma_f32_16x16x32_bf16 v[128:131], a[240:243], a[120:123], v[128:131]
    ds_read_b128 a[148:151], v4 offset:45056
    ds_read_b128 a[152:155], v4 offset:46080
    v_mfma_f32_16x16x32_bf16 v[132:135], a[240:243], a[124:127], v[132:135]
    s_add_u32 m0, s65, 98304
    s_add_u32 s58, s44, 3
    s_waitcnt lgkmcnt(4)
    v_mfma_f32_16x16x32_bf16 v[136:139], a[240:243], a[128:131], v[136:139]
    s_and_b32 s58, s58, 7
    s_lshl_b32 s58, s58, 7
    s_add_u32 s58, s58, 262144
    buffer_load_dwordx4 v197, s[20:23], s58 offen offset:0 lds
    v_mfma_f32_16x16x32_bf16 v[140:143], a[240:243], a[132:135], v[140:143]
    ds_read_b64_tr_b16 a[248:249], v194 offset:24576
    ds_read_b64_tr_b16 a[250:251], v194 offset:26624
    ds_read_b128 a[156:159], v4 offset:47104
    v_mfma_f32_16x16x32_bf16 v[144:147], a[240:243], a[136:139], v[144:147]
    ds_read_b128 a[160:163], v4 offset:48128
    s_waitcnt lgkmcnt(4)
    v_mfma_f32_16x16x32_bf16 v[120:123], a[244:247], a[140:143], v[120:123]
    ds_read_b128 a[164:167], v4 offset:49152
    s_addk_i32 s58, 7168
    buffer_load_dwordx4 v197, s[20:23], s58 offen offset:1024 lds
    v_mfma_f32_16x16x32_bf16 v[124:127], a[244:247], a[144:147], v[124:127]
    ds_read_b128 a[168:171], v4 offset:21504
    ds_read_b128 a[172:175], v4 offset:22528
    v_mfma_f32_16x16x32_bf16 v[128:131], a[244:247], a[148:151], v[128:131]
    ds_read_b128 a[176:179], v4 offset:23552
    ds_read_b128 a[180:183], v4 offset:24576
    v_mfma_f32_16x16x32_bf16 v[132:135], a[244:247], a[152:155], v[132:135]
    s_addk_i32 s58, 7168
    buffer_load_dwordx4 v197, s[20:23], s58 offen offset:2048 lds
    s_waitcnt lgkmcnt(4)
    v_mfma_f32_16x16x32_bf16 v[136:139], a[244:247], a[156:159], v[136:139]
    ds_read_b64_tr_b16 a[252:253], v194 offset:28672
    ds_read_b64_tr_b16 a[254:255], v194 offset:30720
    v_mfma_f32_16x16x32_bf16 v[140:143], a[244:247], a[160:163], v[140:143]
    ds_read_b128 a[184:187], v4 offset:25600
    ds_read_b128 a[188:191], v4 offset:26624
    v_mfma_f32_16x16x32_bf16 v[144:147], a[244:247], a[164:167], v[144:147]
    s_addk_i32 s58, 7168
    buffer_load_dwordx4 v197, s[20:23], s58 offen offset:3072 lds
    s_waitcnt lgkmcnt(4)
    v_mfma_f32_16x16x32_bf16 v[120:123], a[248:251], a[168:171], v[120:123]
    ds_read_b128 a[192:195], v4 offset:27648
    ds_read_b128 a[196:199], v4 offset:50176
    v_mfma_f32_16x16x32_bf16 v[124:127], a[248:251], a[172:175], v[124:127]
    ds_read_b128 a[200:203], v4 offset:51200
    ds_read_b128 a[204:207], v4 offset:52224
    v_mfma_f32_16x16x32_bf16 v[128:131], a[248:251], a[176:179], v[128:131]
    s_add_u32 m0, s65, 114688
    s_add_u32 s58, s44, 3
    s_and_b32 s58, s58, 7
    s_lshl_b32 s58, s58, 7
    s_add_u32 s58, s58, 327680
    buffer_load_dwordx4 v197, s[20:23], s58 offen offset:0 lds
    v_mfma_f32_16x16x32_bf16 v[132:135], a[248:251], a[180:183], v[132:135]
    ds_read_b128 a[208:211], v4 offset:53248
    s_lshl3_add_u32 s52, s6, s5
    s_waitcnt lgkmcnt(4)
    v_mfma_f32_16x16x32_bf16 v[136:139], a[248:251], a[184:187], v[136:139]
    s_lshl_b32 s53, s43, 12
    s_waitcnt vmcnt(9)
    s_barrier
    v_mfma_f32_16x16x32_bf16 v[140:143], a[248:251], a[188:191], v[140:143]
    ds_read_b64_tr_b16 a[224:225], v193 offset:0
    ds_read_b64_tr_b16 a[226:227], v193 offset:2048
    ds_read_b128 a[212:215], v4 offset:54272
    s_addk_i32 s58, 7168
    buffer_load_dwordx4 v197, s[20:23], s58 offen offset:1024 lds
    s_lshl_b32 s62, s52, 17
    v_mfma_f32_16x16x32_bf16 v[144:147], a[248:251], a[192:195], v[144:147]
    ds_read_b128 a[216:219], v4 offset:55296
    s_add_u32 s62, s62, s53
    s_waitcnt lgkmcnt(4)
    v_mfma_f32_16x16x32_bf16 v[120:123], a[252:255], a[196:199], v[120:123]
    ds_read_b128 a[220:223], v4 offset:56320
    s_mul_i32 s57, s52, 0x9e3779b1
    v_mfma_f32_16x16x32_bf16 v[124:127], a[252:255], a[200:203], v[124:127]
    s_addk_i32 s58, 7168
    buffer_load_dwordx4 v197, s[20:23], s58 offen offset:2048 lds
    s_lshr_b32 s57, s57, 15
    v_mfma_f32_16x16x32_bf16 v[128:131], a[252:255], a[204:207], v[128:131]
    s_and_b32 s57, s57, 0x1c000
    s_xor_b32 s62, s62, s57
    s_addk_i32 s58, 7168
    v_mfma_f32_16x16x32_bf16 v[132:135], a[252:255], a[208:211], v[132:135]
    s_waitcnt lgkmcnt(0)
    v_mfma_f32_16x16x32_bf16 v[136:139], a[252:255], a[212:215], v[136:139]
    buffer_load_dwordx4 v197, s[20:23], s58 offen offset:3072 lds
    s_lshl_b32 s61, s6, 20
    v_mfma_f32_16x16x32_bf16 v[140:143], a[252:255], a[216:219], v[140:143]
    ds_read_b64_tr_b16 a[228:229], v193 offset:4096
    ds_read_b64_tr_b16 a[230:231], v193 offset:6144
    s_add_u32 s61, s61, s53
    v_mfma_f32_16x16x32_bf16 v[144:147], a[252:255], a[220:223], v[144:147]
    v_mfma_f32_4x4x4_16b_bf16 v[148:151], v[204:205], v[22:23], 0
    v_mfma_f32_4x4x4_16b_bf16 v[152:155], v[204:205], v[24:25], 0
    v_mfma_f32_4x4x4_16b_bf16 v[156:159], v[204:205], v[26:27], 0
    v_mfma_f32_4x4x4_16b_bf16 v[160:163], v[204:205], v[28:29], 0
    v_mfma_f32_4x4x4_16b_bf16 v[164:167], v[204:205], v[30:31], 0
    v_mfma_f32_4x4x4_16b_bf16 v[168:171], v[204:205], v[32:33], 0
    v_mfma_f32_4x4x4_16b_bf16 v[172:175], v[204:205], v[34:35], 0
    s_lshl_b32 s53, s43, 7
    s_add_u32 s53, s53, 33554432
    v_mfma_f32_16x16x32_bf16 v[148:151], a[224:227], a[0:3], v[148:151]
    s_lshl_b32 s64, s52, 9
    s_add_u32 s64, s64, s53
    s_lshl_b32 s63, s6, 12
    v_mfma_f32_16x16x32_bf16 v[152:155], a[224:227], a[4:7], v[152:155]
    s_add_u32 s63, s63, s53
    s_waitcnt vmcnt(8)
    s_barrier
    v_mfma_f32_16x16x32_bf16 v[156:159], a[224:227], a[8:11], v[156:159]
    ds_read_b64_tr_b16 a[232:233], v193 offset:8192
    ds_read_b64_tr_b16 a[234:235], v193 offset:10240
    v_mfma_f32_16x16x32_bf16 v[160:163], a[224:227], a[12:15], v[160:163]
    v_cvt_pk_bf16_f32 v8, v120, v121
    v_cvt_pk_bf16_f32 v9, v122, v123
    v_mfma_f32_16x16x32_bf16 v[164:167], a[224:227], a[16:19], v[164:167]
    v_cvt_pk_bf16_f32 v10, v124, v125
    v_cvt_pk_bf16_f32 v11, v126, v127
    v_mfma_f32_16x16x32_bf16 v[168:171], a[224:227], a[20:23], v[168:171]
    v_cvt_pk_bf16_f32 v12, v128, v129
    v_cvt_pk_bf16_f32 v13, v130, v131
    v_mfma_f32_16x16x32_bf16 v[172:175], a[224:227], a[24:27], v[172:175]
    v_cvt_pk_bf16_f32 v14, v132, v133
    s_waitcnt lgkmcnt(2)
    v_mfma_f32_16x16x32_bf16 v[148:151], a[228:231], a[28:31], v[148:151]
    v_cvt_pk_bf16_f32 v15, v134, v135
    v_cvt_pk_bf16_f32 v16, v136, v137
    v_mfma_f32_16x16x32_bf16 v[152:155], a[228:231], a[32:35], v[152:155]
    v_cvt_pk_bf16_f32 v17, v138, v139
    v_cvt_pk_bf16_f32 v18, v140, v141
    v_mfma_f32_16x16x32_bf16 v[156:159], a[228:231], a[36:39], v[156:159]
    ds_read_b64_tr_b16 a[236:237], v193 offset:12288
    ds_read_b64_tr_b16 a[238:239], v193 offset:14336
    v_mfma_f32_16x16x32_bf16 v[160:163], a[228:231], a[40:43], v[160:163]
    v_cvt_pk_bf16_f32 v19, v142, v143
    v_cvt_pk_bf16_f32 v20, v144, v145
    v_mfma_f32_16x16x32_bf16 v[164:167], a[228:231], a[44:47], v[164:167]
    s_add_u32 s56, s5, 1
    s_and_b32 s56, s56, 7
    s_lshl_b32 s56, s56, 17
    v_mfma_f32_16x16x32_bf16 v[168:171], a[228:231], a[48:51], v[168:171]
    s_add_u32 s56, s56, s61
    s_lshr_b32 s57, s56, 17
    s_mul_i32 s57, s57, 0x9e3779b1
    s_lshr_b32 s57, s57, 15
    s_and_b32 s57, s57, 0x1c000
    s_xor_b32 s56, s56, s57
    s_xor_b32 s56, s56, 16384
    v_mfma_f32_16x16x32_bf16 v[172:175], a[228:231], a[52:55], v[172:175]
    v_cvt_pk_bf16_f32 v21, v146, v147
    s_waitcnt lgkmcnt(2)
    v_mfma_f32_16x16x32_bf16 v[148:151], a[232:235], a[56:59], v[148:151]
    buffer_store_dwordx4 v[8:11], v4, s[24:27], s56 offen offset:0 sc1
    v_mfma_f32_16x16x32_bf16 v[152:155], a[232:235], a[60:63], v[152:155]
    buffer_store_dwordx4 v[12:15], v4, s[24:27], s56 offen offset:1024 sc1
    v_mfma_f32_16x16x32_bf16 v[156:159], a[232:235], a[64:67], v[156:159]
    ds_read_b64_tr_b16 a[240:241], v193 offset:16384
    ds_read_b64_tr_b16 a[242:243], v193 offset:18432
    v_mfma_f32_16x16x32_bf16 v[160:163], a[232:235], a[68:71], v[160:163]
    buffer_store_dwordx4 v[16:19], v4, s[24:27], s56 offen offset:2048 sc1
    v_mfma_f32_16x16x32_bf16 v[164:167], a[232:235], a[72:75], v[164:167]
    v_mfma_f32_16x16x32_bf16 v[168:171], a[232:235], a[76:79], v[168:171]
    buffer_store_dwordx2 v[20:21], v198, s[24:27], s56 offen offset:3072 sc1
    v_mfma_f32_16x16x32_bf16 v[172:175], a[232:235], a[80:83], v[172:175]
    s_waitcnt lgkmcnt(2)
    v_mfma_f32_16x16x32_bf16 v[148:151], a[236:239], a[84:87], v[148:151]
    ds_read_b64_tr_b16 a[244:245], v193 offset:20480
    ds_read_b64_tr_b16 a[246:247], v193 offset:22528
    v_mfma_f32_16x16x32_bf16 v[152:155], a[236:239], a[88:91], v[152:155]
    v_mfma_f32_16x16x32_bf16 v[156:159], a[236:239], a[92:95], v[156:159]
    v_mfma_f32_16x16x32_bf16 v[160:163], a[236:239], a[96:99], v[160:163]
    v_mfma_f32_16x16x32_bf16 v[164:167], a[236:239], a[100:103], v[164:167]
    v_mfma_f32_16x16x32_bf16 v[168:171], a[236:239], a[104:107], v[168:171]
    v_mfma_f32_16x16x32_bf16 v[172:175], a[236:239], a[108:111], v[172:175]
    s_waitcnt lgkmcnt(2)
    v_mfma_f32_16x16x32_bf16 v[148:151], a[240:243], a[112:115], v[148:151]
    ds_read_b64_tr_b16 a[248:249], v193 offset:24576
    ds_read_b64_tr_b16 a[250:251], v193 offset:26624
    v_mfma_f32_16x16x32_bf16 v[152:155], a[240:243], a[116:119], v[152:155]
    v_mov_b32 v202, 1
    v_mov_b32 v1, 2147418112
    v_mfma_f32_16x16x32_bf16 v[156:159], a[240:243], a[120:123], v[156:159]
    s_add_u32 m0, s65, 0
    s_add_u32 s58, s44, 4
    s_and_b32 s58, s58, 7
    v_mfma_f32_16x16x32_bf16 v[160:163], a[240:243], a[124:127], v[160:163]
    s_lshl_b32 s58, s58, 7
    s_add_u32 s58, s58, 262144
    v_mfma_f32_16x16x32_bf16 v[164:167], a[240:243], a[128:131], v[164:167]
    buffer_load_dwordx4 v197, s[20:23], s58 offen offset:0 lds
    v_mfma_f32_16x16x32_bf16 v[168:171], a[240:243], a[132:135], v[168:171]
    v_lshlrev_b32 v199, 2, v0
    v_cmp_eq_u32 vcc, 0, v0
    v_mfma_f32_16x16x32_bf16 v[172:175], a[240:243], a[136:139], v[172:175]
    s_addk_i32 s58, 7168
    s_waitcnt lgkmcnt(2)
    v_mfma_f32_16x16x32_bf16 v[148:151], a[244:247], a[140:143], v[148:151]
    buffer_load_dwordx4 v197, s[20:23], s58 offen offset:1024 lds
    v_mfma_f32_16x16x32_bf16 v[152:155], a[244:247], a[144:147], v[152:155]
    s_nop 0
    ds_read_b64_tr_b16 a[252:253], v193 offset:28672
    ds_read_b64_tr_b16 a[254:255], v193 offset:30720
    v_mfma_f32_16x16x32_bf16 v[156:159], a[244:247], a[148:151], v[156:159]
    v_cndmask_b32 v200, v1, v0, vcc
    s_addk_i32 s58, 7168
    v_mfma_f32_16x16x32_bf16 v[160:163], a[244:247], a[152:155], v[160:163]
    buffer_load_dwordx4 v197, s[20:23], s58 offen offset:2048 lds
    v_mfma_f32_16x16x32_bf16 v[164:167], a[244:247], a[156:159], v[164:167]
    v_cmp_gt_u32 vcc, 8, v0
    s_nop 0
    v_mfma_f32_16x16x32_bf16 v[168:171], a[244:247], a[160:163], v[168:171]
    s_addk_i32 s58, 7168
    v_mfma_f32_16x16x32_bf16 v[172:175], a[244:247], a[164:167], v[172:175]
    s_waitcnt lgkmcnt(2)
    v_mfma_f32_16x16x32_bf16 v[148:151], a[248:251], a[168:171], v[148:151]
    buffer_load_dwordx4 v197, s[20:23], s58 offen offset:3072 lds
    v_mfma_f32_16x16x32_bf16 v[152:155], a[248:251], a[172:175], v[152:155]
    v_cndmask_b32 v199, v1, v199, vcc
    s_mul_i32 s52, s4, 7168
    v_mfma_f32_16x16x32_bf16 v[156:159], a[248:251], a[176:179], v[156:159]
    s_waitcnt vmcnt(12)
    s_barrier
    ds_read_b64_tr_b16 a[224:225], v193 offset:32768
    v_mfma_f32_16x16x32_bf16 v[160:163], a[248:251], a[180:183], v[160:163]
    ds_read_b64_tr_b16 a[226:227], v193 offset:34816
    s_add_u32 m0, s65, 16384
    v_mfma_f32_16x16x32_bf16 v[164:167], a[248:251], a[184:187], v[164:167]
    s_add_u32 s58, s44, 4
    s_and_b32 s58, s58, 7
    s_lshl_b32 s58, s58, 7
    v_mfma_f32_16x16x32_bf16 v[168:171], a[248:251], a[188:191], v[168:171]
    s_add_u32 s58, s58, 327680
    buffer_load_dwordx4 v197, s[20:23], s58 offen offset:0 lds
    s_lshl3_add_u32 s54, s3, s44
    v_mfma_f32_16x16x32_bf16 v[172:175], a[248:251], a[192:195], v[172:175]
    s_lshl2_add_u32 s54, s54, s43
    s_addk_i32 s58, 7168
    s_waitcnt lgkmcnt(2)
    v_mfma_f32_16x16x32_bf16 v[148:151], a[252:255], a[196:199], v[148:151]
    buffer_load_dwordx4 v197, s[20:23], s58 offen offset:1024 lds
    v_mfma_f32_16x16x32_bf16 v[152:155], a[252:255], a[200:203], v[152:155]
    s_add_u32 s52, s52, s54
    s_lshl_b32 s52, s52, 5
    s_addk_i32 s58, 7168
    v_mfma_f32_16x16x32_bf16 v[156:159], a[252:255], a[204:207], v[156:159]
    buffer_load_dwordx4 v197, s[20:23], s58 offen offset:2048 lds
    v_mfma_f32_16x16x32_bf16 v[160:163], a[252:255], a[208:211], v[160:163]
    v_and_b32 v1, 15, v0
    ds_read_b64_tr_b16 a[228:229], v193 offset:36864
    v_mfma_f32_16x16x32_bf16 v[164:167], a[252:255], a[212:215], v[164:167]
    ds_read_b64_tr_b16 a[230:231], v193 offset:38912
    v_lshlrev_b32 v1, 11, v1
    v_mfma_f32_16x16x32_bf16 v[168:171], a[252:255], a[216:219], v[168:171]
    s_addk_i32 s58, 7168
    v_mfma_f32_16x16x32_bf16 v[172:175], a[252:255], a[220:223], v[172:175]
    v_mfma_f32_4x4x4_16b_bf16 v[120:123], v[204:205], v[36:37], 0
    v_mfma_f32_4x4x4_16b_bf16 v[124:127], v[204:205], v[38:39], 0
    v_mfma_f32_4x4x4_16b_bf16 v[128:131], v[204:205], v[40:41], 0
    v_mfma_f32_4x4x4_16b_bf16 v[132:135], v[204:205], v[42:43], 0
    v_mfma_f32_4x4x4_16b_bf16 v[136:139], v[204:205], v[44:45], 0
    v_mfma_f32_4x4x4_16b_bf16 v[140:143], v[204:205], v[46:47], 0
    v_mfma_f32_4x4x4_16b_bf16 v[144:147], v[204:205], v[48:49], 0
    s_waitcnt lgkmcnt(2)
    v_mfma_f32_16x16x32_bf16 v[120:123], a[224:227], a[0:3], v[120:123]
    buffer_load_dwordx4 v197, s[20:23], s58 offen offset:3072 lds
    v_lshrrev_b32 v2, 4, v0
    v_mfma_f32_16x16x32_bf16 v[124:127], a[224:227], a[4:7], v[124:127]
    v_lshl_add_u32 v1, v2, 3, v1
    v_add_u32 v206, s52, v1
    v_mfma_f32_16x16x32_bf16 v[128:131], a[224:227], a[8:11], v[128:131]
    s_waitcnt vmcnt(12)
    s_barrier
    ds_read_b64_tr_b16 a[232:233], v193 offset:40960
    v_mfma_f32_16x16x32_bf16 v[132:135], a[224:227], a[12:15], v[132:135]
    ds_read_b64_tr_b16 a[234:235], v193 offset:43008
    v_cvt_pk_bf16_f32 v22, v148, v149
    v_mfma_f32_16x16x32_bf16 v[136:139], a[224:227], a[16:19], v[136:139]
    v_cvt_pk_bf16_f32 v23, v150, v151
    v_cvt_pk_bf16_f32 v24, v152, v153
    v_mfma_f32_16x16x32_bf16 v[140:143], a[224:227], a[20:23], v[140:143]
    v_cvt_pk_bf16_f32 v25, v154, v155
    v_cvt_pk_bf16_f32 v26, v156, v157
    v_mfma_f32_16x16x32_bf16 v[144:147], a[224:227], a[24:27], v[144:147]
    v_cvt_pk_bf16_f32 v27, v158, v159
    s_waitcnt lgkmcnt(2)
    v_mfma_f32_16x16x32_bf16 v[120:123], a[228:231], a[28:31], v[120:123]
    v_cvt_pk_bf16_f32 v28, v160, v161
    v_cvt_pk_bf16_f32 v29, v162, v163
    v_mfma_f32_16x16x32_bf16 v[124:127], a[228:231], a[32:35], v[124:127]
    v_cvt_pk_bf16_f32 v30, v164, v165
    s_add_u32 s53, s5, 1
    v_mfma_f32_16x16x32_bf16 v[128:131], a[228:231], a[36:39], v[128:131]
    s_and_b32 s53, s53, 7
    s_lshl_b32 s53, s53, 9
    s_add_u32 s53, s53, s63
    v_mfma_f32_16x16x32_bf16 v[132:135], a[228:231], a[40:43], v[132:135]
    s_waitcnt vmcnt(8)
    v_mfma_f32_16x16x32_bf16 v[136:139], a[228:231], a[44:47], v[136:139]
    buffer_store_dword v202, v200, s[24:27], s53 offen offset:4 sc1
    v_cvt_pk_bf16_f32 v31, v166, v167
    v_cvt_pk_bf16_f32 v32, v168, v169
    v_mfma_f32_16x16x32_bf16 v[140:143], a[228:231], a[48:51], v[140:143]
    ds_read_b64_tr_b16 a[236:237], v193 offset:45056
    ds_read_b64_tr_b16 a[238:239], v193 offset:47104
    v_cvt_pk_bf16_f32 v33, v170, v171
    v_cvt_pk_bf16_f32 v34, v172, v173
    s_add_u32 s56, s5, 2
    s_and_b32 s56, s56, 7
    s_lshl_b32 s56, s56, 17
    s_add_u32 s56, s56, s61
    s_lshr_b32 s57, s56, 17
    s_mul_i32 s57, s57, 0x9e3779b1
    s_lshr_b32 s57, s57, 15
    s_and_b32 s57, s57, 0x1c000
    s_xor_b32 s56, s56, s57
    s_xor_b32 s56, s56, 32768
    v_mfma_f32_16x16x32_bf16 v[144:147], a[228:231], a[52:55], v[144:147]
    v_cvt_pk_bf16_f32 v35, v174, v175
    s_waitcnt lgkmcnt(2)
    v_mfma_f32_16x16x32_bf16 v[120:123], a[232:235], a[56:59], v[120:123]
    buffer_store_dwordx4 v[22:25], v4, s[24:27], s56 offen offset:0 sc1
    v_mfma_f32_16x16x32_bf16 v[124:127], a[232:235], a[60:63], v[124:127]
    buffer_store_dwordx4 v[26:29], v4, s[24:27], s56 offen offset:1024 sc1
    v_mfma_f32_16x16x32_bf16 v[128:131], a[232:235], a[64:67], v[128:131]
    ds_read_b64_tr_b16 a[240:241], v193 offset:49152
    ds_read_b64_tr_b16 a[242:243], v193 offset:51200
    v_mfma_f32_16x16x32_bf16 v[132:135], a[232:235], a[68:71], v[132:135]
    buffer_store_dwordx4 v[30:33], v4, s[24:27], s56 offen offset:2048 sc1
    v_mfma_f32_16x16x32_bf16 v[136:139], a[232:235], a[72:75], v[136:139]
    v_mfma_f32_16x16x32_bf16 v[140:143], a[232:235], a[76:79], v[140:143]
    buffer_store_dwordx2 v[34:35], v198, s[24:27], s56 offen offset:3072 sc1
    v_mfma_f32_16x16x32_bf16 v[144:147], a[232:235], a[80:83], v[144:147]
    s_waitcnt lgkmcnt(2)
    v_mfma_f32_16x16x32_bf16 v[120:123], a[236:239], a[84:87], v[120:123]
    ds_read_b64_tr_b16 a[244:245], v193 offset:53248
    ds_read_b64_tr_b16 a[246:247], v193 offset:55296
    v_mfma_f32_16x16x32_bf16 v[124:127], a[236:239], a[88:91], v[124:127]
    v_mfma_f32_16x16x32_bf16 v[128:131], a[236:239], a[92:95], v[128:131]
    v_mfma_f32_16x16x32_bf16 v[132:135], a[236:239], a[96:99], v[132:135]
    v_mfma_f32_16x16x32_bf16 v[136:139], a[236:239], a[100:103], v[136:139]
    v_mfma_f32_16x16x32_bf16 v[140:143], a[236:239], a[104:107], v[140:143]
    v_mfma_f32_16x16x32_bf16 v[144:147], a[236:239], a[108:111], v[144:147]
    s_waitcnt lgkmcnt(2)
    v_mfma_f32_16x16x32_bf16 v[120:123], a[240:243], a[112:115], v[120:123]
    ds_read_b64_tr_b16 a[248:249], v193 offset:57344
    ds_read_b64_tr_b16 a[250:251], v193 offset:59392
    v_mfma_f32_16x16x32_bf16 v[124:127], a[240:243], a[116:119], v[124:127]
    v_mfma_f32_16x16x32_bf16 v[128:131], a[240:243], a[120:123], v[128:131]
    s_add_u32 m0, s65, 32768
    s_add_u32 s58, s44, 5
    s_and_b32 s58, s58, 7
    v_mfma_f32_16x16x32_bf16 v[132:135], a[240:243], a[124:127], v[132:135]
    s_lshl_b32 s58, s58, 7
    s_add_u32 s58, s58, 262144
    v_mfma_f32_16x16x32_bf16 v[136:139], a[240:243], a[128:131], v[136:139]
    buffer_load_dwordx4 v197, s[20:23], s58 offen offset:0 lds
    v_mfma_f32_16x16x32_bf16 v[140:143], a[240:243], a[132:135], v[140:143]
    s_addk_i32 s58, 7168
    v_mfma_f32_16x16x32_bf16 v[144:147], a[240:243], a[136:139], v[144:147]
    s_waitcnt lgkmcnt(2)
    v_mfma_f32_16x16x32_bf16 v[120:123], a[244:247], a[140:143], v[120:123]
    buffer_load_dwordx4 v197, s[20:23], s58 offen offset:1024 lds
    v_mfma_f32_16x16x32_bf16 v[124:127], a[244:247], a[144:147], v[124:127]
    ds_read_b64_tr_b16 a[252:253], v193 offset:61440
    ds_read_b64_tr_b16 a[254:255], v193 offset:63488
    v_mfma_f32_16x16x32_bf16 v[128:131], a[244:247], a[148:151], v[128:131]
    s_addk_i32 s58, 7168
    v_mfma_f32_16x16x32_bf16 v[132:135], a[244:247], a[152:155], v[132:135]
    buffer_load_dwordx4 v197, s[20:23], s58 offen offset:2048 lds
    v_mfma_f32_16x16x32_bf16 v[136:139], a[244:247], a[156:159], v[136:139]
    s_addk_i32 s58, 7168
    v_mfma_f32_16x16x32_bf16 v[140:143], a[244:247], a[160:163], v[140:143]
    buffer_load_dwordx4 v197, s[20:23], s58 offen offset:3072 lds
    v_mfma_f32_16x16x32_bf16 v[144:147], a[244:247], a[164:167], v[144:147]
    s_waitcnt lgkmcnt(2)
    v_mfma_f32_16x16x32_bf16 v[120:123], a[248:251], a[168:171], v[120:123]
    s_waitcnt vmcnt(13)
    s_barrier
    ds_read_b64_tr_b16 a[224:225], v192 offset:0
    v_mfma_f32_16x16x32_bf16 v[124:127], a[248:251], a[172:175], v[124:127]
    ds_read_b64_tr_b16 a[226:227], v192 offset:2048
    s_add_u32 m0, s65, 49152
    v_mfma_f32_16x16x32_bf16 v[128:131], a[248:251], a[176:179], v[128:131]
    s_add_u32 s58, s44, 5
    s_and_b32 s58, s58, 7
    s_lshl_b32 s58, s58, 7
    v_mfma_f32_16x16x32_bf16 v[132:135], a[248:251], a[180:183], v[132:135]
    s_add_u32 s58, s58, 327680
    v_mfma_f32_16x16x32_bf16 v[136:139], a[248:251], a[184:187], v[136:139]
    buffer_load_dwordx4 v197, s[20:23], s58 offen offset:0 lds
    v_mfma_f32_16x16x32_bf16 v[140:143], a[248:251], a[188:191], v[140:143]
    s_addk_i32 s58, 7168
    v_mfma_f32_16x16x32_bf16 v[144:147], a[248:251], a[192:195], v[144:147]
    s_waitcnt lgkmcnt(2)
    v_mfma_f32_16x16x32_bf16 v[120:123], a[252:255], a[196:199], v[120:123]
    buffer_load_dwordx4 v197, s[20:23], s58 offen offset:1024 lds
    v_mfma_f32_16x16x32_bf16 v[124:127], a[252:255], a[200:203], v[124:127]
    s_addk_i32 s58, 7168
    v_mfma_f32_16x16x32_bf16 v[128:131], a[252:255], a[204:207], v[128:131]
    buffer_load_dwordx4 v197, s[20:23], s58 offen offset:2048 lds
    v_mfma_f32_16x16x32_bf16 v[132:135], a[252:255], a[208:211], v[132:135]
    ds_read_b64_tr_b16 a[228:229], v192 offset:4096
    ds_read_b64_tr_b16 a[230:231], v192 offset:6144
    v_mfma_f32_16x16x32_bf16 v[136:139], a[252:255], a[212:215], v[136:139]
    s_addk_i32 s58, 7168
    v_mfma_f32_16x16x32_bf16 v[140:143], a[252:255], a[216:219], v[140:143]
    buffer_load_dwordx4 v197, s[20:23], s58 offen offset:3072 lds
    v_mfma_f32_16x16x32_bf16 v[144:147], a[252:255], a[220:223], v[144:147]
    v_mfma_f32_4x4x4_16b_bf16 v[148:151], v[204:205], v[50:51], 0
    v_mfma_f32_4x4x4_16b_bf16 v[152:155], v[204:205], v[52:53], 0
    v_mfma_f32_4x4x4_16b_bf16 v[156:159], v[204:205], v[54:55], 0
    v_mfma_f32_4x4x4_16b_bf16 v[160:163], v[204:205], v[56:57], 0
    v_mfma_f32_4x4x4_16b_bf16 v[164:167], v[204:205], v[58:59], 0
    v_mfma_f32_4x4x4_16b_bf16 v[168:171], v[204:205], v[60:61], 0
    v_mfma_f32_4x4x4_16b_bf16 v[172:175], v[204:205], v[62:63], 0
    s_waitcnt lgkmcnt(2)
    v_mfma_f32_16x16x32_bf16 v[148:151], a[224:227], a[0:3], v[148:151]
    s_waitcnt vmcnt(13)
    s_barrier
    ds_read_b64_tr_b16 a[232:233], v192 offset:8192
    v_mfma_f32_16x16x32_bf16 v[152:155], a[224:227], a[4:7], v[152:155]
    ds_read_b64_tr_b16 a[234:235], v192 offset:10240
    v_cvt_pk_bf16_f32 v36, v120, v121
    v_mfma_f32_16x16x32_bf16 v[156:159], a[224:227], a[8:11], v[156:159]
    v_cvt_pk_bf16_f32 v37, v122, v123
    s_mul_i32 s52, s4, 1792
    v_mfma_f32_16x16x32_bf16 v[160:163], a[224:227], a[12:15], v[160:163]
    v_cvt_pk_bf16_f32 v38, v124, v125
    v_cvt_pk_bf16_f32 v39, v126, v127
    v_mfma_f32_16x16x32_bf16 v[164:167], a[224:227], a[16:19], v[164:167]
    s_lshl3_add_u32 s54, s3, s44
    v_cvt_pk_bf16_f32 v40, v128, v129
    v_cvt_pk_bf16_f32 v41, v130, v131
    v_mfma_f32_16x16x32_bf16 v[168:171], a[224:227], a[20:23], v[168:171]
    v_cvt_pk_bf16_f32 v42, v132, v133
    s_add_u32 s52, s52, s54
    v_mfma_f32_16x16x32_bf16 v[172:175], a[224:227], a[24:27], v[172:175]
    v_cvt_pk_bf16_f32 v43, v134, v135
    s_waitcnt lgkmcnt(2)
    v_mfma_f32_16x16x32_bf16 v[148:151], a[228:231], a[28:31], v[148:151]
    v_cvt_pk_bf16_f32 v44, v136, v137
    s_lshl_b32 s52, s52, 7
    v_mfma_f32_16x16x32_bf16 v[152:155], a[228:231], a[32:35], v[152:155]
    s_add_u32 s53, s5, 2
    s_and_b32 s53, s53, 7
    s_lshl_b32 s53, s53, 9
    v_mfma_f32_16x16x32_bf16 v[156:159], a[228:231], a[36:39], v[156:159]
    s_add_u32 s53, s53, s63
    s_waitcnt vmcnt(8)
    v_mfma_f32_16x16x32_bf16 v[160:163], a[228:231], a[40:43], v[160:163]
    buffer_store_dword v202, v200, s[24:27], s53 offen offset:8 sc1
    v_mfma_f32_16x16x32_bf16 v[164:167], a[228:231], a[44:47], v[164:167]
    v_cvt_pk_bf16_f32 v45, v138, v139
    v_cvt_pk_bf16_f32 v46, v140, v141
    v_mfma_f32_16x16x32_bf16 v[168:171], a[228:231], a[48:51], v[168:171]
    ds_read_b64_tr_b16 a[236:237], v192 offset:12288
    ds_read_b64_tr_b16 a[238:239], v192 offset:14336
    v_cvt_pk_bf16_f32 v47, v142, v143
    v_cvt_pk_bf16_f32 v48, v144, v145
    s_add_u32 s56, s5, 3
    s_and_b32 s56, s56, 7
    s_lshl_b32 s56, s56, 17
    s_add_u32 s56, s56, s61
    s_lshr_b32 s57, s56, 17
    s_mul_i32 s57, s57, 0x9e3779b1
    s_lshr_b32 s57, s57, 15
    s_and_b32 s57, s57, 0x1c000
    s_xor_b32 s56, s56, s57
    s_xor_b32 s56, s56, 49152
    v_mfma_f32_16x16x32_bf16 v[172:175], a[228:231], a[52:55], v[172:175]
    v_lshrrev_b32 v1, 3, v0
    v_cvt_pk_bf16_f32 v49, v146, v147
    s_waitcnt lgkmcnt(2)
    v_mfma_f32_16x16x32_bf16 v[148:151], a[232:235], a[56:59], v[148:151]
    v_lshl_add_u32 v1, s40, 3, v1
    v_mfma_f32_16x16x32_bf16 v[152:155], a[232:235], a[60:63], v[152:155]
    buffer_store_dwordx4 v[36:39], v4, s[24:27], s56 offen offset:0 sc1
    v_mfma_f32_16x16x32_bf16 v[156:159], a[232:235], a[64:67], v[156:159]
    v_and_b32 v2, 7, v0
    v_lshlrev_b32 v2, 4, v2
    v_mfma_f32_16x16x32_bf16 v[160:163], a[232:235], a[68:71], v[160:163]
    buffer_store_dwordx4 v[40:43], v4, s[24:27], s56 offen offset:1024 sc1
    v_mfma_f32_16x16x32_bf16 v[164:167], a[232:235], a[72:75], v[164:167]
    ds_read_b64_tr_b16 a[240:241], v192 offset:16384
    ds_read_b64_tr_b16 a[242:243], v192 offset:18432
    v_mfma_f32_16x16x32_bf16 v[168:171], a[232:235], a[76:79], v[168:171]
    v_lshl_add_u32 v206, v1, 11, v2
    v_add_u32 v206, s52, v206
    v_mfma_f32_16x16x32_bf16 v[172:175], a[232:235], a[80:83], v[172:175]
    s_waitcnt lgkmcnt(2)
    v_mfma_f32_16x16x32_bf16 v[148:151], a[236:239], a[84:87], v[148:151]
    buffer_store_dwordx4 v[44:47], v4, s[24:27], s56 offen offset:2048 sc1
    v_mfma_f32_16x16x32_bf16 v[152:155], a[236:239], a[88:91], v[152:155]
    v_mul_u32_u24 v1, 144, v1
    v_add_u32 v1, v1, v2
    v_mfma_f32_16x16x32_bf16 v[156:159], a[236:239], a[92:95], v[156:159]
    buffer_store_dwordx2 v[48:49], v198, s[24:27], s56 offen offset:3072 sc1
    v_mfma_f32_16x16x32_bf16 v[160:163], a[236:239], a[96:99], v[160:163]
    v_add_u32 v208, 32768, v1
    ds_read_b64_tr_b16 a[244:245], v192 offset:20480
    v_mfma_f32_16x16x32_bf16 v[164:167], a[236:239], a[100:103], v[164:167]
    ds_read_b64_tr_b16 a[246:247], v192 offset:22528
    v_and_b32 v1, 15, v0
    v_mfma_f32_16x16x32_bf16 v[168:171], a[236:239], a[104:107], v[168:171]
    v_mul_u32_u24 v1, 144, v1
    v_lshrrev_b32 v2, 4, v0
    v_mfma_f32_16x16x32_bf16 v[172:175], a[236:239], a[108:111], v[172:175]
    v_lshl_add_u32 v1, v2, 3, v1
    s_waitcnt lgkmcnt(2)
    v_mfma_f32_16x16x32_bf16 v[148:151], a[240:243], a[112:115], v[148:151]
    s_lshl_b32 s52, s43, 5
    ds_read_b64_tr_b16 a[248:249], v192 offset:24576
    ds_read_b64_tr_b16 a[250:251], v192 offset:26624
    v_mfma_f32_16x16x32_bf16 v[152:155], a[240:243], a[116:119], v[152:155]
    s_add_u32 s52, s52, 32768
    v_mfma_f32_16x16x32_bf16 v[156:159], a[240:243], a[120:123], v[156:159]
    s_add_u32 m0, s65, 131072
    s_add_u32 s58, s44, 6
    s_and_b32 s58, s58, 7
    v_mfma_f32_16x16x32_bf16 v[160:163], a[240:243], a[124:127], v[160:163]
    s_lshl_b32 s58, s58, 7
    s_add_u32 s58, s58, 262144
    v_mfma_f32_16x16x32_bf16 v[164:167], a[240:243], a[128:131], v[164:167]
    buffer_load_dwordx4 v197, s[20:23], s58 offen offset:0 lds
    v_mfma_f32_16x16x32_bf16 v[168:171], a[240:243], a[132:135], v[168:171]
    v_add_u32 v207, s52, v1
    s_addk_i32 s58, 7168
    v_mfma_f32_16x16x32_bf16 v[172:175], a[240:243], a[136:139], v[172:175]
    s_waitcnt lgkmcnt(2)
    v_mfma_f32_16x16x32_bf16 v[148:151], a[244:247], a[140:143], v[148:151]
    buffer_load_dwordx4 v197, s[20:23], s58 offen offset:1024 lds
    v_mfma_f32_16x16x32_bf16 v[152:155], a[244:247], a[144:147], v[152:155]
    ds_read_b64_tr_b16 a[252:253], v192 offset:28672
    ds_read_b64_tr_b16 a[254:255], v192 offset:30720
    v_mfma_f32_16x16x32_bf16 v[156:159], a[244:247], a[148:151], v[156:159]
    s_addk_i32 s58, 7168
    v_mfma_f32_16x16x32_bf16 v[160:163], a[244:247], a[152:155], v[160:163]
    buffer_load_dwordx4 v197, s[20:23], s58 offen offset:2048 lds
    v_mfma_f32_16x16x32_bf16 v[164:167], a[244:247], a[156:159], v[164:167]
    buffer_load_dword v201, v199, s[24:27], s64 offen sc1
    v_mfma_f32_16x16x32_bf16 v[168:171], a[244:247], a[160:163], v[168:171]
    s_addk_i32 s58, 7168
    v_mfma_f32_16x16x32_bf16 v[172:175], a[244:247], a[164:167], v[172:175]
    s_waitcnt lgkmcnt(2)
    v_mfma_f32_16x16x32_bf16 v[148:151], a[248:251], a[168:171], v[148:151]
    buffer_load_dwordx4 v197, s[20:23], s58 offen offset:3072 lds
    v_mfma_f32_16x16x32_bf16 v[152:155], a[248:251], a[172:175], v[152:155]
    s_waitcnt vmcnt(14)
    s_barrier
    ds_read_b64_tr_b16 a[224:225], v192 offset:32768
    v_mfma_f32_16x16x32_bf16 v[156:159], a[248:251], a[176:179], v[156:159]
    ds_read_b64_tr_b16 a[226:227], v192 offset:34816
    s_add_u32 m0, s65, 147456
    v_mfma_f32_16x16x32_bf16 v[160:163], a[248:251], a[180:183], v[160:163]
    s_add_u32 s58, s44, 6
    s_and_b32 s58, s58, 7
    s_lshl_b32 s58, s58, 7
    v_mfma_f32_16x16x32_bf16 v[164:167], a[248:251], a[184:187], v[164:167]
    s_add_u32 s58, s58, 327680
    v_mfma_f32_16x16x32_bf16 v[168:171], a[248:251], a[188:191], v[168:171]
    buffer_load_dwordx4 v197, s[20:23], s58 offen offset:0 lds
    v_mfma_f32_16x16x32_bf16 v[172:175], a[248:251], a[192:195], v[172:175]
    s_addk_i32 s58, 7168
    s_waitcnt lgkmcnt(2)
    v_mfma_f32_16x16x32_bf16 v[148:151], a[252:255], a[196:199], v[148:151]
    buffer_load_dwordx4 v197, s[20:23], s58 offen offset:1024 lds
    v_mfma_f32_16x16x32_bf16 v[152:155], a[252:255], a[200:203], v[152:155]
    s_addk_i32 s58, 7168
    v_mfma_f32_16x16x32_bf16 v[156:159], a[252:255], a[204:207], v[156:159]
    buffer_load_dwordx4 v197, s[20:23], s58 offen offset:2048 lds
    v_mfma_f32_16x16x32_bf16 v[160:163], a[252:255], a[208:211], v[160:163]
    ds_read_b64_tr_b16 a[228:229], v192 offset:36864
    ds_read_b64_tr_b16 a[230:231], v192 offset:38912
    v_mfma_f32_16x16x32_bf16 v[164:167], a[252:255], a[212:215], v[164:167]
    s_addk_i32 s58, 7168
    v_mfma_f32_16x16x32_bf16 v[168:171], a[252:255], a[216:219], v[168:171]
    buffer_load_dwordx4 v197, s[20:23], s58 offen offset:3072 lds
    v_mfma_f32_16x16x32_bf16 v[172:175], a[252:255], a[220:223], v[172:175]
    v_mfma_f32_4x4x4_16b_bf16 v[120:123], v[204:205], v[64:65], 0
    v_mfma_f32_4x4x4_16b_bf16 v[124:127], v[204:205], v[66:67], 0
    v_mfma_f32_4x4x4_16b_bf16 v[128:131], v[204:205], v[68:69], 0
    v_mfma_f32_4x4x4_16b_bf16 v[132:135], v[204:205], v[70:71], 0
    v_mfma_f32_4x4x4_16b_bf16 v[136:139], v[204:205], v[72:73], 0
    v_mfma_f32_4x4x4_16b_bf16 v[140:143], v[204:205], v[74:75], 0
    v_mfma_f32_4x4x4_16b_bf16 v[144:147], v[204:205], v[76:77], 0
    s_waitcnt lgkmcnt(2)
    v_mfma_f32_16x16x32_bf16 v[120:123], a[224:227], a[0:3], v[120:123]
    s_waitcnt vmcnt(14)
    s_barrier
    ds_read_b64_tr_b16 a[232:233], v192 offset:40960
    v_mfma_f32_16x16x32_bf16 v[124:127], a[224:227], a[4:7], v[124:127]
    ds_read_b64_tr_b16 a[234:235], v192 offset:43008
    v_cvt_pk_bf16_f32 v50, v148, v149
    v_mfma_f32_16x16x32_bf16 v[128:131], a[224:227], a[8:11], v[128:131]
    v_cvt_pk_bf16_f32 v51, v150, v151
    v_cvt_pk_bf16_f32 v52, v152, v153
    v_mfma_f32_16x16x32_bf16 v[132:135], a[224:227], a[12:15], v[132:135]
    v_cvt_pk_bf16_f32 v53, v154, v155
    v_cvt_pk_bf16_f32 v54, v156, v157
    v_mfma_f32_16x16x32_bf16 v[136:139], a[224:227], a[16:19], v[136:139]
    v_cvt_pk_bf16_f32 v55, v158, v159
    v_cvt_pk_bf16_f32 v56, v160, v161
    v_mfma_f32_16x16x32_bf16 v[140:143], a[224:227], a[20:23], v[140:143]
    v_cvt_pk_bf16_f32 v57, v162, v163
    v_cvt_pk_bf16_f32 v58, v164, v165
    v_mfma_f32_16x16x32_bf16 v[144:147], a[224:227], a[24:27], v[144:147]
    s_add_u32 s53, s5, 3
    s_and_b32 s53, s53, 7
    s_waitcnt lgkmcnt(2)
    v_mfma_f32_16x16x32_bf16 v[120:123], a[228:231], a[28:31], v[120:123]
    s_lshl_b32 s53, s53, 9
    s_add_u32 s53, s53, s63
    s_waitcnt vmcnt(9)
    v_mfma_f32_16x16x32_bf16 v[124:127], a[228:231], a[32:35], v[124:127]
    buffer_store_dword v202, v200, s[24:27], s53 offen offset:12 sc1
    v_mfma_f32_16x16x32_bf16 v[128:131], a[228:231], a[36:39], v[128:131]
    v_cvt_pk_bf16_f32 v59, v166, v167
    v_cvt_pk_bf16_f32 v60, v168, v169
    v_mfma_f32_16x16x32_bf16 v[132:135], a[228:231], a[40:43], v[132:135]
    ds_read_b64_tr_b16 a[236:237], v192 offset:45056
    ds_read_b64_tr_b16 a[238:239], v192 offset:47104
    v_mfma_f32_16x16x32_bf16 v[136:139], a[228:231], a[44:47], v[136:139]
    v_cvt_pk_bf16_f32 v61, v170, v171
    v_cvt_pk_bf16_f32 v62, v172, v173
    v_mfma_f32_16x16x32_bf16 v[140:143], a[228:231], a[48:51], v[140:143]
    s_add_u32 s56, s5, 4
    s_and_b32 s56, s56, 7
    s_lshl_b32 s56, s56, 17
    s_add_u32 s56, s56, s61
    s_lshr_b32 s57, s56, 17
    s_mul_i32 s57, s57, 0x9e3779b1
    s_lshr_b32 s57, s57, 15
    s_and_b32 s57, s57, 0x1c000
    s_xor_b32 s56, s56, s57
    s_xor_b32 s56, s56, 65536
    v_mfma_f32_16x16x32_bf16 v[144:147], a[228:231], a[52:55], v[144:147]
    v_cvt_pk_bf16_f32 v63, v174, v175
    s_waitcnt lgkmcnt(2)
    v_mfma_f32_16x16x32_bf16 v[120:123], a[232:235], a[56:59], v[120:123]
    buffer_store_dwordx4 v[50:53], v4, s[24:27], s56 offen offset:0 sc1
    v_mfma_f32_16x16x32_bf16 v[124:127], a[232:235], a[60:63], v[124:127]
    buffer_store_dwordx4 v[54:57], v4, s[24:27], s56 offen offset:1024 sc1
    v_mfma_f32_16x16x32_bf16 v[128:131], a[232:235], a[64:67], v[128:131]
    ds_read_b64_tr_b16 a[240:241], v192 offset:49152
    ds_read_b64_tr_b16 a[242:243], v192 offset:51200
    v_mfma_f32_16x16x32_bf16 v[132:135], a[232:235], a[68:71], v[132:135]
    buffer_store_dwordx4 v[58:61], v4, s[24:27], s56 offen offset:2048 sc1
    v_mfma_f32_16x16x32_bf16 v[136:139], a[232:235], a[72:75], v[136:139]
    v_mfma_f32_16x16x32_bf16 v[140:143], a[232:235], a[76:79], v[140:143]
    buffer_store_dwordx2 v[62:63], v198, s[24:27], s56 offen offset:3072 sc1
    v_mfma_f32_16x16x32_bf16 v[144:147], a[232:235], a[80:83], v[144:147]
    s_waitcnt lgkmcnt(2)
    v_mfma_f32_16x16x32_bf16 v[120:123], a[236:239], a[84:87], v[120:123]
    ds_read_b64_tr_b16 a[244:245], v192 offset:53248
    ds_read_b64_tr_b16 a[246:247], v192 offset:55296
    v_mfma_f32_16x16x32_bf16 v[124:127], a[236:239], a[88:91], v[124:127]
    v_mfma_f32_16x16x32_bf16 v[128:131], a[236:239], a[92:95], v[128:131]
    v_mfma_f32_16x16x32_bf16 v[132:135], a[236:239], a[96:99], v[132:135]
    v_mfma_f32_16x16x32_bf16 v[136:139], a[236:239], a[100:103], v[136:139]
    v_mfma_f32_16x16x32_bf16 v[140:143], a[236:239], a[104:107], v[140:143]
    s_waitcnt vmcnt(10)
    v_readlane_b32 s52, v201, 1
    s_xor_b32 s54, s62, 16384
    v_mfma_f32_16x16x32_bf16 v[144:147], a[236:239], a[108:111], v[144:147]
    s_cmp_eq_u32 s52, 1
    s_cbranch_scc0 L_spin1
L_got1:
    s_waitcnt lgkmcnt(2)
    v_mfma_f32_16x16x32_bf16 v[120:123], a[240:243], a[112:115], v[120:123]
    ds_read_b64_tr_b16 a[248:249], v192 offset:57344
    ds_read_b64_tr_b16 a[250:251], v192 offset:59392
    v_mfma_f32_16x16x32_bf16 v[124:127], a[240:243], a[116:119], v[124:127]
    buffer_load_dwordx4 v[8:11], v4, s[24:27], s54 offen offset:0 sc1
    v_mfma_f32_16x16x32_bf16 v[128:131], a[240:243], a[120:123], v[128:131]
    s_add_u32 m0, s65, 65536
    s_add_u32 s58, s44, 7
    s_and_b32 s58, s58, 7
    v_mfma_f32_16x16x32_bf16 v[132:135], a[240:243], a[124:127], v[132:135]
    s_lshl_b32 s58, s58, 7
    s_add_u32 s58, s58, 262144
    v_mfma_f32_16x16x32_bf16 v[136:139], a[240:243], a[128:131], v[136:139]
    buffer_load_dwordx4 v197, s[20:23], s58 offen offset:0 lds
    v_mfma_f32_16x16x32_bf16 v[140:143], a[240:243], a[132:135], v[140:143]
    buffer_load_dwordx4 v[12:15], v4, s[24:27], s54 offen offset:1024 sc1
    v_mfma_f32_16x16x32_bf16 v[144:147], a[240:243], a[136:139], v[144:147]
    s_addk_i32 s58, 7168
    s_waitcnt lgkmcnt(2)
    v_mfma_f32_16x16x32_bf16 v[120:123], a[244:247], a[140:143], v[120:123]
    buffer_load_dwordx4 v197, s[20:23], s58 offen offset:1024 lds
    v_mfma_f32_16x16x32_bf16 v[124:127], a[244:247], a[144:147], v[124:127]
    ds_read_b64_tr_b16 a[252:253], v192 offset:61440
    ds_read_b64_tr_b16 a[254:255], v192 offset:63488
    v_mfma_f32_16x16x32_bf16 v[128:131], a[244:247], a[148:151], v[128:131]
    buffer_load_dwordx4 v[16:19], v4, s[24:27], s54 offen offset:2048 sc1
    v_mfma_f32_16x16x32_bf16 v[132:135], a[244:247], a[152:155], v[132:135]
    s_addk_i32 s58, 7168
    v_mfma_f32_16x16x32_bf16 v[136:139], a[244:247], a[156:159], v[136:139]
    buffer_load_dwordx4 v197, s[20:23], s58 offen offset:2048 lds
    v_mfma_f32_16x16x32_bf16 v[140:143], a[244:247], a[160:163], v[140:143]
    buffer_load_dwordx2 v[20:21], v198, s[24:27], s54 offen offset:3072 sc1
    v_mfma_f32_16x16x32_bf16 v[144:147], a[244:247], a[164:167], v[144:147]
    s_waitcnt lgkmcnt(2)
    v_mfma_f32_16x16x32_bf16 v[120:123], a[248:251], a[168:171], v[120:123]
    buffer_load_dword v201, v199, s[24:27], s64 offen sc1
    v_mfma_f32_16x16x32_bf16 v[124:127], a[248:251], a[172:175], v[124:127]
    s_addk_i32 s58, 7168
    v_mfma_f32_16x16x32_bf16 v[128:131], a[248:251], a[176:179], v[128:131]
    buffer_load_dwordx4 v197, s[20:23], s58 offen offset:3072 lds
    v_mfma_f32_16x16x32_bf16 v[132:135], a[248:251], a[180:183], v[132:135]
    s_waitcnt vmcnt(18)
    s_barrier
    ds_read_b64_tr_b16 a[224:225], v194 offset:0
    v_mfma_f32_16x16x32_bf16 v[136:139], a[248:251], a[184:187], v[136:139]
    ds_read_b64_tr_b16 a[226:227], v194 offset:2048
    s_add_u32 m0, s65, 81920
    v_mfma_f32_16x16x32_bf16 v[140:143], a[248:251], a[188:191], v[140:143]
    s_add_u32 s58, s44, 7
    s_and_b32 s58, s58, 7
    s_lshl_b32 s58, s58, 7
    s_add_u32 s58, s58, 327680
    buffer_load_dwordx4 v197, s[20:23], s58 offen offset:0 lds
    v_mfma_f32_16x16x32_bf16 v[144:147], a[248:251], a[192:195], v[144:147]
    s_addk_i32 s58, 7168
    s_waitcnt lgkmcnt(2)
    v_mfma_f32_16x16x32_bf16 v[120:123], a[252:255], a[196:199], v[120:123]
    buffer_load_dwordx4 v197, s[20:23], s58 offen offset:1024 lds
    v_mfma_f32_16x16x32_bf16 v[124:127], a[252:255], a[200:203], v[124:127]
    s_addk_i32 s58, 7168
    v_mfma_f32_16x16x32_bf16 v[128:131], a[252:255], a[204:207], v[128:131]
    buffer_load_dwordx4 v197, s[20:23], s58 offen offset:2048 lds
    v_mfma_f32_16x16x32_bf16 v[132:135], a[252:255], a[208:211], v[132:135]
    ds_read_b64_tr_b16 a[228:229], v194 offset:4096
    ds_read_b64_tr_b16 a[230:231], v194 offset:6144
    v_mfma_f32_16x16x32_bf16 v[136:139], a[252:255], a[212:215], v[136:139]
    s_addk_i32 s58, 7168
    v_mfma_f32_16x16x32_bf16 v[140:143], a[252:255], a[216:219], v[140:143]
    buffer_load_dwordx4 v197, s[20:23], s58 offen offset:3072 lds
    v_mfma_f32_16x16x32_bf16 v[144:147], a[252:255], a[220:223], v[144:147]
    v_mfma_f32_4x4x4_16b_bf16 v[148:151], v[204:205], v[78:79], 0
    v_mfma_f32_4x4x4_16b_bf16 v[152:155], v[204:205], v[80:81], 0
    v_mfma_f32_4x4x4_16b_bf16 v[156:159], v[204:205], v[82:83], 0
    v_mfma_f32_4x4x4_16b_bf16 v[160:163], v[204:205], v[84:85], 0
    v_mfma_f32_4x4x4_16b_bf16 v[164:167], v[204:205], v[86:87], 0
    v_mfma_f32_4x4x4_16b_bf16 v[168:171], v[204:205], v[88:89], 0
    v_mfma_f32_4x4x4_16b_bf16 v[172:175], v[204:205], v[90:91], 0
    s_waitcnt lgkmcnt(2)
    v_mfma_f32_16x16x32_bf16 v[148:151], a[224:227], a[0:3], v[148:151]
    s_waitcnt vmcnt(18)
    s_barrier
    ds_read_b64_tr_b16 a[232:233], v194 offset:8192
    v_mfma_f32_16x16x32_bf16 v[152:155], a[224:227], a[4:7], v[152:155]
    ds_read_b64_tr_b16 a[234:235], v194 offset:10240
    v_cvt_pk_bf16_f32 v64, v120, v121
    v_mfma_f32_16x16x32_bf16 v[156:159], a[224:227], a[8:11], v[156:159]
    v_cvt_pk_bf16_f32 v65, v122, v123
    v_cvt_pk_bf16_f32 v66, v124, v125
    v_mfma_f32_16x16x32_bf16 v[160:163], a[224:227], a[12:15], v[160:163]
    v_cvt_pk_bf16_f32 v67, v126, v127
    v_cvt_pk_bf16_f32 v68, v128, v129
    v_mfma_f32_16x16x32_bf16 v[164:167], a[224:227], a[16:19], v[164:167]
    v_cvt_pk_bf16_f32 v69, v130, v131
    v_cvt_pk_bf16_f32 v70, v132, v133
    v_mfma_f32_16x16x32_bf16 v[168:171], a[224:227], a[20:23], v[168:171]
    v_cvt_pk_bf16_f32 v71, v134, v135
    v_cvt_pk_bf16_f32 v72, v136, v137
    v_mfma_f32_16x16x32_bf16 v[172:175], a[224:227], a[24:27], v[172:175]
    s_add_u32 s53, s5, 4
    s_and_b32 s53, s53, 7
    s_waitcnt lgkmcnt(2)
    v_mfma_f32_16x16x32_bf16 v[148:151], a[228:231], a[28:31], v[148:151]
    s_lshl_b32 s53, s53, 9
    s_add_u32 s53, s53, s63
    s_waitcnt vmcnt(13)
    v_mfma_f32_16x16x32_bf16 v[152:155], a[228:231], a[32:35], v[152:155]
    buffer_store_dword v202, v200, s[24:27], s53 offen offset:16 sc1
    v_mfma_f32_16x16x32_bf16 v[156:159], a[228:231], a[36:39], v[156:159]
    v_cvt_pk_bf16_f32 v73, v138, v139
    v_cvt_pk_bf16_f32 v74, v140, v141
    v_mfma_f32_16x16x32_bf16 v[160:163], a[228:231], a[40:43], v[160:163]
    ds_read_b64_tr_b16 a[236:237], v194 offset:12288
    ds_read_b64_tr_b16 a[238:239], v194 offset:14336
    v_mfma_f32_16x16x32_bf16 v[164:167], a[228:231], a[44:47], v[164:167]
    v_cvt_pk_bf16_f32 v75, v142, v143
    v_cvt_pk_bf16_f32 v76, v144, v145
    v_mfma_f32_16x16x32_bf16 v[168:171], a[228:231], a[48:51], v[168:171]
    s_add_u32 s56, s5, 5
    s_and_b32 s56, s56, 7
    s_lshl_b32 s56, s56, 17
    s_add_u32 s56, s56, s61
    s_lshr_b32 s57, s56, 17
    s_mul_i32 s57, s57, 0x9e3779b1
    s_lshr_b32 s57, s57, 15
    s_and_b32 s57, s57, 0x1c000
    s_xor_b32 s56, s56, s57
    s_xor_b32 s56, s56, 81920
    v_mfma_f32_16x16x32_bf16 v[172:175], a[228:231], a[52:55], v[172:175]
    v_cvt_pk_bf16_f32 v77, v146, v147
    s_waitcnt lgkmcnt(2)
    v_mfma_f32_16x16x32_bf16 v[148:151], a[232:235], a[56:59], v[148:151]
    buffer_store_dwordx4 v[64:67], v4, s[24:27], s56 offen offset:0 sc1
    v_mfma_f32_16x16x32_bf16 v[152:155], a[232:235], a[60:63], v[152:155]
    buffer_store_dwordx4 v[68:71], v4, s[24:27], s56 offen offset:1024 sc1
    v_mfma_f32_16x16x32_bf16 v[156:159], a[232:235], a[64:67], v[156:159]
    ds_read_b64_tr_b16 a[240:241], v194 offset:16384
    ds_read_b64_tr_b16 a[242:243], v194 offset:18432
    v_mfma_f32_16x16x32_bf16 v[160:163], a[232:235], a[68:71], v[160:163]
    buffer_store_dwordx4 v[72:75], v4, s[24:27], s56 offen offset:2048 sc1
    v_mfma_f32_16x16x32_bf16 v[164:167], a[232:235], a[72:75], v[164:167]
    v_mfma_f32_16x16x32_bf16 v[168:171], a[232:235], a[76:79], v[168:171]
    buffer_store_dwordx2 v[76:77], v198, s[24:27], s56 offen offset:3072 sc1
    v_mfma_f32_16x16x32_bf16 v[172:175], a[232:235], a[80:83], v[172:175]
    s_waitcnt lgkmcnt(2)
    v_mfma_f32_16x16x32_bf16 v[148:151], a[236:239], a[84:87], v[148:151]
    ds_read_b64_tr_b16 a[244:245], v194 offset:20480
    ds_read_b64_tr_b16 a[246:247], v194 offset:22528
    v_mfma_f32_16x16x32_bf16 v[152:155], a[236:239], a[88:91], v[152:155]
    v_mfma_f32_16x16x32_bf16 v[156:159], a[236:239], a[92:95], v[156:159]
    v_mfma_f32_16x16x32_bf16 v[160:163], a[236:239], a[96:99], v[160:163]
    v_mfma_f32_16x16x32_bf16 v[164:167], a[236:239], a[100:103], v[164:167]
    v_mfma_f32_16x16x32_bf16 v[168:171], a[236:239], a[104:107], v[168:171]
    s_waitcnt vmcnt(10)
    v_readlane_b32 s52, v201, 2
    s_xor_b32 s54, s62, 32768
    v_mfma_f32_16x16x32_bf16 v[172:175], a[236:239], a[108:111], v[172:175]
    s_cmp_eq_u32 s52, 1
    s_cbranch_scc0 L_spin2
L_got2:
    s_waitcnt lgkmcnt(2)
    v_mfma_f32_16x16x32_bf16 v[148:151], a[240:243], a[112:115], v[148:151]
    ds_read_b64_tr_b16 a[248:249], v194 offset:24576
    ds_read_b64_tr_b16 a[250:251], v194 offset:26624
    v_mfma_f32_16x16x32_bf16 v[152:155], a[240:243], a[116:119], v[152:155]
    buffer_load_dwordx4 v[22:25], v4, s[24:27], s54 offen offset:0 sc1
    v_mfma_f32_16x16x32_bf16 v[156:159], a[240:243], a[120:123], v[156:159]
    s_add_u32 m0, s65, 98304
    s_add_u32 s58, s44, 8
    s_and_b32 s58, s58, 7
    v_mfma_f32_16x16x32_bf16 v[160:163], a[240:243], a[124:127], v[160:163]
    s_lshl_b32 s58, s58, 7
    s_add_u32 s58, s58, 262144
    v_mfma_f32_16x16x32_bf16 v[164:167], a[240:243], a[128:131], v[164:167]
    buffer_load_dwordx4 v197, s[20:23], s58 offen offset:0 lds
    v_mfma_f32_16x16x32_bf16 v[168:171], a[240:243], a[132:135], v[168:171]
    buffer_load_dwordx4 v[26:29], v4, s[24:27], s54 offen offset:1024 sc1
    v_mfma_f32_16x16x32_bf16 v[172:175], a[240:243], a[136:139], v[172:175]
    s_addk_i32 s58, 7168
    s_waitcnt lgkmcnt(2)
    v_mfma_f32_16x16x32_bf16 v[148:151], a[244:247], a[140:143], v[148:151]
    buffer_load_dwordx4 v197, s[20:23], s58 offen offset:1024 lds
    v_mfma_f32_16x16x32_bf16 v[152:155], a[244:247], a[144:147], v[152:155]
    ds_read_b64_tr_b16 a[252:253], v194 offset:28672
    ds_read_b64_tr_b16 a[254:255], v194 offset:30720
    v_mfma_f32_16x16x32_bf16 v[156:159], a[244:247], a[148:151], v[156:159]
    buffer_load_dwordx4 v[30:33], v4, s[24:27], s54 offen offset:2048 sc1
    v_mfma_f32_16x16x32_bf16 v[160:163], a[244:247], a[152:155], v[160:163]
    s_addk_i32 s58, 7168
    v_mfma_f32_16x16x32_bf16 v[164:167], a[244:247], a[156:159], v[164:167]
    buffer_load_dwordx4 v197, s[20:23], s58 offen offset:2048 lds
    v_mfma_f32_16x16x32_bf16 v[168:171], a[244:247], a[160:163], v[168:171]
    buffer_load_dwordx2 v[34:35], v198, s[24:27], s54 offen offset:3072 sc1
    v_mfma_f32_16x16x32_bf16 v[172:175], a[244:247], a[164:167], v[172:175]
    s_waitcnt lgkmcnt(2)
    v_mfma_f32_16x16x32_bf16 v[148:151], a[248:251], a[168:171], v[148:151]
    buffer_load_dword v201, v199, s[24:27], s64 offen sc1
    v_mfma_f32_16x16x32_bf16 v[152:155], a[248:251], a[172:175], v[152:155]
    s_addk_i32 s58, 7168
    v_mfma_f32_16x16x32_bf16 v[156:159], a[248:251], a[176:179], v[156:159]
    buffer_load_dwordx4 v197, s[20:23], s58 offen offset:3072 lds
    v_mfma_f32_16x16x32_bf16 v[160:163], a[248:251], a[180:183], v[160:163]
    s_waitcnt vmcnt(14)
    s_barrier
    ds_read_b64_tr_b16 a[224:225], v193 offset:0
    v_mfma_f32_16x16x32_bf16 v[164:167], a[248:251], a[184:187], v[164:167]
    ds_read_b64_tr_b16 a[226:227], v193 offset:2048
    s_add_u32 m0, s65, 114688
    v_mfma_f32_16x16x32_bf16 v[168:171], a[248:251], a[188:191], v[168:171]
    s_add_u32 s58, s44, 8
    s_and_b32 s58, s58, 7
    s_lshl_b32 s58, s58, 7
    s_add_u32 s58, s58, 327680
    buffer_load_dwordx4 v197, s[20:23], s58 offen offset:0 lds
    v_mfma_f32_16x16x32_bf16 v[172:175], a[248:251], a[192:195], v[172:175]
    s_addk_i32 s58, 7168
    s_waitcnt lgkmcnt(2)
    v_mfma_f32_16x16x32_bf16 v[148:151], a[252:255], a[196:199], v[148:151]
    buffer_load_dwordx4 v197, s[20:23], s58 offen offset:1024 lds
    v_mfma_f32_16x16x32_bf16 v[152:155], a[252:255], a[200:203], v[152:155]
    s_addk_i32 s58, 7168
    v_mfma_f32_16x16x32_bf16 v[156:159], a[252:255], a[204:207], v[156:159]
    buffer_load_dwordx4 v197, s[20:23], s58 offen offset:2048 lds
    v_mfma_f32_16x16x32_bf16 v[160:163], a[252:255], a[208:211], v[160:163]
    ds_read_b64_tr_b16 a[228:229], v193 offset:4096
    ds_read_b64_tr_b16 a[230:231], v193 offset:6144
    v_mfma_f32_16x16x32_bf16 v[164:167], a[252:255], a[212:215], v[164:167]
    s_addk_i32 s58, 7168
    v_mfma_f32_16x16x32_bf16 v[168:171], a[252:255], a[216:219], v[168:171]
    buffer_load_dwordx4 v197, s[20:23], s58 offen offset:3072 lds
    v_mfma_f32_16x16x32_bf16 v[172:175], a[252:255], a[220:223], v[172:175]
    v_mfma_f32_4x4x4_16b_bf16 v[120:123], v[204:205], v[92:93], 0
    v_mfma_f32_4x4x4_16b_bf16 v[124:127], v[204:205], v[94:95], 0
    v_mfma_f32_4x4x4_16b_bf16 v[128:131], v[204:205], v[96:97], 0
    v_mfma_f32_4x4x4_16b_bf16 v[132:135], v[204:205], v[98:99], 0
    v_mfma_f32_4x4x4_16b_bf16 v[136:139], v[204:205], v[100:101], 0
    v_mfma_f32_4x4x4_16b_bf16 v[140:143], v[204:205], v[102:103], 0
    v_mfma_f32_4x4x4_16b_bf16 v[144:147], v[204:205], v[104:105], 0
    s_waitcnt lgkmcnt(2)
    v_mfma_f32_16x16x32_bf16 v[120:123], a[224:227], a[0:3], v[120:123]
    ds_read_b64_tr_b16 a[232:233], v193 offset:8192
    ds_read_b64_tr_b16 a[234:235], v193 offset:10240
    v_mfma_f32_16x16x32_bf16 v[124:127], a[224:227], a[4:7], v[124:127]
    v_cvt_pk_bf16_f32 v78, v148, v149
    v_cvt_pk_bf16_f32 v79, v150, v151
    v_mfma_f32_16x16x32_bf16 v[128:131], a[224:227], a[8:11], v[128:131]
    v_cvt_pk_bf16_f32 v80, v152, v153
    v_cvt_pk_bf16_f32 v81, v154, v155
    v_mfma_f32_16x16x32_bf16 v[132:135], a[224:227], a[12:15], v[132:135]
    v_cvt_pk_bf16_f32 v82, v156, v157
    v_cvt_pk_bf16_f32 v83, v158, v159
    v_mfma_f32_16x16x32_bf16 v[136:139], a[224:227], a[16:19], v[136:139]
    v_cvt_pk_bf16_f32 v84, v160, v161
    v_mfma_f32_16x16x32_bf16 v[140:143], a[224:227], a[20:23], v[140:143]
    v_cvt_pk_bf16_f32 v85, v162, v163
    v_cvt_pk_bf16_f32 v86, v164, v165
    v_mfma_f32_16x16x32_bf16 v[144:147], a[224:227], a[24:27], v[144:147]
    s_add_u32 s53, s5, 5
    s_and_b32 s53, s53, 7
    s_waitcnt lgkmcnt(2)
    v_mfma_f32_16x16x32_bf16 v[120:123], a[228:231], a[28:31], v[120:123]
    s_lshl_b32 s53, s53, 9
    s_add_u32 s53, s53, s63
    s_waitcnt vmcnt(13)
    v_mfma_f32_16x16x32_bf16 v[124:127], a[228:231], a[32:35], v[124:127]
    buffer_store_dword v202, v200, s[24:27], s53 offen offset:20 sc1
    v_mfma_f32_16x16x32_bf16 v[128:131], a[228:231], a[36:39], v[128:131]
    v_cvt_pk_bf16_f32 v87, v166, v167
    v_cvt_pk_bf16_f32 v88, v168, v169
    v_mfma_f32_16x16x32_bf16 v[132:135], a[228:231], a[40:43], v[132:135]
    ds_read_b64_tr_b16 a[236:237], v193 offset:12288
    ds_read_b64_tr_b16 a[238:239], v193 offset:14336
    v_mfma_f32_16x16x32_bf16 v[136:139], a[228:231], a[44:47], v[136:139]
    v_cvt_pk_bf16_f32 v89, v170, v171
    v_cvt_pk_bf16_f32 v90, v172, v173
    v_mfma_f32_16x16x32_bf16 v[140:143], a[228:231], a[48:51], v[140:143]
    s_add_u32 s56, s5, 6
    s_and_b32 s56, s56, 7
    s_lshl_b32 s56, s56, 17
    s_add_u32 s56, s56, s61
    s_lshr_b32 s57, s56, 17
    s_mul_i32 s57, s57, 0x9e3779b1
    s_lshr_b32 s57, s57, 15
    s_and_b32 s57, s57, 0x1c000
    s_xor_b32 s56, s56, s57
    s_xor_b32 s56, s56, 98304
    v_mfma_f32_16x16x32_bf16 v[144:147], a[228:231], a[52:55], v[144:147]
    v_cvt_pk_bf16_f32 v91, v174, v175
    s_waitcnt lgkmcnt(2)
    v_mfma_f32_16x16x32_bf16 v[120:123], a[232:235], a[56:59], v[120:123]
    buffer_store_dwordx4 v[78:81], v4, s[24:27], s56 offen offset:0 sc1
    v_mfma_f32_16x16x32_bf16 v[124:127], a[232:235], a[60:63], v[124:127]
    buffer_store_dwordx4 v[82:85], v4, s[24:27], s56 offen offset:1024 sc1
    v_mfma_f32_16x16x32_bf16 v[128:131], a[232:235], a[64:67], v[128:131]
    ds_read_b64_tr_b16 a[240:241], v193 offset:16384
    ds_read_b64_tr_b16 a[242:243], v193 offset:18432
    v_mfma_f32_16x16x32_bf16 v[132:135], a[232:235], a[68:71], v[132:135]
    buffer_store_dwordx4 v[86:89], v4, s[24:27], s56 offen offset:2048 sc1
    v_mfma_f32_16x16x32_bf16 v[136:139], a[232:235], a[72:75], v[136:139]
    v_mfma_f32_16x16x32_bf16 v[140:143], a[232:235], a[76:79], v[140:143]
    buffer_store_dwordx2 v[90:91], v198, s[24:27], s56 offen offset:3072 sc1
    v_mfma_f32_16x16x32_bf16 v[144:147], a[232:235], a[80:83], v[144:147]
    s_waitcnt lgkmcnt(2)
    v_mfma_f32_16x16x32_bf16 v[120:123], a[236:239], a[84:87], v[120:123]
    ds_read_b64_tr_b16 a[244:245], v193 offset:20480
    ds_read_b64_tr_b16 a[246:247], v193 offset:22528
    v_mfma_f32_16x16x32_bf16 v[124:127], a[236:239], a[88:91], v[124:127]
    v_mfma_f32_16x16x32_bf16 v[128:131], a[236:239], a[92:95], v[128:131]
    v_mfma_f32_16x16x32_bf16 v[132:135], a[236:239], a[96:99], v[132:135]
    v_mfma_f32_16x16x32_bf16 v[136:139], a[236:239], a[100:103], v[136:139]
    v_mfma_f32_16x16x32_bf16 v[140:143], a[236:239], a[104:107], v[140:143]
    s_waitcnt vmcnt(10)
    v_readlane_b32 s52, v201, 3
    s_xor_b32 s54, s62, 49152
    v_mfma_f32_16x16x32_bf16 v[144:147], a[236:239], a[108:111], v[144:147]
    s_cmp_eq_u32 s52, 1
    s_cbranch_scc0 L_spin3
L_got3:
    s_waitcnt lgkmcnt(2)
    v_mfma_f32_16x16x32_bf16 v[120:123], a[240:243], a[112:115], v[120:123]
    ds_read_b64_tr_b16 a[248:249], v193 offset:24576
    ds_read_b64_tr_b16 a[250:251], v193 offset:26624
    v_mfma_f32_16x16x32_bf16 v[124:127], a[240:243], a[116:119], v[124:127]
    buffer_load_dwordx4 v[36:39], v4, s[24:27], s54 offen offset:0 sc1
    v_mfma_f32_16x16x32_bf16 v[128:131], a[240:243], a[120:123], v[128:131]
    v_mfma_f32_16x16x32_bf16 v[132:135], a[240:243], a[124:127], v[132:135]
    v_mfma_f32_16x16x32_bf16 v[136:139], a[240:243], a[128:131], v[136:139]
    buffer_load_dwordx4 v[40:43], v4, s[24:27], s54 offen offset:1024 sc1
    v_mfma_f32_16x16x32_bf16 v[140:143], a[240:243], a[132:135], v[140:143]
    v_mfma_f32_16x16x32_bf16 v[144:147], a[240:243], a[136:139], v[144:147]
    s_waitcnt lgkmcnt(2)
    v_mfma_f32_16x16x32_bf16 v[120:123], a[244:247], a[140:143], v[120:123]
    ds_read_b64_tr_b16 a[252:253], v193 offset:28672
    ds_read_b64_tr_b16 a[254:255], v193 offset:30720
    v_mfma_f32_16x16x32_bf16 v[124:127], a[244:247], a[144:147], v[124:127]
    buffer_load_dwordx4 v[44:47], v4, s[24:27], s54 offen offset:2048 sc1
    v_mfma_f32_16x16x32_bf16 v[128:131], a[244:247], a[148:151], v[128:131]
    v_mfma_f32_16x16x32_bf16 v[132:135], a[244:247], a[152:155], v[132:135]
    buffer_load_dwordx2 v[48:49], v198, s[24:27], s54 offen offset:3072 sc1
    v_mfma_f32_16x16x32_bf16 v[136:139], a[244:247], a[156:159], v[136:139]
    buffer_load_dword v201, v199, s[24:27], s64 offen sc1
    v_mfma_f32_16x16x32_bf16 v[140:143], a[244:247], a[160:163], v[140:143]
    v_mfma_f32_16x16x32_bf16 v[144:147], a[244:247], a[164:167], v[144:147]
    s_waitcnt lgkmcnt(2)
    v_mfma_f32_16x16x32_bf16 v[120:123], a[248:251], a[168:171], v[120:123]
    s_waitcnt vmcnt(10)
    s_barrier
    ds_read_b64_tr_b16 a[224:225], v193 offset:32768
    v_mfma_f32_16x16x32_bf16 v[124:127], a[248:251], a[172:175], v[124:127]
    ds_read_b64_tr_b16 a[226:227], v193 offset:34816
    v_mfma_f32_16x16x32_bf16 v[128:131], a[248:251], a[176:179], v[128:131]
    v_mfma_f32_16x16x32_bf16 v[132:135], a[248:251], a[180:183], v[132:135]
    v_mfma_f32_16x16x32_bf16 v[136:139], a[248:251], a[184:187], v[136:139]
    v_mfma_f32_16x16x32_bf16 v[140:143], a[248:251], a[188:191], v[140:143]
    v_mfma_f32_16x16x32_bf16 v[144:147], a[248:251], a[192:195], v[144:147]
    s_waitcnt lgkmcnt(2)
    v_mfma_f32_16x16x32_bf16 v[120:123], a[252:255], a[196:199], v[120:123]
    ds_read_b64_tr_b16 a[228:229], v193 offset:36864
    ds_read_b64_tr_b16 a[230:231], v193 offset:38912
    v_mfma_f32_16x16x32_bf16 v[124:127], a[252:255], a[200:203], v[124:127]
    v_mfma_f32_16x16x32_bf16 v[128:131], a[252:255], a[204:207], v[128:131]
    v_mfma_f32_16x16x32_bf16 v[132:135], a[252:255], a[208:211], v[132:135]
    v_mfma_f32_16x16x32_bf16 v[136:139], a[252:255], a[212:215], v[136:139]
    v_mfma_f32_16x16x32_bf16 v[140:143], a[252:255], a[216:219], v[140:143]
    v_mfma_f32_16x16x32_bf16 v[144:147], a[252:255], a[220:223], v[144:147]
    v_mfma_f32_4x4x4_16b_bf16 v[148:151], v[204:205], v[106:107], 0
    v_mfma_f32_4x4x4_16b_bf16 v[152:155], v[204:205], v[108:109], 0
    v_mfma_f32_4x4x4_16b_bf16 v[156:159], v[204:205], v[110:111], 0
    v_mfma_f32_4x4x4_16b_bf16 v[160:163], v[204:205], v[112:113], 0
    v_mfma_f32_4x4x4_16b_bf16 v[164:167], v[204:205], v[114:115], 0
    v_mfma_f32_4x4x4_16b_bf16 v[168:171], v[204:205], v[116:117], 0
    v_mfma_f32_4x4x4_16b_bf16 v[172:175], v[204:205], v[118:119], 0
    s_waitcnt lgkmcnt(2)
    v_mfma_f32_16x16x32_bf16 v[148:151], a[224:227], a[0:3], v[148:151]
    ds_read_b64_tr_b16 a[232:233], v193 offset:40960
    ds_read_b64_tr_b16 a[234:235], v193 offset:43008
    v_mfma_f32_16x16x32_bf16 v[152:155], a[224:227], a[4:7], v[152:155]
    v_cvt_pk_bf16_f32 v92, v120, v121
    v_cvt_pk_bf16_f32 v93, v122, v123
    v_mfma_f32_16x16x32_bf16 v[156:159], a[224:227], a[8:11], v[156:159]
    v_cvt_pk_bf16_f32 v94, v124, v125
    v_cvt_pk_bf16_f32 v95, v126, v127
    v_mfma_f32_16x16x32_bf16 v[160:163], a[224:227], a[12:15], v[160:163]
    v_cvt_pk_bf16_f32 v96, v128, v129
    v_cvt_pk_bf16_f32 v97, v130, v131
    v_mfma_f32_16x16x32_bf16 v[164:167], a[224:227], a[16:19], v[164:167]
    v_cvt_pk_bf16_f32 v98, v132, v133
    v_mfma_f32_16x16x32_bf16 v[168:171], a[224:227], a[20:23], v[168:171]
    v_cvt_pk_bf16_f32 v99, v134, v135
    v_cvt_pk_bf16_f32 v100, v136, v137
    v_mfma_f32_16x16x32_bf16 v[172:175], a[224:227], a[24:27], v[172:175]
    s_add_u32 s53, s5, 6
    s_and_b32 s53, s53, 7
    s_waitcnt lgkmcnt(2)
    v_mfma_f32_16x16x32_bf16 v[148:151], a[228:231], a[28:31], v[148:151]
    s_lshl_b32 s53, s53, 9
    s_add_u32 s53, s53, s63
    s_waitcnt vmcnt(5)
    v_mfma_f32_16x16x32_bf16 v[152:155], a[228:231], a[32:35], v[152:155]
    buffer_store_dword v202, v200, s[24:27], s53 offen offset:24 sc1
    v_mfma_f32_16x16x32_bf16 v[156:159], a[228:231], a[36:39], v[156:159]
    v_cvt_pk_bf16_f32 v101, v138, v139
    v_cvt_pk_bf16_f32 v102, v140, v141
    v_mfma_f32_16x16x32_bf16 v[160:163], a[228:231], a[40:43], v[160:163]
    ds_read_b64_tr_b16 a[236:237], v193 offset:45056
    ds_read_b64_tr_b16 a[238:239], v193 offset:47104
    v_mfma_f32_16x16x32_bf16 v[164:167], a[228:231], a[44:47], v[164:167]
    v_cvt_pk_bf16_f32 v103, v142, v143
    v_cvt_pk_bf16_f32 v104, v144, v145
    v_mfma_f32_16x16x32_bf16 v[168:171], a[228:231], a[48:51], v[168:171]
    s_add_u32 s56, s5, 7
    s_and_b32 s56, s56, 7
    s_lshl_b32 s56, s56, 17
    s_add_u32 s56, s56, s61
    s_lshr_b32 s57, s56, 17
    s_mul_i32 s57, s57, 0x9e3779b1
    s_lshr_b32 s57, s57, 15
    s_and_b32 s57, s57, 0x1c000
    s_xor_b32 s56, s56, s57
    s_xor_b32 s56, s56, 114688
    v_mfma_f32_16x16x32_bf16 v[172:175], a[228:231], a[52:55], v[172:175]
    v_cvt_pk_bf16_f32 v105, v146, v147
    s_waitcnt lgkmcnt(2)
    v_mfma_f32_16x16x32_bf16 v[148:151], a[232:235], a[56:59], v[148:151]
    buffer_store_dwordx4 v[92:95], v4, s[24:27], s56 offen offset:0 sc1
    v_mfma_f32_16x16x32_bf16 v[152:155], a[232:235], a[60:63], v[152:155]
    buffer_store_dwordx4 v[96:99], v4, s[24:27], s56 offen offset:1024 sc1
    v_mfma_f32_16x16x32_bf16 v[156:159], a[232:235], a[64:67], v[156:159]
    ds_read_b64_tr_b16 a[240:241], v193 offset:49152
    ds_read_b64_tr_b16 a[242:243], v193 offset:51200
    v_mfma_f32_16x16x32_bf16 v[160:163], a[232:235], a[68:71], v[160:163]
    buffer_store_dwordx4 v[100:103], v4, s[24:27], s56 offen offset:2048 sc1
    v_mfma_f32_16x16x32_bf16 v[164:167], a[232:235], a[72:75], v[164:167]
    v_mfma_f32_16x16x32_bf16 v[168:171], a[232:235], a[76:79], v[168:171]
    buffer_store_dwordx2 v[104:105], v198, s[24:27], s56 offen offset:3072 sc1
    v_mfma_f32_16x16x32_bf16 v[172:175], a[232:235], a[80:83], v[172:175]
    s_waitcnt lgkmcnt(2)
    v_mfma_f32_16x16x32_bf16 v[148:151], a[236:239], a[84:87], v[148:151]
    ds_read_b64_tr_b16 a[244:245], v193 offset:53248
    ds_read_b64_tr_b16 a[246:247], v193 offset:55296
    v_mfma_f32_16x16x32_bf16 v[152:155], a[236:239], a[88:91], v[152:155]
    v_mfma_f32_16x16x32_bf16 v[156:159], a[236:239], a[92:95], v[156:159]
    v_mfma_f32_16x16x32_bf16 v[160:163], a[236:239], a[96:99], v[160:163]
    v_mfma_f32_16x16x32_bf16 v[164:167], a[236:239], a[100:103], v[164:167]
    v_mfma_f32_16x16x32_bf16 v[168:171], a[236:239], a[104:107], v[168:171]
    s_waitcnt vmcnt(5)
    v_readlane_b32 s52, v201, 4
    s_xor_b32 s54, s62, 65536
    v_mfma_f32_16x16x32_bf16 v[172:175], a[236:239], a[108:111], v[172:175]
    s_cmp_eq_u32 s52, 1
    s_cbranch_scc0 L_spin4
L_got4:
    s_waitcnt lgkmcnt(2)
    v_mfma_f32_16x16x32_bf16 v[148:151], a[240:243], a[112:115], v[148:151]
    ds_read_b64_tr_b16 a[248:249], v193 offset:57344
    ds_read_b64_tr_b16 a[250:251], v193 offset:59392
    v_mfma_f32_16x16x32_bf16 v[152:155], a[240:243], a[116:119], v[152:155]
    buffer_load_dwordx4 v[50:53], v4, s[24:27], s54 offen offset:0 sc1
    v_mfma_f32_16x16x32_bf16 v[156:159], a[240:243], a[120:123], v[156:159]
    v_mfma_f32_16x16x32_bf16 v[160:163], a[240:243], a[124:127], v[160:163]
    v_mfma_f32_16x16x32_bf16 v[164:167], a[240:243], a[128:131], v[164:167]
    buffer_load_dwordx4 v[54:57], v4, s[24:27], s54 offen offset:1024 sc1
    v_mfma_f32_16x16x32_bf16 v[168:171], a[240:243], a[132:135], v[168:171]
    v_mfma_f32_16x16x32_bf16 v[172:175], a[240:243], a[136:139], v[172:175]
    s_waitcnt lgkmcnt(2)
    v_mfma_f32_16x16x32_bf16 v[148:151], a[244:247], a[140:143], v[148:151]
    ds_read_b64_tr_b16 a[252:253], v193 offset:61440
    ds_read_b64_tr_b16 a[254:255], v193 offset:63488
    v_mfma_f32_16x16x32_bf16 v[152:155], a[244:247], a[144:147], v[152:155]
    buffer_load_dwordx4 v[58:61], v4, s[24:27], s54 offen offset:2048 sc1
    v_mfma_f32_16x16x32_bf16 v[156:159], a[244:247], a[148:151], v[156:159]
    v_mfma_f32_16x16x32_bf16 v[160:163], a[244:247], a[152:155], v[160:163]
    buffer_load_dwordx2 v[62:63], v198, s[24:27], s54 offen offset:3072 sc1
    v_mfma_f32_16x16x32_bf16 v[164:167], a[244:247], a[156:159], v[164:167]
    v_mfma_f32_16x16x32_bf16 v[168:171], a[244:247], a[160:163], v[168:171]
    v_mfma_f32_16x16x32_bf16 v[172:175], a[244:247], a[164:167], v[172:175]
    s_waitcnt lgkmcnt(2)
    v_mfma_f32_16x16x32_bf16 v[148:151], a[248:251], a[168:171], v[148:151]
    v_mfma_f32_16x16x32_bf16 v[152:155], a[248:251], a[172:175], v[152:155]
    v_mfma_f32_16x16x32_bf16 v[156:159], a[248:251], a[176:179], v[156:159]
    v_mfma_f32_16x16x32_bf16 v[160:163], a[248:251], a[180:183], v[160:163]
    v_mfma_f32_16x16x32_bf16 v[164:167], a[248:251], a[184:187], v[164:167]
    v_mfma_f32_16x16x32_bf16 v[168:171], a[248:251], a[188:191], v[168:171]
    v_mfma_f32_16x16x32_bf16 v[172:175], a[248:251], a[192:195], v[172:175]
    s_waitcnt lgkmcnt(0)
    v_mfma_f32_16x16x32_bf16 v[148:151], a[252:255], a[196:199], v[148:151]
    v_mfma_f32_16x16x32_bf16 v[152:155], a[252:255], a[200:203], v[152:155]
    v_mfma_f32_16x16x32_bf16 v[156:159], a[252:255], a[204:207], v[156:159]
    v_mfma_f32_16x16x32_bf16 v[160:163], a[252:255], a[208:211], v[160:163]
    v_mfma_f32_16x16x32_bf16 v[164:167], a[252:255], a[212:215], v[164:167]
    v_mfma_f32_16x16x32_bf16 v[168:171], a[252:255], a[216:219], v[168:171]
    v_mfma_f32_16x16x32_bf16 v[172:175], a[252:255], a[220:223], v[172:175]
    buffer_load_dword v201, v199, s[24:27], s64 offen sc1
    s_add_u32 s53, s5, 7
    s_and_b32 s53, s53, 7
    s_lshl_b32 s53, s53, 9
    s_add_u32 s53, s53, s63
    s_waitcnt vmcnt(5)
    buffer_store_dword v202, v200, s[24:27], s53 offen offset:28 sc1
    s_waitcnt vmcnt(1)
    v_readlane_b32 s52, v201, 5
    s_xor_b32 s54, s62, 81920
    s_cmp_eq_u32 s52, 1
    s_cbranch_scc0 L_spin5
L_got5:
    buffer_load_dwordx4 v[64:67], v4, s[24:27], s54 offen offset:0 sc1
    buffer_load_dwordx4 v[68:71], v4, s[24:27], s54 offen offset:1024 sc1
    buffer_load_dwordx4 v[72:75], v4, s[24:27], s54 offen offset:2048 sc1
    buffer_load_dwordx2 v[76:77], v198, s[24:27], s54 offen offset:3072 sc1
    v_readlane_b32 s52, v201, 6
    s_xor_b32 s54, s62, 98304
    s_cmp_eq_u32 s52, 1
    s_cbranch_scc0 L_spin6
L_got6:
    buffer_load_dwordx4 v[78:81], v4, s[24:27], s54 offen offset:0 sc1
    buffer_load_dwordx4 v[82:85], v4, s[24:27], s54 offen offset:1024 sc1
    buffer_load_dwordx4 v[86:89], v4, s[24:27], s54 offen offset:2048 sc1
    buffer_load_dwordx2 v[90:91], v198, s[24:27], s54 offen offset:3072 sc1
    v_readlane_b32 s52, v201, 7
    s_xor_b32 s54, s62, 114688
    s_cmp_eq_u32 s52, 1
    s_cbranch_scc0 L_spin7
L_got7:
    buffer_load_dwordx4 v[92:95], v4, s[24:27], s54 offen offset:0 sc1
    buffer_load_dwordx4 v[96:99], v4, s[24:27], s54 offen offset:1024 sc1
    buffer_load_dwordx4 v[100:103], v4, s[24:27], s54 offen offset:2048 sc1
    buffer_load_dwordx2 v[104:105], v198, s[24:27], s54 offen offset:3072 sc1
    v_mfma_f32_4x4x4_16b_bf16 v[148:151], v[204:205], v[8:9], v[148:151]
    v_mfma_f32_4x4x4_16b_bf16 v[152:155], v[204:205], v[10:11], v[152:155]
    v_mfma_f32_4x4x4_16b_bf16 v[156:159], v[204:205], v[12:13], v[156:159]
    v_mfma_f32_4x4x4_16b_bf16 v[160:163], v[204:205], v[14:15], v[160:163]
    v_mfma_f32_4x4x4_16b_bf16 v[164:167], v[204:205], v[16:17], v[164:167]
    v_mfma_f32_4x4x4_16b_bf16 v[168:171], v[204:205], v[18:19], v[168:171]
    v_mfma_f32_4x4x4_16b_bf16 v[172:175], v[204:205], v[20:21], v[172:175]
    v_mfma_f32_4x4x4_16b_bf16 v[148:151], v[204:205], v[22:23], v[148:151]
    v_mfma_f32_4x4x4_16b_bf16 v[152:155], v[204:205], v[24:25], v[152:155]
    v_mfma_f32_4x4x4_16b_bf16 v[156:159], v[204:205], v[26:27], v[156:159]
    v_mfma_f32_4x4x4_16b_bf16 v[160:163], v[204:205], v[28:29], v[160:163]
    v_mfma_f32_4x4x4_16b_bf16 v[164:167], v[204:205], v[30:31], v[164:167]
    v_mfma_f32_4x4x4_16b_bf16 v[168:171], v[204:205], v[32:33], v[168:171]
    v_mfma_f32_4x4x4_16b_bf16 v[172:175], v[204:205], v[34:35], v[172:175]
    v_mfma_f32_4x4x4_16b_bf16 v[148:151], v[204:205], v[36:37], v[148:151]
    v_mfma_f32_4x4x4_16b_bf16 v[152:155], v[204:205], v[38:39], v[152:155]
    v_mfma_f32_4x4x4_16b_bf16 v[156:159], v[204:205], v[40:41], v[156:159]
    v_mfma_f32_4x4x4_16b_bf16 v[160:163], v[204:205], v[42:43], v[160:163]
    v_mfma_f32_4x4x4_16b_bf16 v[164:167], v[204:205], v[44:45], v[164:167]
    v_mfma_f32_4x4x4_16b_bf16 v[168:171], v[204:205], v[46:47], v[168:171]
    v_mfma_f32_4x4x4_16b_bf16 v[172:175], v[204:205], v[48:49], v[172:175]
    v_mfma_f32_4x4x4_16b_bf16 v[148:151], v[204:205], v[50:51], v[148:151]
    v_mfma_f32_4x4x4_16b_bf16 v[152:155], v[204:205], v[52:53], v[152:155]
    v_mfma_f32_4x4x4_16b_bf16 v[156:159], v[204:205], v[54:55], v[156:159]
    v_mfma_f32_4x4x4_16b_bf16 v[160:163], v[204:205], v[56:57], v[160:163]
    v_mfma_f32_4x4x4_16b_bf16 v[164:167], v[204:205], v[58:59], v[164:167]
    v_mfma_f32_4x4x4_16b_bf16 v[168:171], v[204:205], v[60:61], v[168:171]
    v_mfma_f32_4x4x4_16b_bf16 v[172:175], v[204:205], v[62:63], v[172:175]
    s_waitcnt vmcnt(8)
    v_mfma_f32_4x4x4_16b_bf16 v[148:151], v[204:205], v[64:65], v[148:151]
    v_mfma_f32_4x4x4_16b_bf16 v[152:155], v[204:205], v[66:67], v[152:155]
    v_mfma_f32_4x4x4_16b_bf16 v[156:159], v[204:205], v[68:69], v[156:159]
    v_mfma_f32_4x4x4_16b_bf16 v[160:163], v[204:205], v[70:71], v[160:163]
    v_mfma_f32_4x4x4_16b_bf16 v[164:167], v[204:205], v[72:73], v[164:167]
    v_mfma_f32_4x4x4_16b_bf16 v[168:171], v[204:205], v[74:75], v[168:171]
    v_mfma_f32_4x4x4_16b_bf16 v[172:175], v[204:205], v[76:77], v[172:175]
    s_waitcnt vmcnt(4)
    v_mfma_f32_4x4x4_16b_bf16 v[148:151], v[204:205], v[78:79], v[148:151]
    v_mfma_f32_4x4x4_16b_bf16 v[152:155], v[204:205], v[80:81], v[152:155]
    v_mfma_f32_4x4x4_16b_bf16 v[156:159], v[204:205], v[82:83], v[156:159]
    v_mfma_f32_4x4x4_16b_bf16 v[160:163], v[204:205], v[84:85], v[160:163]
    v_mfma_f32_4x4x4_16b_bf16 v[164:167], v[204:205], v[86:87], v[164:167]
    v_mfma_f32_4x4x4_16b_bf16 v[168:171], v[204:205], v[88:89], v[168:171]
    v_mfma_f32_4x4x4_16b_bf16 v[172:175], v[204:205], v[90:91], v[172:175]
    s_waitcnt vmcnt(0)
    v_mfma_f32_4x4x4_16b_bf16 v[148:151], v[204:205], v[92:93], v[148:151]
    v_mfma_f32_4x4x4_16b_bf16 v[152:155], v[204:205], v[94:95], v[152:155]
    v_mfma_f32_4x4x4_16b_bf16 v[156:159], v[204:205], v[96:97], v[156:159]
    v_mfma_f32_4x4x4_16b_bf16 v[160:163], v[204:205], v[98:99], v[160:163]
    v_mfma_f32_4x4x4_16b_bf16 v[164:167], v[204:205], v[100:101], v[164:167]
    v_mfma_f32_4x4x4_16b_bf16 v[168:171], v[204:205], v[102:103], v[168:171]
    v_mfma_f32_4x4x4_16b_bf16 v[172:175], v[204:205], v[104:105], v[172:175]
    v_cvt_pk_bf16_f32 v148, v148, v149
    v_cvt_pk_bf16_f32 v149, v150, v151
    ds_write_b64 v207, v[148:149] offset:0
    v_cvt_pk_bf16_f32 v152, v152, v153
    v_cvt_pk_bf16_f32 v153, v154, v155
    ds_write_b64 v207, v[152:153] offset:2304
    v_cvt_pk_bf16_f32 v156, v156, v157
    v_cvt_pk_bf16_f32 v157, v158, v159
    ds_write_b64 v207, v[156:157] offset:4608
    v_cvt_pk_bf16_f32 v160, v160, v161
    v_cvt_pk_bf16_f32 v161, v162, v163
    ds_write_b64 v207, v[160:161] offset:6912
    v_cvt_pk_bf16_f32 v164, v164, v165
    v_cvt_pk_bf16_f32 v165, v166, v167
    ds_write_b64 v207, v[164:165] offset:9216
    v_cvt_pk_bf16_f32 v168, v168, v169
    v_cvt_pk_bf16_f32 v169, v170, v171
    ds_write_b64 v207, v[168:169] offset:11520
    v_cvt_pk_bf16_f32 v172, v172, v173
    v_cvt_pk_bf16_f32 v173, v174, v175
    ds_write_b64 v207, v[172:173] offset:13824
    s_waitcnt lgkmcnt(0)
    s_barrier
    ds_read_b128 v[8:11], v208 offset:0
    ds_read_b128 v[12:15], v208 offset:4608
    ds_read_b128 v[16:19], v208 offset:9216
    ds_read_b128 v[20:23], v208 offset:13824
    s_cmp_lt_u32 s40, 2
    s_mov_b32 s53, 196608
    s_cselect_b32 s53, s53, 2146435072
    s_waitcnt lgkmcnt(3)
    buffer_store_dwordx4 v[8:11], v206, s[32:35], 0 offen sc1
    s_mov_b32 s52, 65536
    s_waitcnt lgkmcnt(2)
    buffer_store_dwordx4 v[12:15], v206, s[32:35], s52 offen sc1
    s_mov_b32 s52, 131072
    s_waitcnt lgkmcnt(1)
    buffer_store_dwordx4 v[16:19], v206, s[32:35], s52 offen sc1
    s_waitcnt lgkmcnt(0)
    buffer_store_dwordx4 v[20:23], v206, s[32:35], s53 offen sc1
    s_endpgm
L_spin1:
    s_mov_b32 s60, 0
L_spl1:
    buffer_load_dword v201, v199, s[24:27], s64 offen sc1
    s_waitcnt vmcnt(0)
    v_readlane_b32 s52, v201, 1
    s_nop 0
    s_cmp_eq_u32 s52, 1
    s_cbranch_scc1 L_got1
    s_add_u32 s60, s60, 1
    s_cmp_gt_u32 s60, 0x40000
    s_cbranch_scc1 L_got1
    s_sleep 1
    s_branch L_spl1
L_spin2:
    s_mov_b32 s60, 0
L_spl2:
    buffer_load_dword v201, v199, s[24:27], s64 offen sc1
    s_waitcnt vmcnt(0)
    v_readlane_b32 s52, v201, 2
    s_nop 0
    s_cmp_eq_u32 s52, 1
    s_cbranch_scc1 L_got2
    s_add_u32 s60, s60, 1
    s_cmp_gt_u32 s60, 0x40000
    s_cbranch_scc1 L_got2
    s_sleep 1
    s_branch L_spl2
L_spin3:
    s_mov_b32 s60, 0
L_spl3:
    buffer_load_dword v201, v199, s[24:27], s64 offen sc1
    s_waitcnt vmcnt(0)
    v_readlane_b32 s52, v201, 3
    s_nop 0
    s_cmp_eq_u32 s52, 1
    s_cbranch_scc1 L_got3
    s_add_u32 s60, s60, 1
    s_cmp_gt_u32 s60, 0x40000
    s_cbranch_scc1 L_got3
    s_sleep 1
    s_branch L_spl3
L_spin4:
    s_mov_b32 s60, 0
L_spl4:
    buffer_load_dword v201, v199, s[24:27], s64 offen sc1
    s_waitcnt vmcnt(0)
    v_readlane_b32 s52, v201, 4
    s_nop 0
    s_cmp_eq_u32 s52, 1
    s_cbranch_scc1 L_got4
    s_add_u32 s60, s60, 1
    s_cmp_gt_u32 s60, 0x40000
    s_cbranch_scc1 L_got4
    s_sleep 1
    s_branch L_spl4
L_spin5:
    s_mov_b32 s60, 0
L_spl5:
    buffer_load_dword v201, v199, s[24:27], s64 offen sc1
    s_waitcnt vmcnt(0)
    v_readlane_b32 s52, v201, 5
    s_nop 0
    s_cmp_eq_u32 s52, 1
    s_cbranch_scc1 L_got5
    s_add_u32 s60, s60, 1
    s_cmp_gt_u32 s60, 0x40000
    s_cbranch_scc1 L_got5
    s_sleep 1
    s_branch L_spl5
L_spin6:
    s_mov_b32 s60, 0
L_spl6:
    buffer_load_dword v201, v199, s[24:27], s64 offen sc1
    s_waitcnt vmcnt(0)
    v_readlane_b32 s52, v201, 6
    s_nop 0
    s_cmp_eq_u32 s52, 1
    s_cbranch_scc1 L_got6
    s_add_u32 s60, s60, 1
    s_cmp_gt_u32 s60, 0x40000
    s_cbranch_scc1 L_got6
    s_sleep 1
    s_branch L_spl6
L_spin7:
    s_mov_b32 s60, 0
L_spl7:
    buffer_load_dword v201, v199, s[24:27], s64 offen sc1
    s_waitcnt vmcnt(0)
    v_readlane_b32 s52, v201, 7
    s_nop 0
    s_cmp_eq_u32 s52, 1
    s_cbranch_scc1 L_got7
    s_add_u32 s60, s60, 1
    s_cmp_gt_u32 s60, 0x40000
    s_cbranch_scc1 L_got7
    s_sleep 1
    s_branch L_spl7
L_safe:
    s_mul_i32 s53, s41, 28672
    s_add_u32 s52, s53, 65536
    s_cmp_eq_u32 s42, 0
    s_cselect_b32 s54, s52, s53
    s_cselect_b32 s58, s46, s47
    s_and_b32 s58, s58, 0xfffe0000
    s_lshl_b32 s52, s41, 15
    s_sub_u32 s52, s54, s52
    v_add_u32 v236, s52, v236
    v_add_u32 v237, s52, v237
    v_add_u32 v238, s52, v238
    v_add_u32 v239, s52, v239
    v_add_u32 v240, s52, v240
    v_add_u32 v241, s52, v241
    v_add_u32 v242, s52, v242
    v_add_u32 v243, s52, v243
    v_add_u32 v244, s52, v244
    v_add_u32 v245, s52, v245
    v_add_u32 v246, s52, v246
    v_add_u32 v247, s52, v247
    v_mov_b32 v248, 0xff800000
    v_mov_b32 v249, 0xff800000
    v_mov_b32 v250, 0xff800000
    v_mov_b32 v251, 0xff800000
    v_mov_b32 v252, 0xff800000
    v_mov_b32 v253, 0xff800000
    v_mov_b32 v254, 0xff800000
    v_mov_b32 v8, 0
    v_mov_b32 v9, 0
    v_mov_b32 v10, 0
    v_mov_b32 v11, 0
    v_mov_b32 v12, 0
    v_mov_b32 v13, 0
    v_mov_b32 v14, 0
    v_mov_b32 v15, 0
    v_mov_b32 v16, 0
    v_mov_b32 v17, 0
    v_mov_b32 v18, 0
    v_mov_b32 v19, 0
    v_mov_b32 v20, 0
    v_mov_b32 v21, 0
    v_mov_b32 v22, 0
    v_mov_b32 v23, 0
    v_mov_b32 v24, 0
    v_mov_b32 v25, 0
    v_mov_b32 v26, 0
    v_mov_b32 v27, 0
    v_mov_b32 v28, 0
    v_mov_b32 v29, 0
    v_mov_b32 v30, 0
    v_mov_b32 v31, 0
    v_mov_b32 v32, 0
    v_mov_b32 v33, 0
    v_mov_b32 v34, 0
    v_mov_b32 v35, 0
    v_mov_b32 v36, 0
    v_mov_b32 v37, 0
    v_mov_b32 v38, 0
    v_mov_b32 v39, 0
    v_mov_b32 v40, 0
    v_mov_b32 v41, 0
    v_mov_b32 v42, 0
    v_mov_b32 v43, 0
    v_mov_b32 v44, 0
    v_mov_b32 v45, 0
    v_mov_b32 v46, 0
    v_mov_b32 v47, 0
    v_mov_b32 v48, 0
    v_mov_b32 v49, 0
    v_mov_b32 v50, 0
    v_mov_b32 v51, 0
    v_mov_b32 v52, 0
    v_mov_b32 v53, 0
    v_mov_b32 v54, 0
    v_mov_b32 v55, 0
    v_mov_b32 v56, 0
    v_mov_b32 v57, 0
    v_mov_b32 v58, 0
    v_mov_b32 v59, 0
    v_mov_b32 v60, 0
    v_mov_b32 v61, 0
    v_mov_b32 v62, 0
    v_mov_b32 v63, 0
    v_mov_b32 v64, 0
    v_mov_b32 v65, 0
    v_mov_b32 v66, 0
    v_mov_b32 v67, 0
    v_mov_b32 v68, 0
    v_mov_b32 v69, 0
    v_mov_b32 v70, 0
    v_mov_b32 v71, 0
    v_mov_b32 v72, 0
    v_mov_b32 v73, 0
    v_mov_b32 v74, 0
    v_mov_b32 v75, 0
    v_mov_b32 v76, 0
    v_mov_b32 v77, 0
    v_mov_b32 v78, 0
    v_mov_b32 v79, 0
    v_mov_b32 v80, 0
    v_mov_b32 v81, 0
    v_mov_b32 v82, 0
    v_mov_b32 v83, 0
    v_mov_b32 v84, 0
    v_mov_b32 v85, 0
    v_mov_b32 v86, 0
    v_mov_b32 v87, 0
    v_mov_b32 v88, 0
    v_mov_b32 v89, 0
    v_mov_b32 v90, 0
    v_mov_b32 v91, 0
    v_mov_b32 v92, 0
    v_mov_b32 v93, 0
    v_mov_b32 v94, 0
    v_mov_b32 v95, 0
    v_mov_b32 v96, 0
    v_mov_b32 v97, 0
    v_mov_b32 v98, 0
    v_mov_b32 v99, 0
    v_mov_b32 v100, 0
    v_mov_b32 v101, 0
    v_mov_b32 v102, 0
    v_mov_b32 v103, 0
    v_mov_b32 v104, 0
    v_mov_b32 v105, 0
    v_mov_b32 v106, 0
    v_mov_b32 v107, 0
    v_mov_b32 v108, 0
    v_mov_b32 v109, 0
    v_mov_b32 v110, 0
    v_mov_b32 v111, 0
    v_mov_b32 v112, 0
    v_mov_b32 v113, 0
    v_mov_b32 v114, 0
    v_mov_b32 v115, 0
    v_mov_b32 v116, 0
    v_mov_b32 v117, 0
    v_mov_b32 v118, 0
    v_mov_b32 v119, 0
    v_mov_b32 v120, 0
    v_mov_b32 v121, 0
    v_mov_b32 v122, 0
    v_mov_b32 v123, 0
    v_mov_b32 v124, 0
    v_mov_b32 v125, 0
    v_mov_b32 v126, 0
    v_mov_b32 v127, 0
    v_mov_b32 v128, 0
    v_mov_b32 v129, 0
    v_mov_b32 v130, 0
    v_mov_b32 v131, 0
    v_mov_b32 v132, 0
    v_mov_b32 v133, 0
    v_mov_b32 v134, 0
    v_mov_b32 v135, 0
    v_mov_b32 v136, 0
    v_mov_b32 v137, 0
    v_mov_b32 v138, 0
    v_mov_b32 v139, 0
    v_mov_b32 v140, 0
    v_mov_b32 v141, 0
    v_mov_b32 v142, 0
    v_mov_b32 v143, 0
    v_mov_b32 v144, 0
    v_mov_b32 v145, 0
    v_mov_b32 v146, 0
    v_mov_b32 v147, 0
    v_mov_b32 v148, 0
    v_mov_b32 v149, 0
    v_mov_b32 v150, 0
    v_mov_b32 v151, 0
    v_mov_b32 v152, 0
    v_mov_b32 v153, 0
    v_mov_b32 v154, 0
    v_mov_b32 v155, 0
    v_mov_b32 v156, 0
    v_mov_b32 v157, 0
    v_mov_b32 v158, 0
    v_mov_b32 v159, 0
    v_mov_b32 v160, 0
    v_mov_b32 v161, 0
    v_mov_b32 v162, 0
    v_mov_b32 v163, 0
    v_mov_b32 v164, 0
    v_mov_b32 v165, 0
    v_mov_b32 v166, 0
    v_mov_b32 v167, 0
    v_mov_b32 v168, 0
    v_mov_b32 v169, 0
    v_mov_b32 v170, 0
    v_mov_b32 v171, 0
    v_mov_b32 v172, 0
    v_mov_b32 v173, 0
    v_mov_b32 v174, 0
    v_mov_b32 v175, 0
    v_accvgpr_write_b32 a0, 0
    v_accvgpr_write_b32 a1, 0
    v_accvgpr_write_b32 a2, 0
    v_accvgpr_write_b32 a3, 0
    v_accvgpr_write_b32 a4, 0
    v_accvgpr_write_b32 a5, 0
    v_accvgpr_write_b32 a6, 0
    v_accvgpr_write_b32 a7, 0
    v_accvgpr_write_b32 a8, 0
    v_accvgpr_write_b32 a9, 0
    v_accvgpr_write_b32 a10, 0
    v_accvgpr_write_b32 a11, 0
    v_accvgpr_write_b32 a12, 0
    v_accvgpr_write_b32 a13, 0
    v_accvgpr_write_b32 a14, 0
    v_accvgpr_write_b32 a15, 0
    v_accvgpr_write_b32 a16, 0
    v_accvgpr_write_b32 a17, 0
    v_accvgpr_write_b32 a18, 0
    v_accvgpr_write_b32 a19, 0
    v_accvgpr_write_b32 a20, 0
    v_accvgpr_write_b32 a21, 0
    v_accvgpr_write_b32 a22, 0
    v_accvgpr_write_b32 a23, 0
    v_accvgpr_write_b32 a24, 0
    v_accvgpr_write_b32 a25, 0
    v_accvgpr_write_b32 a26, 0
    v_accvgpr_write_b32 a27, 0
    v_accvgpr_write_b32 a28, 0
    v_accvgpr_write_b32 a29, 0
    v_accvgpr_write_b32 a30, 0
    v_accvgpr_write_b32 a31, 0
    v_accvgpr_write_b32 a32, 0
    v_accvgpr_write_b32 a33, 0
    v_accvgpr_write_b32 a34, 0
    v_accvgpr_write_b32 a35, 0
    v_accvgpr_write_b32 a36, 0
    v_accvgpr_write_b32 a37, 0
    v_accvgpr_write_b32 a38, 0
    v_accvgpr_write_b32 a39, 0
    v_accvgpr_write_b32 a40, 0
    v_accvgpr_write_b32 a41, 0
    v_accvgpr_write_b32 a42, 0
    v_accvgpr_write_b32 a43, 0
    v_accvgpr_write_b32 a44, 0
    v_accvgpr_write_b32 a45, 0
    v_accvgpr_write_b32 a46, 0
    v_accvgpr_write_b32 a47, 0
    v_accvgpr_write_b32 a48, 0
    v_accvgpr_write_b32 a49, 0
    v_accvgpr_write_b32 a50, 0
    v_accvgpr_write_b32 a51, 0
    v_accvgpr_write_b32 a52, 0
    v_accvgpr_write_b32 a53, 0
    v_accvgpr_write_b32 a54, 0
    v_accvgpr_write_b32 a55, 0
    v_accvgpr_write_b32 a56, 0
    v_accvgpr_write_b32 a57, 0
    v_accvgpr_write_b32 a58, 0
    v_accvgpr_write_b32 a59, 0
    v_accvgpr_write_b32 a60, 0
    v_accvgpr_write_b32 a61, 0
    v_accvgpr_write_b32 a62, 0
    v_accvgpr_write_b32 a63, 0
    v_accvgpr_write_b32 a64, 0
    v_accvgpr_write_b32 a65, 0
    v_accvgpr_write_b32 a66, 0
    v_accvgpr_write_b32 a67, 0
    v_accvgpr_write_b32 a68, 0
    v_accvgpr_write_b32 a69, 0
    v_accvgpr_write_b32 a70, 0
    v_accvgpr_write_b32 a71, 0
    v_accvgpr_write_b32 a72, 0
    v_accvgpr_write_b32 a73, 0
    v_accvgpr_write_b32 a74, 0
    v_accvgpr_write_b32 a75, 0
    v_accvgpr_write_b32 a76, 0
    v_accvgpr_write_b32 a77, 0
    v_accvgpr_write_b32 a78, 0
    v_accvgpr_write_b32 a79, 0
    v_accvgpr_write_b32 a80, 0
    v_accvgpr_write_b32 a81, 0
    v_accvgpr_write_b32 a82, 0
    v_accvgpr_write_b32 a83, 0
    s_mov_b32 s59, 0
L_sloop:
    s_add_u32 m0, s54, 0
    s_add_u32 s56, s58, 0
    buffer_load_dwordx4 v5, s[8:11], s56 offen offset:0 lds
    buffer_load_dwordx4 v6, s[8:11], s56 offen offset:1024 lds
    buffer_load_dwordx4 v5, s[8:11], s56 offen offset:2048 lds
    buffer_load_dwordx4 v6, s[8:11], s56 offen offset:3072 lds
    s_add_u32 m0, s54, 4096
    s_add_u32 s56, s58, 4096
    buffer_load_dwordx4 v5, s[8:11], s56 offen offset:0 lds
    buffer_load_dwordx4 v6, s[8:11], s56 offen offset:1024 lds
    buffer_load_dwordx4 v5, s[8:11], s56 offen offset:2048 lds
    buffer_load_dwordx4 v6, s[8:11], s56 offen offset:3072 lds
    s_waitcnt vmcnt(0)
    ds_read_b128 a[88:91], v236 offset:0
    ds_read_b128 a[92:95], v236 offset:4096
    ds_read_b128 a[96:99], v237 offset:0
    ds_read_b128 a[100:103], v237 offset:4096
    ds_read_b128 a[104:107], v238 offset:0
    ds_read_b128 a[108:111], v238 offset:4096
    ds_read_b128 a[112:115], v239 offset:0
    ds_read_b128 a[84:87], v239 offset:4096
    s_waitcnt lgkmcnt(0)
    s_add_u32 m0, s54, 0
    s_add_u32 s56, s58, 0
    buffer_load_dwordx4 v5, s[12:15], s56 offen offset:0 lds
    buffer_load_dwordx4 v6, s[12:15], s56 offen offset:1024 lds
    buffer_load_dwordx4 v5, s[12:15], s56 offen offset:2048 lds
    buffer_load_dwordx4 v6, s[12:15], s56 offen offset:3072 lds
    s_add_u32 m0, s54, 4096
    s_add_u32 s56, s58, 4096
    buffer_load_dwordx4 v5, s[12:15], s56 offen offset:0 lds
    buffer_load_dwordx4 v6, s[12:15], s56 offen offset:1024 lds
    buffer_load_dwordx4 v5, s[12:15], s56 offen offset:2048 lds
    buffer_load_dwordx4 v6, s[12:15], s56 offen offset:3072 lds
    v_mfma_f32_16x16x32_bf16 v[176:179], a[88:91], a[144:147], 0
    v_mfma_f32_16x16x32_bf16 v[180:183], a[92:95], a[144:147], 0
    v_mfma_f32_16x16x32_bf16 v[176:179], a[96:99], a[148:151], v[176:179]
    v_mfma_f32_16x16x32_bf16 v[180:183], a[100:103], a[148:151], v[180:183]
    v_mfma_f32_16x16x32_bf16 v[176:179], a[104:107], a[152:155], v[176:179]
    v_mfma_f32_16x16x32_bf16 v[180:183], a[108:111], a[152:155], v[180:183]
    v_mfma_f32_16x16x32_bf16 v[176:179], a[112:115], a[156:159], v[176:179]
    v_mfma_f32_16x16x32_bf16 v[180:183], a[84:87], a[156:159], v[180:183]
    v_mfma_f32_16x16x32_bf16 v[184:187], a[88:91], a[160:163], 0
    v_mfma_f32_16x16x32_bf16 v[188:191], a[92:95], a[160:163], 0
    v_mfma_f32_16x16x32_bf16 v[184:187], a[96:99], a[164:167], v[184:187]
    v_mfma_f32_16x16x32_bf16 v[188:191], a[100:103], a[164:167], v[188:191]
    v_mfma_f32_16x16x32_bf16 v[184:187], a[104:107], a[168:171], v[184:187]
    v_mfma_f32_16x16x32_bf16 v[188:191], a[108:111], a[168:171], v[188:191]
    v_mfma_f32_16x16x32_bf16 v[184:187], a[112:115], a[172:175], v[184:187]
    v_mfma_f32_16x16x32_bf16 v[188:191], a[84:87], a[172:175], v[188:191]
    v_mfma_f32_16x16x32_bf16 v[192:195], a[88:91], a[176:179], 0
    v_mfma_f32_16x16x32_bf16 v[196:199], a[92:95], a[176:179], 0
    v_mfma_f32_16x16x32_bf16 v[192:195], a[96:99], a[180:183], v[192:195]
    v_mfma_f32_16x16x32_bf16 v[196:199], a[100:103], a[180:183], v[196:199]
    v_mfma_f32_16x16x32_bf16 v[192:195], a[104:107], a[184:187], v[192:195]
    v_mfma_f32_16x16x32_bf16 v[196:199], a[108:111], a[184:187], v[196:199]
    v_mfma_f32_16x16x32_bf16 v[192:195], a[112:115], a[188:191], v[192:195]
    v_mfma_f32_16x16x32_bf16 v[196:199], a[84:87], a[188:191], v[196:199]
    v_mfma_f32_16x16x32_bf16 v[200:203], a[88:91], a[192:195], 0
    v_mfma_f32_16x16x32_bf16 v[204:207], a[92:95], a[192:195], 0
    v_mfma_f32_16x16x32_bf16 v[200:203], a[96:99], a[196:199], v[200:203]
    v_mfma_f32_16x16x32_bf16 v[204:207], a[100:103], a[196:199], v[204:207]
    v_mfma_f32_16x16x32_bf16 v[200:203], a[104:107], a[200:203], v[200:203]
    v_mfma_f32_16x16x32_bf16 v[204:207], a[108:111], a[200:203], v[204:207]
    v_mfma_f32_16x16x32_bf16 v[200:203], a[112:115], a[204:207], v[200:203]
    v_mfma_f32_16x16x32_bf16 v[204:207], a[84:87], a[204:207], v[204:207]
    v_mfma_f32_16x16x32_bf16 v[208:211], a[88:91], a[208:211], 0
    v_mfma_f32_16x16x32_bf16 v[212:215], a[92:95], a[208:211], 0
    v_mfma_f32_16x16x32_bf16 v[208:211], a[96:99], a[212:215], v[208:211]
    v_mfma_f32_16x16x32_bf16 v[212:215], a[100:103], a[212:215], v[212:215]
    v_mfma_f32_16x16x32_bf16 v[208:211], a[104:107], a[216:219], v[208:211]
    v_mfma_f32_16x16x32_bf16 v[212:215], a[108:111], a[216:219], v[212:215]
    v_mfma_f32_16x16x32_bf16 v[208:211], a[112:115], a[220:223], v[208:211]
    v_mfma_f32_16x16x32_bf16 v[212:215], a[84:87], a[220:223], v[212:215]
    v_mfma_f32_16x16x32_bf16 v[216:219], a[88:91], a[224:227], 0
    v_mfma_f32_16x16x32_bf16 v[220:223], a[92:95], a[224:227], 0
    v_mfma_f32_16x16x32_bf16 v[216:219], a[96:99], a[228:231], v[216:219]
    v_mfma_f32_16x16x32_bf16 v[220:223], a[100:103], a[228:231], v[220:223]
    v_mfma_f32_16x16x32_bf16 v[216:219], a[104:107], a[232:235], v[216:219]
    v_mfma_f32_16x16x32_bf16 v[220:223], a[108:111], a[232:235], v[220:223]
    v_mfma_f32_16x16x32_bf16 v[216:219], a[112:115], a[236:239], v[216:219]
    v_mfma_f32_16x16x32_bf16 v[220:223], a[84:87], a[236:239], v[220:223]
    v_mfma_f32_16x16x32_bf16 v[224:227], a[88:91], a[240:243], 0
    v_mfma_f32_16x16x32_bf16 v[228:231], a[92:95], a[240:243], 0
    v_mfma_f32_16x16x32_bf16 v[224:227], a[96:99], a[244:247], v[224:227]
    v_mfma_f32_16x16x32_bf16 v[228:231], a[100:103], a[244:247], v[228:231]
    v_mfma_f32_16x16x32_bf16 v[224:227], a[104:107], a[248:251], v[224:227]
    v_mfma_f32_16x16x32_bf16 v[228:231], a[108:111], a[248:251], v[228:231]
    v_mfma_f32_16x16x32_bf16 v[224:227], a[112:115], a[252:255], v[224:227]
    v_mfma_f32_16x16x32_bf16 v[228:231], a[84:87], a[252:255], v[228:231]
    s_waitcnt vmcnt(0)
    ds_read_b64_tr_b16 a[84:85], v240 offset:0
    ds_read_b64_tr_b16 a[86:87], v240 offset:4096
    ds_read_b64_tr_b16 a[116:117], v241 offset:0
    ds_read_b64_tr_b16 a[118:119], v241 offset:4096
    ds_read_b64_tr_b16 a[120:121], v242 offset:0
    ds_read_b64_tr_b16 a[122:123], v242 offset:4096
    ds_read_b64_tr_b16 a[124:125], v243 offset:0
    ds_read_b64_tr_b16 a[126:127], v243 offset:4096
    s_waitcnt lgkmcnt(0)
    ds_read_b64_tr_b16 a[128:129], v244 offset:0
    ds_read_b64_tr_b16 a[130:131], v244 offset:4096
    ds_read_b64_tr_b16 a[132:133], v245 offset:0
    ds_read_b64_tr_b16 a[134:135], v245 offset:4096
    ds_read_b64_tr_b16 a[136:137], v246 offset:0
    ds_read_b64_tr_b16 a[138:139], v246 offset:4096
    ds_read_b64_tr_b16 a[140:141], v247 offset:0
    ds_read_b64_tr_b16 a[142:143], v247 offset:4096
    v_max3_f32 v2, v176, v177, v178
    v_max3_f32 v2, v2, v179, v180
    v_max3_f32 v2, v2, v181, v182
    v_max3_f32 v2, v2, v183, v248
    v_mov_b32 v1, v2
    s_nop 1
    v_permlane32_swap_b32 v2, v1
    v_max_f32 v2, v2, v1
    v_mov_b32 v1, v2
    s_nop 1
    v_permlane16_swap_b32 v2, v1
    v_max_f32 v2, v2, v1
    v_sub_f32 v3, v248, v2
    v_exp_f32 v3, v3
    v_mov_b32 v248, v2
    v_sub_f32 v176, v176, v2
    v_sub_f32 v177, v177, v2
    v_sub_f32 v178, v178, v2
    v_sub_f32 v179, v179, v2
    v_sub_f32 v180, v180, v2
    v_sub_f32 v181, v181, v2
    v_sub_f32 v182, v182, v2
    v_sub_f32 v183, v183, v2
    v_exp_f32 v176, v176
    v_exp_f32 v177, v177
    v_exp_f32 v178, v178
    v_exp_f32 v179, v179
    v_exp_f32 v180, v180
    v_exp_f32 v181, v181
    v_exp_f32 v182, v182
    v_exp_f32 v183, v183
    v_mul_f32 v8, v8, v3
    v_mul_f32 v9, v9, v3
    v_mul_f32 v10, v10, v3
    v_mul_f32 v11, v11, v3
    v_mul_f32 v12, v12, v3
    v_mul_f32 v13, v13, v3
    v_mul_f32 v14, v14, v3
    v_mul_f32 v15, v15, v3
    v_mul_f32 v16, v16, v3
    v_mul_f32 v17, v17, v3
    v_mul_f32 v18, v18, v3
    v_mul_f32 v19, v19, v3
    v_mul_f32 v20, v20, v3
    v_mul_f32 v21, v21, v3
    v_mul_f32 v22, v22, v3
    v_mul_f32 v23, v23, v3
    v_mul_f32 v120, v120, v3
    v_mul_f32 v121, v121, v3
    v_mul_f32 v122, v122, v3
    v_mul_f32 v123, v123, v3
    v_mul_f32 v124, v124, v3
    v_mul_f32 v125, v125, v3
    v_mul_f32 v126, v126, v3
    v_mul_f32 v127, v127, v3
    v_accvgpr_read_b32 v1, a0
    v_mul_f32 v1, v1, v3
    v_accvgpr_write_b32 a0, v1
    v_accvgpr_read_b32 v1, a1
    v_mul_f32 v1, v1, v3
    v_accvgpr_write_b32 a1, v1
    v_accvgpr_read_b32 v1, a2
    v_mul_f32 v1, v1, v3
    v_accvgpr_write_b32 a2, v1
    v_accvgpr_read_b32 v1, a3
    v_mul_f32 v1, v1, v3
    v_accvgpr_write_b32 a3, v1
    v_accvgpr_read_b32 v1, a4
    v_mul_f32 v1, v1, v3
    v_accvgpr_write_b32 a4, v1
    v_accvgpr_read_b32 v1, a5
    v_mul_f32 v1, v1, v3
    v_accvgpr_write_b32 a5, v1
    v_accvgpr_read_b32 v1, a6
    v_mul_f32 v1, v1, v3
    v_accvgpr_write_b32 a6, v1
    v_accvgpr_read_b32 v1, a7
    v_mul_f32 v1, v1, v3
    v_accvgpr_write_b32 a7, v1
    v_accvgpr_read_b32 v1, a56
    v_mul_f32 v1, v1, v3
    v_accvgpr_write_b32 a56, v1
    v_accvgpr_read_b32 v1, a57
    v_mul_f32 v1, v1, v3
    v_accvgpr_write_b32 a57, v1
    v_accvgpr_read_b32 v1, a58
    v_mul_f32 v1, v1, v3
    v_accvgpr_write_b32 a58, v1
    v_accvgpr_read_b32 v1, a59
    v_mul_f32 v1, v1, v3
    v_accvgpr_write_b32 a59, v1
    v_cvt_pk_bf16_f32 v176, v176, v177
    v_cvt_pk_bf16_f32 v177, v178, v179
    v_cvt_pk_bf16_f32 v178, v180, v181
    v_cvt_pk_bf16_f32 v179, v182, v183
    v_max3_f32 v2, v184, v185, v186
    v_max3_f32 v2, v2, v187, v188
    v_max3_f32 v2, v2, v189, v190
    v_max3_f32 v2, v2, v191, v249
    v_mov_b32 v1, v2
    s_nop 1
    v_permlane32_swap_b32 v2, v1
    v_max_f32 v2, v2, v1
    v_mov_b32 v1, v2
    s_nop 1
    v_permlane16_swap_b32 v2, v1
    v_max_f32 v2, v2, v1
    v_sub_f32 v3, v249, v2
    v_exp_f32 v3, v3
    v_mov_b32 v249, v2
    v_sub_f32 v184, v184, v2
    v_sub_f32 v185, v185, v2
    v_sub_f32 v186, v186, v2
    v_sub_f32 v187, v187, v2
    v_sub_f32 v188, v188, v2
    v_sub_f32 v189, v189, v2
    v_sub_f32 v190, v190, v2
    v_sub_f32 v191, v191, v2
    v_exp_f32 v184, v184
    v_exp_f32 v185, v185
    v_exp_f32 v186, v186
    v_exp_f32 v187, v187
    v_exp_f32 v188, v188
    v_exp_f32 v189, v189
    v_exp_f32 v190, v190
    v_exp_f32 v191, v191
    v_mul_f32 v24, v24, v3
    v_mul_f32 v25, v25, v3
    v_mul_f32 v26, v26, v3
    v_mul_f32 v27, v27, v3
    v_mul_f32 v28, v28, v3
    v_mul_f32 v29, v29, v3
    v_mul_f32 v30, v30, v3
    v_mul_f32 v31, v31, v3
    v_mul_f32 v32, v32, v3
    v_mul_f32 v33, v33, v3
    v_mul_f32 v34, v34, v3
    v_mul_f32 v35, v35, v3
    v_mul_f32 v36, v36, v3
    v_mul_f32 v37, v37, v3
    v_mul_f32 v38, v38, v3
    v_mul_f32 v39, v39, v3
    v_mul_f32 v128, v128, v3
    v_mul_f32 v129, v129, v3
    v_mul_f32 v130, v130, v3
    v_mul_f32 v131, v131, v3
    v_mul_f32 v132, v132, v3
    v_mul_f32 v133, v133, v3
    v_mul_f32 v134, v134, v3
    v_mul_f32 v135, v135, v3
    v_accvgpr_read_b32 v1, a8
    v_mul_f32 v1, v1, v3
    v_accvgpr_write_b32 a8, v1
    v_accvgpr_read_b32 v1, a9
    v_mul_f32 v1, v1, v3
    v_accvgpr_write_b32 a9, v1
    v_accvgpr_read_b32 v1, a10
    v_mul_f32 v1, v1, v3
    v_accvgpr_write_b32 a10, v1
    v_accvgpr_read_b32 v1, a11
    v_mul_f32 v1, v1, v3
    v_accvgpr_write_b32 a11, v1
    v_accvgpr_read_b32 v1, a12
    v_mul_f32 v1, v1, v3
    v_accvgpr_write_b32 a12, v1
    v_accvgpr_read_b32 v1, a13
    v_mul_f32 v1, v1, v3
    v_accvgpr_write_b32 a13, v1
    v_accvgpr_read_b32 v1, a14
    v_mul_f32 v1, v1, v3
    v_accvgpr_write_b32 a14, v1
    v_accvgpr_read_b32 v1, a15
    v_mul_f32 v1, v1, v3
    v_accvgpr_write_b32 a15, v1
    v_accvgpr_read_b32 v1, a60
    v_mul_f32 v1, v1, v3
    v_accvgpr_write_b32 a60, v1
    v_accvgpr_read_b32 v1, a61
    v_mul_f32 v1, v1, v3
    v_accvgpr_write_b32 a61, v1
    v_accvgpr_read_b32 v1, a62
    v_mul_f32 v1, v1, v3
    v_accvgpr_write_b32 a62, v1
    v_accvgpr_read_b32 v1, a63
    v_mul_f32 v1, v1, v3
    v_accvgpr_write_b32 a63, v1
    v_cvt_pk_bf16_f32 v184, v184, v185
    v_cvt_pk_bf16_f32 v185, v186, v187
    v_cvt_pk_bf16_f32 v186, v188, v189
    v_cvt_pk_bf16_f32 v187, v190, v191
    v_max3_f32 v2, v192, v193, v194
    v_max3_f32 v2, v2, v195, v196
    v_max3_f32 v2, v2, v197, v198
    v_max3_f32 v2, v2, v199, v250
    v_mov_b32 v1, v2
    s_nop 1
    v_permlane32_swap_b32 v2, v1
    v_max_f32 v2, v2, v1
    v_mov_b32 v1, v2
    s_nop 1
    v_permlane16_swap_b32 v2, v1
    v_max_f32 v2, v2, v1
    v_sub_f32 v3, v250, v2
    v_exp_f32 v3, v3
    v_mov_b32 v250, v2
    v_sub_f32 v192, v192, v2
    v_sub_f32 v193, v193, v2
    v_sub_f32 v194, v194, v2
    v_sub_f32 v195, v195, v2
    v_sub_f32 v196, v196, v2
    v_sub_f32 v197, v197, v2
    v_sub_f32 v198, v198, v2
    v_sub_f32 v199, v199, v2
    v_exp_f32 v192, v192
    v_exp_f32 v193, v193
    v_exp_f32 v194, v194
    v_exp_f32 v195, v195
    v_exp_f32 v196, v196
    v_exp_f32 v197, v197
    v_exp_f32 v198, v198
    v_exp_f32 v199, v199
    v_mul_f32 v40, v40, v3
    v_mul_f32 v41, v41, v3
    v_mul_f32 v42, v42, v3
    v_mul_f32 v43, v43, v3
    v_mul_f32 v44, v44, v3
    v_mul_f32 v45, v45, v3
    v_mul_f32 v46, v46, v3
    v_mul_f32 v47, v47, v3
    v_mul_f32 v48, v48, v3
    v_mul_f32 v49, v49, v3
    v_mul_f32 v50, v50, v3
    v_mul_f32 v51, v51, v3
    v_mul_f32 v52, v52, v3
    v_mul_f32 v53, v53, v3
    v_mul_f32 v54, v54, v3
    v_mul_f32 v55, v55, v3
    v_mul_f32 v136, v136, v3
    v_mul_f32 v137, v137, v3
    v_mul_f32 v138, v138, v3
    v_mul_f32 v139, v139, v3
    v_mul_f32 v140, v140, v3
    v_mul_f32 v141, v141, v3
    v_mul_f32 v142, v142, v3
    v_mul_f32 v143, v143, v3
    v_accvgpr_read_b32 v1, a16
    v_mul_f32 v1, v1, v3
    v_accvgpr_write_b32 a16, v1
    v_accvgpr_read_b32 v1, a17
    v_mul_f32 v1, v1, v3
    v_accvgpr_write_b32 a17, v1
    v_accvgpr_read_b32 v1, a18
    v_mul_f32 v1, v1, v3
    v_accvgpr_write_b32 a18, v1
    v_accvgpr_read_b32 v1, a19
    v_mul_f32 v1, v1, v3
    v_accvgpr_write_b32 a19, v1
    v_accvgpr_read_b32 v1, a20
    v_mul_f32 v1, v1, v3
    v_accvgpr_write_b32 a20, v1
    v_accvgpr_read_b32 v1, a21
    v_mul_f32 v1, v1, v3
    v_accvgpr_write_b32 a21, v1
    v_accvgpr_read_b32 v1, a22
    v_mul_f32 v1, v1, v3
    v_accvgpr_write_b32 a22, v1
    v_accvgpr_read_b32 v1, a23
    v_mul_f32 v1, v1, v3
    v_accvgpr_write_b32 a23, v1
    v_accvgpr_read_b32 v1, a64
    v_mul_f32 v1, v1, v3
    v_accvgpr_write_b32 a64, v1
    v_accvgpr_read_b32 v1, a65
    v_mul_f32 v1, v1, v3
    v_accvgpr_write_b32 a65, v1
    v_accvgpr_read_b32 v1, a66
    v_mul_f32 v1, v1, v3
    v_accvgpr_write_b32 a66, v1
    v_accvgpr_read_b32 v1, a67
    v_mul_f32 v1, v1, v3
    v_accvgpr_write_b32 a67, v1
    v_cvt_pk_bf16_f32 v192, v192, v193
    v_cvt_pk_bf16_f32 v193, v194, v195
    v_cvt_pk_bf16_f32 v194, v196, v197
    v_cvt_pk_bf16_f32 v195, v198, v199
    v_max3_f32 v2, v200, v201, v202
    v_max3_f32 v2, v2, v203, v204
    v_max3_f32 v2, v2, v205, v206
    v_max3_f32 v2, v2, v207, v251
    v_mov_b32 v1, v2
    s_nop 1
    v_permlane32_swap_b32 v2, v1
    v_max_f32 v2, v2, v1
    v_mov_b32 v1, v2
    s_nop 1
    v_permlane16_swap_b32 v2, v1
    v_max_f32 v2, v2, v1
    v_sub_f32 v3, v251, v2
    v_exp_f32 v3, v3
    v_mov_b32 v251, v2
    v_sub_f32 v200, v200, v2
    v_sub_f32 v201, v201, v2
    v_sub_f32 v202, v202, v2
    v_sub_f32 v203, v203, v2
    v_sub_f32 v204, v204, v2
    v_sub_f32 v205, v205, v2
    v_sub_f32 v206, v206, v2
    v_sub_f32 v207, v207, v2
    v_exp_f32 v200, v200
    v_exp_f32 v201, v201
    v_exp_f32 v202, v202
    v_exp_f32 v203, v203
    v_exp_f32 v204, v204
    v_exp_f32 v205, v205
    v_exp_f32 v206, v206
    v_exp_f32 v207, v207
    v_mul_f32 v56, v56, v3
    v_mul_f32 v57, v57, v3
    v_mul_f32 v58, v58, v3
    v_mul_f32 v59, v59, v3
    v_mul_f32 v60, v60, v3
    v_mul_f32 v61, v61, v3
    v_mul_f32 v62, v62, v3
    v_mul_f32 v63, v63, v3
    v_mul_f32 v64, v64, v3
    v_mul_f32 v65, v65, v3
    v_mul_f32 v66, v66, v3
    v_mul_f32 v67, v67, v3
    v_mul_f32 v68, v68, v3
    v_mul_f32 v69, v69, v3
    v_mul_f32 v70, v70, v3
    v_mul_f32 v71, v71, v3
    v_mul_f32 v144, v144, v3
    v_mul_f32 v145, v145, v3
    v_mul_f32 v146, v146, v3
    v_mul_f32 v147, v147, v3
    v_mul_f32 v148, v148, v3
    v_mul_f32 v149, v149, v3
    v_mul_f32 v150, v150, v3
    v_mul_f32 v151, v151, v3
    v_accvgpr_read_b32 v1, a24
    v_mul_f32 v1, v1, v3
    v_accvgpr_write_b32 a24, v1
    v_accvgpr_read_b32 v1, a25
    v_mul_f32 v1, v1, v3
    v_accvgpr_write_b32 a25, v1
    v_accvgpr_read_b32 v1, a26
    v_mul_f32 v1, v1, v3
    v_accvgpr_write_b32 a26, v1
    v_accvgpr_read_b32 v1, a27
    v_mul_f32 v1, v1, v3
    v_accvgpr_write_b32 a27, v1
    v_accvgpr_read_b32 v1, a28
    v_mul_f32 v1, v1, v3
    v_accvgpr_write_b32 a28, v1
    v_accvgpr_read_b32 v1, a29
    v_mul_f32 v1, v1, v3
    v_accvgpr_write_b32 a29, v1
    v_accvgpr_read_b32 v1, a30
    v_mul_f32 v1, v1, v3
    v_accvgpr_write_b32 a30, v1
    v_accvgpr_read_b32 v1, a31
    v_mul_f32 v1, v1, v3
    v_accvgpr_write_b32 a31, v1
    v_accvgpr_read_b32 v1, a68
    v_mul_f32 v1, v1, v3
    v_accvgpr_write_b32 a68, v1
    v_accvgpr_read_b32 v1, a69
    v_mul_f32 v1, v1, v3
    v_accvgpr_write_b32 a69, v1
    v_accvgpr_read_b32 v1, a70
    v_mul_f32 v1, v1, v3
    v_accvgpr_write_b32 a70, v1
    v_accvgpr_read_b32 v1, a71
    v_mul_f32 v1, v1, v3
    v_accvgpr_write_b32 a71, v1
    v_cvt_pk_bf16_f32 v200, v200, v201
    v_cvt_pk_bf16_f32 v201, v202, v203
    v_cvt_pk_bf16_f32 v202, v204, v205
    v_cvt_pk_bf16_f32 v203, v206, v207
    v_max3_f32 v2, v208, v209, v210
    v_max3_f32 v2, v2, v211, v212
    v_max3_f32 v2, v2, v213, v214
    v_max3_f32 v2, v2, v215, v252
    v_mov_b32 v1, v2
    s_nop 1
    v_permlane32_swap_b32 v2, v1
    v_max_f32 v2, v2, v1
    v_mov_b32 v1, v2
    s_nop 1
    v_permlane16_swap_b32 v2, v1
    v_max_f32 v2, v2, v1
    v_sub_f32 v3, v252, v2
    v_exp_f32 v3, v3
    v_mov_b32 v252, v2
    v_sub_f32 v208, v208, v2
    v_sub_f32 v209, v209, v2
    v_sub_f32 v210, v210, v2
    v_sub_f32 v211, v211, v2
    v_sub_f32 v212, v212, v2
    v_sub_f32 v213, v213, v2
    v_sub_f32 v214, v214, v2
    v_sub_f32 v215, v215, v2
    v_exp_f32 v208, v208
    v_exp_f32 v209, v209
    v_exp_f32 v210, v210
    v_exp_f32 v211, v211
    v_exp_f32 v212, v212
    v_exp_f32 v213, v213
    v_exp_f32 v214, v214
    v_exp_f32 v215, v215
    v_mul_f32 v72, v72, v3
    v_mul_f32 v73, v73, v3
    v_mul_f32 v74, v74, v3
    v_mul_f32 v75, v75, v3
    v_mul_f32 v76, v76, v3
    v_mul_f32 v77, v77, v3
    v_mul_f32 v78, v78, v3
    v_mul_f32 v79, v79, v3
    v_mul_f32 v80, v80, v3
    v_mul_f32 v81, v81, v3
    v_mul_f32 v82, v82, v3
    v_mul_f32 v83, v83, v3
    v_mul_f32 v84, v84, v3
    v_mul_f32 v85, v85, v3
    v_mul_f32 v86, v86, v3
    v_mul_f32 v87, v87, v3
    v_mul_f32 v152, v152, v3
    v_mul_f32 v153, v153, v3
    v_mul_f32 v154, v154, v3
    v_mul_f32 v155, v155, v3
    v_mul_f32 v156, v156, v3
    v_mul_f32 v157, v157, v3
    v_mul_f32 v158, v158, v3
    v_mul_f32 v159, v159, v3
    v_accvgpr_read_b32 v1, a32
    v_mul_f32 v1, v1, v3
    v_accvgpr_write_b32 a32, v1
    v_accvgpr_read_b32 v1, a33
    v_mul_f32 v1, v1, v3
    v_accvgpr_write_b32 a33, v1
    v_accvgpr_read_b32 v1, a34
    v_mul_f32 v1, v1, v3
    v_accvgpr_write_b32 a34, v1
    v_accvgpr_read_b32 v1, a35
    v_mul_f32 v1, v1, v3
    v_accvgpr_write_b32 a35, v1
    v_accvgpr_read_b32 v1, a36
    v_mul_f32 v1, v1, v3
    v_accvgpr_write_b32 a36, v1
    v_accvgpr_read_b32 v1, a37
    v_mul_f32 v1, v1, v3
    v_accvgpr_write_b32 a37, v1
    v_accvgpr_read_b32 v1, a38
    v_mul_f32 v1, v1, v3
    v_accvgpr_write_b32 a38, v1
    v_accvgpr_read_b32 v1, a39
    v_mul_f32 v1, v1, v3
    v_accvgpr_write_b32 a39, v1
    v_accvgpr_read_b32 v1, a72
    v_mul_f32 v1, v1, v3
    v_accvgpr_write_b32 a72, v1
    v_accvgpr_read_b32 v1, a73
    v_mul_f32 v1, v1, v3
    v_accvgpr_write_b32 a73, v1
    v_accvgpr_read_b32 v1, a74
    v_mul_f32 v1, v1, v3
    v_accvgpr_write_b32 a74, v1
    v_accvgpr_read_b32 v1, a75
    v_mul_f32 v1, v1, v3
    v_accvgpr_write_b32 a75, v1
    v_cvt_pk_bf16_f32 v208, v208, v209
    v_cvt_pk_bf16_f32 v209, v210, v211
    v_cvt_pk_bf16_f32 v210, v212, v213
    v_cvt_pk_bf16_f32 v211, v214, v215
    v_max3_f32 v2, v216, v217, v218
    v_max3_f32 v2, v2, v219, v220
    v_max3_f32 v2, v2, v221, v222
    v_max3_f32 v2, v2, v223, v253
    v_mov_b32 v1, v2
    s_nop 1
    v_permlane32_swap_b32 v2, v1
    v_max_f32 v2, v2, v1
    v_mov_b32 v1, v2
    s_nop 1
    v_permlane16_swap_b32 v2, v1
    v_max_f32 v2, v2, v1
    v_sub_f32 v3, v253, v2
    v_exp_f32 v3, v3
    v_mov_b32 v253, v2
    v_sub_f32 v216, v216, v2
    v_sub_f32 v217, v217, v2
    v_sub_f32 v218, v218, v2
    v_sub_f32 v219, v219, v2
    v_sub_f32 v220, v220, v2
    v_sub_f32 v221, v221, v2
    v_sub_f32 v222, v222, v2
    v_sub_f32 v223, v223, v2
    v_exp_f32 v216, v216
    v_exp_f32 v217, v217
    v_exp_f32 v218, v218
    v_exp_f32 v219, v219
    v_exp_f32 v220, v220
    v_exp_f32 v221, v221
    v_exp_f32 v222, v222
    v_exp_f32 v223, v223
    v_mul_f32 v88, v88, v3
    v_mul_f32 v89, v89, v3
    v_mul_f32 v90, v90, v3
    v_mul_f32 v91, v91, v3
    v_mul_f32 v92, v92, v3
    v_mul_f32 v93, v93, v3
    v_mul_f32 v94, v94, v3
    v_mul_f32 v95, v95, v3
    v_mul_f32 v96, v96, v3
    v_mul_f32 v97, v97, v3
    v_mul_f32 v98, v98, v3
    v_mul_f32 v99, v99, v3
    v_mul_f32 v100, v100, v3
    v_mul_f32 v101, v101, v3
    v_mul_f32 v102, v102, v3
    v_mul_f32 v103, v103, v3
    v_mul_f32 v160, v160, v3
    v_mul_f32 v161, v161, v3
    v_mul_f32 v162, v162, v3
    v_mul_f32 v163, v163, v3
    v_mul_f32 v164, v164, v3
    v_mul_f32 v165, v165, v3
    v_mul_f32 v166, v166, v3
    v_mul_f32 v167, v167, v3
    v_accvgpr_read_b32 v1, a40
    v_mul_f32 v1, v1, v3
    v_accvgpr_write_b32 a40, v1
    v_accvgpr_read_b32 v1, a41
    v_mul_f32 v1, v1, v3
    v_accvgpr_write_b32 a41, v1
    v_accvgpr_read_b32 v1, a42
    v_mul_f32 v1, v1, v3
    v_accvgpr_write_b32 a42, v1
    v_accvgpr_read_b32 v1, a43
    v_mul_f32 v1, v1, v3
    v_accvgpr_write_b32 a43, v1
    v_accvgpr_read_b32 v1, a44
    v_mul_f32 v1, v1, v3
    v_accvgpr_write_b32 a44, v1
    v_accvgpr_read_b32 v1, a45
    v_mul_f32 v1, v1, v3
    v_accvgpr_write_b32 a45, v1
    v_accvgpr_read_b32 v1, a46
    v_mul_f32 v1, v1, v3
    v_accvgpr_write_b32 a46, v1
    v_accvgpr_read_b32 v1, a47
    v_mul_f32 v1, v1, v3
    v_accvgpr_write_b32 a47, v1
    v_accvgpr_read_b32 v1, a76
    v_mul_f32 v1, v1, v3
    v_accvgpr_write_b32 a76, v1
    v_accvgpr_read_b32 v1, a77
    v_mul_f32 v1, v1, v3
    v_accvgpr_write_b32 a77, v1
    v_accvgpr_read_b32 v1, a78
    v_mul_f32 v1, v1, v3
    v_accvgpr_write_b32 a78, v1
    v_accvgpr_read_b32 v1, a79
    v_mul_f32 v1, v1, v3
    v_accvgpr_write_b32 a79, v1
    v_cvt_pk_bf16_f32 v216, v216, v217
    v_cvt_pk_bf16_f32 v217, v218, v219
    v_cvt_pk_bf16_f32 v218, v220, v221
    v_cvt_pk_bf16_f32 v219, v222, v223
    v_max3_f32 v2, v224, v225, v226
    v_max3_f32 v2, v2, v227, v228
    v_max3_f32 v2, v2, v229, v230
    v_max3_f32 v2, v2, v231, v254
    v_mov_b32 v1, v2
    s_nop 1
    v_permlane32_swap_b32 v2, v1
    v_max_f32 v2, v2, v1
    v_mov_b32 v1, v2
    s_nop 1
    v_permlane16_swap_b32 v2, v1
    v_max_f32 v2, v2, v1
    v_sub_f32 v3, v254, v2
    v_exp_f32 v3, v3
    v_mov_b32 v254, v2
    v_sub_f32 v224, v224, v2
    v_sub_f32 v225, v225, v2
    v_sub_f32 v226, v226, v2
    v_sub_f32 v227, v227, v2
    v_sub_f32 v228, v228, v2
    v_sub_f32 v229, v229, v2
    v_sub_f32 v230, v230, v2
    v_sub_f32 v231, v231, v2
    v_exp_f32 v224, v224
    v_exp_f32 v225, v225
    v_exp_f32 v226, v226
    v_exp_f32 v227, v227
    v_exp_f32 v228, v228
    v_exp_f32 v229, v229
    v_exp_f32 v230, v230
    v_exp_f32 v231, v231
    v_mul_f32 v104, v104, v3
    v_mul_f32 v105, v105, v3
    v_mul_f32 v106, v106, v3
    v_mul_f32 v107, v107, v3
    v_mul_f32 v108, v108, v3
    v_mul_f32 v109, v109, v3
    v_mul_f32 v110, v110, v3
    v_mul_f32 v111, v111, v3
    v_mul_f32 v112, v112, v3
    v_mul_f32 v113, v113, v3
    v_mul_f32 v114, v114, v3
    v_mul_f32 v115, v115, v3
    v_mul_f32 v116, v116, v3
    v_mul_f32 v117, v117, v3
    v_mul_f32 v118, v118, v3
    v_mul_f32 v119, v119, v3
    v_mul_f32 v168, v168, v3
    v_mul_f32 v169, v169, v3
    v_mul_f32 v170, v170, v3
    v_mul_f32 v171, v171, v3
    v_mul_f32 v172, v172, v3
    v_mul_f32 v173, v173, v3
    v_mul_f32 v174, v174, v3
    v_mul_f32 v175, v175, v3
    v_accvgpr_read_b32 v1, a48
    v_mul_f32 v1, v1, v3
    v_accvgpr_write_b32 a48, v1
    v_accvgpr_read_b32 v1, a49
    v_mul_f32 v1, v1, v3
    v_accvgpr_write_b32 a49, v1
    v_accvgpr_read_b32 v1, a50
    v_mul_f32 v1, v1, v3
    v_accvgpr_write_b32 a50, v1
    v_accvgpr_read_b32 v1, a51
    v_mul_f32 v1, v1, v3
    v_accvgpr_write_b32 a51, v1
    v_accvgpr_read_b32 v1, a52
    v_mul_f32 v1, v1, v3
    v_accvgpr_write_b32 a52, v1
    v_accvgpr_read_b32 v1, a53
    v_mul_f32 v1, v1, v3
    v_accvgpr_write_b32 a53, v1
    v_accvgpr_read_b32 v1, a54
    v_mul_f32 v1, v1, v3
    v_accvgpr_write_b32 a54, v1
    v_accvgpr_read_b32 v1, a55
    v_mul_f32 v1, v1, v3
    v_accvgpr_write_b32 a55, v1
    v_accvgpr_read_b32 v1, a80
    v_mul_f32 v1, v1, v3
    v_accvgpr_write_b32 a80, v1
    v_accvgpr_read_b32 v1, a81
    v_mul_f32 v1, v1, v3
    v_accvgpr_write_b32 a81, v1
    v_accvgpr_read_b32 v1, a82
    v_mul_f32 v1, v1, v3
    v_accvgpr_write_b32 a82, v1
    v_accvgpr_read_b32 v1, a83
    v_mul_f32 v1, v1, v3
    v_accvgpr_write_b32 a83, v1
    v_cvt_pk_bf16_f32 v224, v224, v225
    v_cvt_pk_bf16_f32 v225, v226, v227
    v_cvt_pk_bf16_f32 v226, v228, v229
    v_cvt_pk_bf16_f32 v227, v230, v231
    s_waitcnt lgkmcnt(0)
    v_mfma_f32_16x16x32_bf16 v[8:11], a[84:87], v[176:179], v[8:11]
    v_mfma_f32_16x16x32_bf16 v[12:15], a[116:119], v[176:179], v[12:15]
    v_mfma_f32_16x16x32_bf16 v[16:19], a[120:123], v[176:179], v[16:19]
    v_mfma_f32_16x16x32_bf16 v[20:23], a[124:127], v[176:179], v[20:23]
    v_mfma_f32_16x16x32_bf16 v[120:123], a[128:131], v[176:179], v[120:123]
    v_mfma_f32_16x16x32_bf16 v[124:127], a[132:135], v[176:179], v[124:127]
    v_mfma_f32_16x16x32_bf16 a[0:3], a[136:139], v[176:179], a[0:3]
    v_mfma_f32_16x16x32_bf16 a[4:7], a[140:143], v[176:179], a[4:7]
    v_mfma_f32_16x16x32_bf16 a[56:59], v[232:235], v[176:179], a[56:59]
    v_mfma_f32_16x16x32_bf16 v[24:27], a[84:87], v[184:187], v[24:27]
    v_mfma_f32_16x16x32_bf16 v[28:31], a[116:119], v[184:187], v[28:31]
    v_mfma_f32_16x16x32_bf16 v[32:35], a[120:123], v[184:187], v[32:35]
    v_mfma_f32_16x16x32_bf16 v[36:39], a[124:127], v[184:187], v[36:39]
    v_mfma_f32_16x16x32_bf16 v[128:131], a[128:131], v[184:187], v[128:131]
    v_mfma_f32_16x16x32_bf16 v[132:135], a[132:135], v[184:187], v[132:135]
    v_mfma_f32_16x16x32_bf16 a[8:11], a[136:139], v[184:187], a[8:11]
    v_mfma_f32_16x16x32_bf16 a[12:15], a[140:143], v[184:187], a[12:15]
    v_mfma_f32_16x16x32_bf16 a[60:63], v[232:235], v[184:187], a[60:63]
    v_mfma_f32_16x16x32_bf16 v[40:43], a[84:87], v[192:195], v[40:43]
    v_mfma_f32_16x16x32_bf16 v[44:47], a[116:119], v[192:195], v[44:47]
    v_mfma_f32_16x16x32_bf16 v[48:51], a[120:123], v[192:195], v[48:51]
    v_mfma_f32_16x16x32_bf16 v[52:55], a[124:127], v[192:195], v[52:55]
    v_mfma_f32_16x16x32_bf16 v[136:139], a[128:131], v[192:195], v[136:139]
    v_mfma_f32_16x16x32_bf16 v[140:143], a[132:135], v[192:195], v[140:143]
    v_mfma_f32_16x16x32_bf16 a[16:19], a[136:139], v[192:195], a[16:19]
    v_mfma_f32_16x16x32_bf16 a[20:23], a[140:143], v[192:195], a[20:23]
    v_mfma_f32_16x16x32_bf16 a[64:67], v[232:235], v[192:195], a[64:67]
    v_mfma_f32_16x16x32_bf16 v[56:59], a[84:87], v[200:203], v[56:59]
    v_mfma_f32_16x16x32_bf16 v[60:63], a[116:119], v[200:203], v[60:63]
    v_mfma_f32_16x16x32_bf16 v[64:67], a[120:123], v[200:203], v[64:67]
    v_mfma_f32_16x16x32_bf16 v[68:71], a[124:127], v[200:203], v[68:71]
    v_mfma_f32_16x16x32_bf16 v[144:147], a[128:131], v[200:203], v[144:147]
    v_mfma_f32_16x16x32_bf16 v[148:151], a[132:135], v[200:203], v[148:151]
    v_mfma_f32_16x16x32_bf16 a[24:27], a[136:139], v[200:203], a[24:27]
    v_mfma_f32_16x16x32_bf16 a[28:31], a[140:143], v[200:203], a[28:31]
    v_mfma_f32_16x16x32_bf16 a[68:71], v[232:235], v[200:203], a[68:71]
    v_mfma_f32_16x16x32_bf16 v[72:75], a[84:87], v[208:211], v[72:75]
    v_mfma_f32_16x16x32_bf16 v[76:79], a[116:119], v[208:211], v[76:79]
    v_mfma_f32_16x16x32_bf16 v[80:83], a[120:123], v[208:211], v[80:83]
    v_mfma_f32_16x16x32_bf16 v[84:87], a[124:127], v[208:211], v[84:87]
    v_mfma_f32_16x16x32_bf16 v[152:155], a[128:131], v[208:211], v[152:155]
    v_mfma_f32_16x16x32_bf16 v[156:159], a[132:135], v[208:211], v[156:159]
    v_mfma_f32_16x16x32_bf16 a[32:35], a[136:139], v[208:211], a[32:35]
    v_mfma_f32_16x16x32_bf16 a[36:39], a[140:143], v[208:211], a[36:39]
    v_mfma_f32_16x16x32_bf16 a[72:75], v[232:235], v[208:211], a[72:75]
    v_mfma_f32_16x16x32_bf16 v[88:91], a[84:87], v[216:219], v[88:91]
    v_mfma_f32_16x16x32_bf16 v[92:95], a[116:119], v[216:219], v[92:95]
    v_mfma_f32_16x16x32_bf16 v[96:99], a[120:123], v[216:219], v[96:99]
    v_mfma_f32_16x16x32_bf16 v[100:103], a[124:127], v[216:219], v[100:103]
    v_mfma_f32_16x16x32_bf16 v[160:163], a[128:131], v[216:219], v[160:163]
    v_mfma_f32_16x16x32_bf16 v[164:167], a[132:135], v[216:219], v[164:167]
    v_mfma_f32_16x16x32_bf16 a[40:43], a[136:139], v[216:219], a[40:43]
    v_mfma_f32_16x16x32_bf16 a[44:47], a[140:143], v[216:219], a[44:47]
    v_mfma_f32_16x16x32_bf16 a[76:79], v[232:235], v[216:219], a[76:79]
    v_mfma_f32_16x16x32_bf16 v[104:107], a[84:87], v[224:227], v[104:107]
    v_mfma_f32_16x16x32_bf16 v[108:111], a[116:119], v[224:227], v[108:111]
    v_mfma_f32_16x16x32_bf16 v[112:115], a[120:123], v[224:227], v[112:115]
    v_mfma_f32_16x16x32_bf16 v[116:119], a[124:127], v[224:227], v[116:119]
    v_mfma_f32_16x16x32_bf16 v[168:171], a[128:131], v[224:227], v[168:171]
    v_mfma_f32_16x16x32_bf16 v[172:175], a[132:135], v[224:227], v[172:175]
    v_mfma_f32_16x16x32_bf16 a[48:51], a[136:139], v[224:227], a[48:51]
    v_mfma_f32_16x16x32_bf16 a[52:55], a[140:143], v[224:227], a[52:55]
    v_mfma_f32_16x16x32_bf16 a[80:83], v[232:235], v[224:227], a[80:83]
    s_addk_i32 s58, 0x2000
    s_add_u32 s59, s59, 1
    s_cmp_lt_u32 s59, 16
    s_cbranch_scc1 L_sloop
    s_nop 7
    v_accvgpr_read_b32 v224, a56
    v_accvgpr_read_b32 v225, a60
    v_accvgpr_read_b32 v226, a64
    v_accvgpr_read_b32 v227, a68
    v_accvgpr_read_b32 v228, a72
    v_accvgpr_read_b32 v229, a76
    v_accvgpr_read_b32 v230, a80
    v_rcp_f32 v224, v224
    v_rcp_f32 v225, v225
    v_rcp_f32 v226, v226
    v_rcp_f32 v227, v227
    v_rcp_f32 v228, v228
    v_rcp_f32 v229, v229
    v_rcp_f32 v230, v230
    s_branch L_lok
L_end:
    s_endpgm
.section .rodata,"a"
.p2align 6
.amdhsa_kernel concat_heads__mha_block_cached__mha_block_cached__near_ridge_kernel
  .amdhsa_next_free_vgpr 512
  .amdhsa_next_free_sgpr 102
  .amdhsa_accum_offset 256
  .amdhsa_group_segment_fixed_size 0
  .amdhsa_kernarg_size 104
  .amdhsa_user_sgpr_count 2
  .amdhsa_user_sgpr_kernarg_segment_ptr 1
  .amdhsa_system_sgpr_workgroup_id_x 1
  .amdhsa_float_denorm_mode_32 3
.end_amdhsa_kernel
```
